```python
import torch

def _softmax(x, axis=-1):
    return torch.softmax(x, dim=axis)
def _gelu(x):
    return torch.nn.functional.gelu(x, approximate="tanh")
def _silu(x):
    return torch.nn.functional.silu(x)
def _sigmoid(x):
    return torch.sigmoid(x)
def _layernorm(x, axis=-1, eps=1e-5):
    m = x.mean(dim=axis, keepdim=True)
    v = x.var(dim=axis, keepdim=True, unbiased=False)
    return (x - m) / torch.sqrt(v + eps)
def _scatter_add(tgt, idx, src, axis=0):
    return tgt.clone().index_add_(axis, idx, src)
def _segment_sum(src, seg, n):
    out = torch.zeros((n,) + src.shape[1:], dtype=src.dtype)
    return out.index_add_(0, seg, src)
def _pad(x, pw):
    flat = tuple(v for pair in reversed(pw) for v in pair)
    return torch.nn.functional.pad(x, flat)

kernel_name = 'recurrent_scan__ssm_conv_s5__mixer_channel_mlp__prompt'

def setup_inputs():

    _w = (lambda a: (lambda t: t.to(torch.bfloat16) if t.is_floating_point() else t)(torch.as_tensor(a)))
    def _A_setup():
        B, S, D = 1, 2048, 1024
        P = D
        Lambda_re = -0.5 * (lambda _x: torch.exp(torch.as_tensor(_x)))((lambda *s: torch.randn(*s, dtype=torch.bfloat16) * 0.8)(P))
        Lambda_im = (lambda *s: torch.randn(*s, dtype=torch.bfloat16) * 0.8)(P) * 1.0
        B_re = (lambda *s: torch.randn(*s, dtype=torch.bfloat16) * 0.8)(P, D) * (D ** -0.5)
        B_im = (lambda *s: torch.randn(*s, dtype=torch.bfloat16) * 0.8)(P, D) * (D ** -0.5)
        C_re = (lambda *s: torch.randn(*s, dtype=torch.bfloat16) * 0.8)(D, P) * (P ** -0.5)
        C_im = (lambda *s: torch.randn(*s, dtype=torch.bfloat16) * 0.8)(D, P) * (P ** -0.5)
        log_dt = (lambda *s: torch.randn(*s, dtype=torch.bfloat16) * 0.8)(P) * 0.3 - 2.0
        Dskip = (lambda *s: torch.randn(*s, dtype=torch.bfloat16) * 0.4)(D)
        return {
            "x": _w((lambda *s: torch.randn(*s, dtype=torch.bfloat16) * 0.05)(B, S, D)),
            "Lambda_re": _w(Lambda_re),
            "Lambda_im": _w(Lambda_im),
            "B_re": _w(B_re),
            "B_im": _w(B_im),
            "C_re": _w(C_re),
            "C_im": _w(C_im),
            "log_dt": _w(log_dt),
            "Dskip": _w(Dskip),
        }
    _A_in = _A_setup()

    def _B_setup():
        B, S, D, F = 1, 2048, 1024, 3584
        return {
            "x": _w((lambda *s: torch.randn(*s, dtype=torch.bfloat16) * 0.05)(B, S, D)),
            "w1": _w((lambda *s: torch.randn(*s, dtype=torch.bfloat16) * 0.8)(D, F) * (D ** -0.5)),
            "b1": _w((lambda *s: torch.randn(*s, dtype=torch.bfloat16) * 0.8)(F)),
            "w2": _w((lambda *s: torch.randn(*s, dtype=torch.bfloat16) * 0.1)(F, D) * (F ** -0.5)),
            "b2": _w((lambda *s: torch.randn(*s, dtype=torch.bfloat16) * 0.1)(D)),
        }
    _B_in = _B_setup()

    return {
        "A_x": _A_in["x"],
        "A_Lambda_re": _A_in["Lambda_re"],
        "A_Lambda_im": _A_in["Lambda_im"],
        "A_B_re": _A_in["B_re"],
        "A_B_im": _A_in["B_im"],
        "A_C_re": _A_in["C_re"],
        "A_C_im": _A_in["C_im"],
        "A_log_dt": _A_in["log_dt"],
        "A_Dskip": _A_in["Dskip"],
        "B_x": _B_in["x"],
        "B_w1": _B_in["w1"],
        "B_b1": _B_in["b1"],
        "B_w2": _B_in["w2"],
        "B_b2": _B_in["b2"],
    }

def reference(A_x, A_Lambda_re, A_Lambda_im, A_B_re, A_B_im, A_C_re, A_C_im, A_log_dt, A_Dskip, B_x, B_w1, B_b1, B_w2, B_b2):
    def _A_ref(x, Lambda_re, Lambda_im, B_re, B_im, C_re, C_im, log_dt, Dskip):
        Bsz, L, H = x.shape
        Lam = Lambda_re + 1j * Lambda_im
        Bmat = B_re + 1j * B_im
        Cmat = C_re + 1j * C_im
        dt = torch.exp(log_dt)
        Lam_bar = torch.exp(dt * Lam)
        B_bar = ((Lam_bar - 1.0) / Lam)[:, None] * Bmat
        Bu = torch.einsum("bld,pd->blp", x + 0j, B_bar)
        h = torch.zeros_like(Bu[:, 0, :])
        hs = []
        for t in range(L):
            h = Lam_bar[None, :] * h + Bu[:, t, :]
            hs.append(h)
        hseq = torch.stack(hs, 1)
        y = 2.0 * torch.einsum("blp,dp->bld", hseq, Cmat).real + x * Dskip[None, None, :]
        return y

    def _B_ref(x, w1, b1, w2, b2):
        y = _layernorm(x, axis=-1)
        h = _gelu(torch.einsum("bsd,df->bsf", y, w1) + b1)
        return torch.einsum("bsf,fd->bsd", h, w2) + b2

    x = A_x
    xn = _layernorm(x, axis=-1)
    s = _A_ref(xn, A_Lambda_re, A_Lambda_im, A_B_re, A_B_im, A_C_re, A_C_im, A_log_dt, A_Dskip)
    g = _silu(_B_ref(xn, B_w1, B_b1, B_w2, B_b2))
    return x + s * g
```

```asm
; @launch grid=(256,1,1) block=(512,1,1) lds=163840
.amdgcn_target "amdgcn-amd-amdhsa--gfx950"
.text
.globl recurrent_scan__ssm_conv_s5__mixer_channel_mlp__prompt_kernel
.p2align 8
.type recurrent_scan__ssm_conv_s5__mixer_channel_mlp__prompt_kernel,@function
recurrent_scan__ssm_conv_s5__mixer_channel_mlp__prompt_kernel:
K1_begin:
    s_cmp_ge_u32 s2, 256
    s_cbranch_scc1 K1_end
    s_load_dwordx2 s[4:5], s[0:1], 128
    s_load_dwordx4 s[28:31], s[0:1], 80
    s_load_dwordx4 s[36:39], s[0:1], 24
    s_load_dwordx4 s[32:35], s[0:1], 8
    s_load_dwordx2 s[40:41], s[0:1], 56
    s_load_dwordx4 s[80:83], s[0:1], 40
    s_load_dwordx2 s[84:85], s[0:1], 96
    s_load_dwordx2 s[6:7], s[0:1], 0
    s_load_dwordx2 s[96:97], s[0:1], 120
    v_lshrrev_b32 v2, 6, v0
    v_and_b32 v1, 63, v0
    v_readfirstlane_b32 s20, v2
    s_nop 1
    s_mov_b32 s90, s20
    s_and_b32 s3, s2, 7
    s_lshr_b32 s23, s2, 3
    s_lshr_b32 s21, s3, 2
    s_lshl_b32 s21, s21, 2
    s_lshr_b32 s24, s23, 3
    s_add_u32 s21, s21, s24
    s_and_b32 s22, s3, 3
    s_lshl_b32 s22, s22, 3
    s_and_b32 s24, s23, 7
    s_add_u32 s22, s22, s24
    s_cmp_lt_u32 s20, 4
    s_cbranch_scc1 K1_compute
    s_sub_u32 s20, s20, 4
    v_lshrrev_b32 v14, 5, v1
    v_lshlrev_b32 v14, 4, v14
    v_bfe_u32 v15, v1, 3, 1
    v_lshl_add_u32 v14, v15, 3, v14
    v_bfe_u32 v15, v1, 4, 1
    v_add_u32 v14, v14, v15
    s_lshl_b32 s24, s21, 8
    s_lshl_b32 s25, s20, 6
    s_add_u32 s26, s24, s25
    v_add_u32 v14, s26, v14
    v_lshlrev_b32 v14, 11, v14
    v_lshrrev_b32 v15, 4, v1
    v_and_b32 v16, 7, v1
    v_xor_b32 v15, v15, v16
    v_lshl_add_u32 v2, v15, 4, v14
    v_xor_b32 v14, 64, v2
    v_add_u32 v3, 64512, v14
    v_add_u32 v4, 2048, v2
    v_add_u32 v5, 2048, v3
    v_add_u32 v6, 6144, v4
    v_add_u32 v7, 6144, v5
    v_add_u32 v8, 2048, v6
    v_add_u32 v9, 2048, v7
    v_mul_u32_u24 v14, 4682, v1
    v_lshrrev_b32 v14, 16, v14
    v_mul_u32_u24 v16, 14, v14
    v_sub_u32 v16, v1, v16
    s_lshr_b32 s24, s20, 1
    s_lshl_b32 s24, s24, 4
    s_and_b32 s25, s20, 1
    s_lshl_b32 s25, s25, 2
    s_add_u32 s24, s24, s25
    v_add_u32 v14, s24, v14
    v_mul_u32_u24 v14, 7168, v14
    v_lshl_add_u32 v14, v16, 4, v14
    s_mul_i32 s24, s22, 224
    v_add_u32 v12, s24, v14
    v_add_u32 v13, 56448, v12
    s_and_b32 s24, s20, 1
    s_lshl_b32 s24, s24, 4
    s_lshl_b32 s25, s22, 5
    s_add_u32 s24, s24, s25
    v_lshrrev_b32 v14, 3, v1
    v_add_u32 v14, s24, v14
    v_lshlrev_b32 v14, 11, v14
    v_lshl_add_u32 v10, v15, 4, v14
    v_xor_b32 v14, 64, v10
    v_add_u32 v11, 15360, v14
    s_lshl_b32 s42, s20, 13
    s_lshl_b32 s43, s20, 11
    s_add_u32 s43, s43, 98304
    s_mul_i32 s44, s20, 1792
    s_add_u32 s44, s44, 122880
    s_bfm_b64 s[46:47], 56, 0
    s_waitcnt lgkmcnt(0)
    s_mov_b32 s8, s4
    s_mov_b32 s9, s5
    s_mov_b32 s10, 268435456
    s_mov_b32 s11, 131072
    s_mov_b32 s12, s28
    s_mov_b32 s13, s29
    s_mov_b32 s14, 7340032
    s_mov_b32 s15, 131072
    s_cmp_lt_u32 s20, 2
    s_cselect_b32 s16, s36, s38
    s_cselect_b32 s17, s37, s39
    s_mov_b32 s18, 2097152
    s_mov_b32 s19, 131072
    s_mov_b32 s48, s6
    s_mov_b32 s49, s7
    s_mov_b32 s50, 4194304
    s_mov_b32 s51, 131072
    v_and_b32 v14, 15, v1
    v_lshrrev_b32 v69, 4, v1
    s_lshl_b32 s24, s22, 6
    v_lshl_add_u32 v16, v14, 1, s24
    global_load_ushort v56, v16, s[32:33] offset:0
    global_load_ushort v58, v16, s[34:35] offset:0
    global_load_ushort v60, v16, s[40:41] offset:0
    global_load_ushort v57, v16, s[32:33] offset:32
    global_load_ushort v59, v16, s[34:35] offset:32
    global_load_ushort v61, v16, s[40:41] offset:32
    s_mul_i32 s24, s22, 224
    v_min_u32 v16, 27, v1
    v_lshl_add_u32 v16, v16, 3, s24
    global_load_dwordx2 v[74:75], v16, s[30:31]
    s_mov_b32 s56, 0xffff0000
    s_add_u32 m0, s44, 0
    s_mov_b32 s24, 0
    s_mov_b64 exec, s[46:47]
    buffer_load_dwordx4 v12, s[12:15], s24 offen offset:0 lds
    buffer_load_dwordx4 v13, s[12:15], s24 offen offset:896 lds
    s_mov_b64 exec, -1
    s_add_u32 m0, s42, 0
    s_mov_b32 s25, 0
    buffer_load_dwordx4 v2, s[48:51], s25 offen offset:0 lds
    buffer_load_dwordx4 v3, s[48:51], s25 offen offset:1024 lds
    buffer_load_dwordx4 v4, s[48:51], s25 offen offset:2048 lds
    buffer_load_dwordx4 v5, s[48:51], s25 offen offset:3072 lds
    s_add_u32 m0, s42, 4096
    s_mov_b32 s25, 0
    buffer_load_dwordx4 v6, s[48:51], s25 offen offset:0 lds
    buffer_load_dwordx4 v7, s[48:51], s25 offen offset:1024 lds
    buffer_load_dwordx4 v8, s[48:51], s25 offen offset:2048 lds
    buffer_load_dwordx4 v9, s[48:51], s25 offen offset:3072 lds
    s_add_u32 m0, s43, 0
    s_mov_b32 s25, 0
    buffer_load_dwordx4 v10, s[16:19], s25 offen offset:0 lds
    s_add_u32 m0, s43, 0
    s_mov_b32 s25, 0
    buffer_load_dwordx4 v11, s[16:19], s25 offen offset:1024 lds
    s_add_u32 m0, s44, 7168
    s_mov_b32 s24, 229376
    s_mov_b64 exec, s[46:47]
    buffer_load_dwordx4 v12, s[12:15], s24 offen offset:0 lds
    buffer_load_dwordx4 v13, s[12:15], s24 offen offset:896 lds
    s_mov_b64 exec, -1
    v_lshlrev_b32 v170, 4, v1
    v_mov_b32 v164, 0
    v_mov_b32 v165, 0
    v_mov_b32 v166, 0
    v_mov_b32 v167, 0
    s_bfm_b64 exec, 44, 0
    s_lshl_b32 s24, s20, 10
    s_add_u32 s24, s24, 159744
    v_add_u32 v14, s24, v170
    ds_write_b128 v14, v[164:167]
    s_mov_b64 exec, -1
    s_waitcnt vmcnt(14)
    v_lshlrev_b32 v56, 16, v56
    v_lshlrev_b32 v58, 16, v58
    v_lshlrev_b32 v60, 16, v60
    v_lshlrev_b32 v57, 16, v57
    v_lshlrev_b32 v59, 16, v59
    v_lshlrev_b32 v61, 16, v61
    v_mul_f32 v60, 0x3fb8aa3b, v60
    v_mul_f32 v61, 0x3fb8aa3b, v61
    v_exp_f32 v60, v60
    v_exp_f32 v61, v61
    v_mov_b32 v15, 0
    v_cvt_pk_bf16_f32 v14, v60, v61
    v_lshlrev_b32 v60, 16, v14
    v_and_b32 v61, s56, v14
    v_mul_f32 v62, v60, v56
    v_mul_f32 v64, v60, v58
    v_mul_f32 v62, 0x3fb8aa3b, v62
    v_mul_f32 v64, 0.15915494, v64
    v_mul_f32 v63, v61, v57
    v_mul_f32 v65, v61, v59
    v_mul_f32 v63, 0x3fb8aa3b, v63
    v_mul_f32 v65, 0.15915494, v65
    v_mov_b32 v68, 0x3f800000
    v_mul_f32 v14, v68, v62
    v_mul_f32 v15, v68, v63
    v_mul_f32 v16, v68, v64
    v_mul_f32 v17, v68, v65
    v_exp_f32 v14, v14
    v_exp_f32 v15, v15
    v_fract_f32 v16, v16
    v_fract_f32 v17, v17
    v_sin_f32 v20, v16
    v_cos_f32 v21, v16
    v_sin_f32 v22, v17
    v_cos_f32 v23, v17
    v_mul_f32 v20, v20, v14
    v_mul_f32 v21, v21, v14
    v_mul_f32 v22, v22, v15
    v_mul_f32 v23, v23, v15
    v_mov_b32 v68, 0x41000000
    v_mul_f32 v14, v68, v62
    v_mul_f32 v15, v68, v63
    v_mul_f32 v16, v68, v64
    v_mul_f32 v17, v68, v65
    v_exp_f32 v14, v14
    v_exp_f32 v15, v15
    v_fract_f32 v16, v16
    v_fract_f32 v17, v17
    v_sin_f32 v24, v16
    v_cos_f32 v25, v16
    v_sin_f32 v26, v17
    v_cos_f32 v27, v17
    v_mul_f32 v24, v24, v14
    v_mul_f32 v25, v25, v14
    v_mul_f32 v26, v26, v15
    v_mul_f32 v27, v27, v15
    v_mov_b32 v68, 0x41800000
    v_mul_f32 v14, v68, v62
    v_mul_f32 v15, v68, v63
    v_mul_f32 v16, v68, v64
    v_mul_f32 v17, v68, v65
    v_exp_f32 v14, v14
    v_exp_f32 v15, v15
    v_fract_f32 v16, v16
    v_fract_f32 v17, v17
    v_sin_f32 v48, v16
    v_cos_f32 v49, v16
    v_sin_f32 v50, v17
    v_cos_f32 v51, v17
    v_mul_f32 v48, v48, v14
    v_mul_f32 v49, v49, v14
    v_mul_f32 v50, v50, v15
    v_mul_f32 v51, v51, v15
    v_mov_b32 v68, 0x42800000
    v_mul_f32 v14, v68, v62
    v_mul_f32 v15, v68, v63
    v_mul_f32 v16, v68, v64
    v_mul_f32 v17, v68, v65
    v_exp_f32 v14, v14
    v_exp_f32 v15, v15
    v_fract_f32 v16, v16
    v_fract_f32 v17, v17
    v_sin_f32 v52, v16
    v_cos_f32 v53, v16
    v_sin_f32 v54, v17
    v_cos_f32 v55, v17
    v_mul_f32 v52, v52, v14
    v_mul_f32 v53, v53, v14
    v_mul_f32 v54, v54, v15
    v_mul_f32 v55, v55, v15
    v_add_f32 v14, -1.0, v21
    v_mul_f32 v15, v56, v56
    v_fmac_f32 v15, v58, v58
    v_rcp_f32 v15, v15
    v_mul_f32 v33, v14, v56
    v_fmac_f32 v33, v20, v58
    v_mul_f32 v32, v20, v56
    v_fma_f32 v32, -v14, v58, v32
    v_add_f32 v15, v15, v15
    v_mul_f32 v32, v32, v15
    v_mul_f32 v33, v33, v15
    v_add_f32 v14, -1.0, v23
    v_mul_f32 v15, v57, v57
    v_fmac_f32 v15, v59, v59
    v_rcp_f32 v15, v15
    v_mul_f32 v35, v14, v57
    v_fmac_f32 v35, v22, v59
    v_mul_f32 v34, v22, v57
    v_fma_f32 v34, -v14, v59, v34
    v_add_f32 v15, v15, v15
    v_mul_f32 v34, v34, v15
    v_mul_f32 v35, v35, v15
    v_lshlrev_b32 v66, 4, v69
    v_cvt_f32_u32 v68, v66
    v_mul_f32 v14, v68, v62
    v_mul_f32 v15, v68, v63
    v_mul_f32 v16, v68, v64
    v_mul_f32 v17, v68, v65
    v_exp_f32 v14, v14
    v_exp_f32 v15, v15
    v_fract_f32 v16, v16
    v_fract_f32 v17, v17
    v_sin_f32 v28, v16
    v_cos_f32 v29, v16
    v_sin_f32 v30, v17
    v_cos_f32 v31, v17
    v_mul_f32 v28, v28, v14
    v_mul_f32 v29, v29, v14
    v_mul_f32 v30, v30, v15
    v_mul_f32 v31, v31, v15
    s_lshl_b32 s57, s20, 6
    v_add_u32 v66, s57, v66
    v_cvt_f32_u32 v68, v66
    v_mul_f32 v14, v68, v62
    v_mul_f32 v15, v68, v63
    v_mul_f32 v16, v68, v64
    v_mul_f32 v17, v68, v65
    v_exp_f32 v14, v14
    v_exp_f32 v15, v15
    v_fract_f32 v16, v16
    v_fract_f32 v17, v17
    v_sin_f32 v36, v16
    v_cos_f32 v37, v16
    v_sin_f32 v38, v17
    v_cos_f32 v39, v17
    v_mul_f32 v36, v36, v14
    v_mul_f32 v37, v37, v14
    v_mul_f32 v38, v38, v15
    v_mul_f32 v39, v39, v15
    v_mul_f32 v14, v36, v32
    v_mul_f32 v36, v36, v33
    v_fmac_f32 v36, v37, v32
    v_fma_f32 v37, v37, v33, -v14
    v_mul_f32 v14, v38, v34
    v_mul_f32 v38, v38, v35
    v_fmac_f32 v38, v39, v34
    v_fma_f32 v39, v39, v35, -v14
    s_sub_u32 s57, s21, 1
    v_sub_u32 v66, s57, v69
    v_max_i32 v66, 0, v66
    v_lshlrev_b32 v66, 8, v66
    v_cvt_f32_u32 v68, v66
    v_mul_f32 v14, v68, v62
    v_mul_f32 v15, v68, v63
    v_mul_f32 v16, v68, v64
    v_mul_f32 v17, v68, v65
    v_exp_f32 v14, v14
    v_exp_f32 v15, v15
    v_fract_f32 v16, v16
    v_fract_f32 v17, v17
    v_sin_f32 v40, v16
    v_cos_f32 v41, v16
    v_sin_f32 v42, v17
    v_cos_f32 v43, v17
    v_mul_f32 v40, v40, v14
    v_mul_f32 v41, v41, v14
    v_mul_f32 v42, v42, v15
    v_mul_f32 v43, v43, v15
    s_sub_u32 s57, s21, 5
    v_sub_u32 v66, s57, v69
    v_max_i32 v66, 0, v66
    v_lshlrev_b32 v66, 8, v66
    v_cvt_f32_u32 v68, v66
    v_mul_f32 v14, v68, v62
    v_mul_f32 v15, v68, v63
    v_mul_f32 v16, v68, v64
    v_mul_f32 v17, v68, v65
    v_exp_f32 v14, v14
    v_exp_f32 v15, v15
    v_fract_f32 v16, v16
    v_fract_f32 v17, v17
    v_sin_f32 v44, v16
    v_cos_f32 v45, v16
    v_sin_f32 v46, v17
    v_cos_f32 v47, v17
    v_mul_f32 v44, v44, v14
    v_mul_f32 v45, v45, v14
    v_mul_f32 v46, v46, v15
    v_mul_f32 v47, v47, v15
    v_lshlrev_b32 v72, 16, v74
    v_and_b32 v73, s56, v74
    v_lshlrev_b32 v74, 16, v75
    v_and_b32 v75, s56, v75
    s_waitcnt lgkmcnt(0)
    s_waitcnt vmcnt(2)
    s_barrier
    s_add_u32 m0, s44, 14336
    s_mov_b32 s24, 458752
    s_mov_b64 exec, s[46:47]
    buffer_load_dwordx4 v12, s[12:15], s24 offen offset:0 lds
    buffer_load_dwordx4 v13, s[12:15], s24 offen offset:896 lds
    s_mov_b64 exec, -1
    s_add_u32 m0, s42, 32768
    s_mov_b32 s25, 128
    buffer_load_dwordx4 v2, s[48:51], s25 offen offset:0 lds
    buffer_load_dwordx4 v3, s[48:51], s25 offen offset:1024 lds
    buffer_load_dwordx4 v4, s[48:51], s25 offen offset:2048 lds
    buffer_load_dwordx4 v5, s[48:51], s25 offen offset:3072 lds
    s_add_u32 m0, s43, 8192
    s_mov_b32 s25, 128
    buffer_load_dwordx4 v10, s[16:19], s25 offen offset:0 lds
    s_add_u32 m0, s42, 36864
    s_mov_b32 s25, 128
    buffer_load_dwordx4 v6, s[48:51], s25 offen offset:0 lds
    buffer_load_dwordx4 v7, s[48:51], s25 offen offset:1024 lds
    buffer_load_dwordx4 v8, s[48:51], s25 offen offset:2048 lds
    buffer_load_dwordx4 v9, s[48:51], s25 offen offset:3072 lds
    s_add_u32 m0, s43, 8192
    s_mov_b32 s25, 128
    buffer_load_dwordx4 v11, s[16:19], s25 offen offset:1024 lds
    v_lshlrev_b32 v170, 4, v1
    s_lshl_b32 s27, s21, 8
    s_lshl_b32 s24, s22, 3
    s_add_u32 s27, s27, s24
    s_lshl_b32 s24, s20, 1
    s_add_u32 s27, s27, s24
    s_lshl_b32 s24, s27, 11
    buffer_load_dwordx4 v[76:79], v170, s[48:51], s24 offen offset:0
    buffer_load_dwordx4 v[80:83], v170, s[48:51], s24 offen offset:1024
    buffer_load_dwordx4 v[84:87], v170, s[48:51], s24 offen offset:2048
    buffer_load_dwordx4 v[88:91], v170, s[48:51], s24 offen offset:3072
    v_mov_b32 v160, -1
    v_mov_b32 v161, -1
    v_mov_b32 v162, -1
    v_mov_b32 v163, -1
    v_mov_b32 v164, 0
    v_mov_b32 v165, 0
    v_mov_b32 v166, 0
    v_mov_b32 v167, 0
    s_lshl_b32 s24, s22, 3
    s_add_u32 s24, s24, s21
    s_lshl_b32 s24, s24, 2
    s_add_u32 s24, s24, s20
    s_lshl_b32 s24, s24, 6
    s_add_u32 s24, s24, 48300032
    s_mov_b64 exec, 15
    buffer_store_dwordx4 v[160:163], v170, s[8:11], s24 offen sc1
    s_and_b32 s24, s2, 1
    s_lshl_b32 s24, s24, 5
    s_lshr_b32 s25, s2, 3
    s_add_u32 s24, s24, s25
    s_lshl_b32 s24, s24, 2
    s_bfe_u32 s25, s2, 0x20001
    s_add_u32 s24, s24, s25
    s_lshl_b32 s24, s24, 2
    s_add_u32 s24, s24, s20
    s_lshl_b32 s24, s24, 7
    s_add_u32 s24, s24, 49283072
    s_mov_b64 exec, 1
    buffer_store_dwordx4 v[164:167], v170, s[8:11], s24 offen sc1
    s_lshl_b32 s24, s21, 7
    s_add_u32 s24, s24, s22
    s_lshl_b32 s24, s24, 2
    s_add_u32 s24, s24, s20
    s_lshl_b32 s24, s24, 2
    s_add_u32 s24, s24, 48431104
    s_mov_b64 exec, 7
    v_lshlrev_b32 v14, 9, v1
    buffer_store_dword v164, v14, s[8:11], s24 offen sc1
    s_mov_b64 exec, -1
    v_lshrrev_b32 v14, 4, v1
    v_and_b32 v180, 15, v1
    s_mov_b32 s98, 0x3fff3fff
    s_mov_b32 s99, 0x3fff3fff
    s_lshl_b32 s24, s21, 7
    s_lshl_b32 s25, s20, 5
    s_add_u32 s24, s24, s25
    v_add_u32 v14, s24, v14
    v_mul_u32_u24 v14, 7168, v14
    v_lshl_add_u32 v14, v180, 4, v14
    s_mul_i32 s24, s22, 224
    v_add_u32 v168, s24, v14
    s_and_b32 s24, s20, 1
    s_lshl_b32 s24, s24, 4
    s_lshl_b32 s25, s22, 5
    s_add_u32 s24, s24, s25
    v_lshrrev_b32 v14, 3, v1
    v_add_u32 v14, s24, v14
    v_lshlrev_b32 v14, 11, v14
    v_and_b32 v15, 7, v1
    v_lshl_add_u32 v14, v15, 4, v14
    s_lshl_b32 s24, s21, 8
    v_add_u32 v169, s24, v14
    s_mov_b32 s56, 0xffff0000
    s_waitcnt vmcnt(19)
    s_barrier
    s_add_u32 m0, s44, 21504
    s_mov_b32 s24, 688128
    s_mov_b64 exec, s[46:47]
    buffer_load_dwordx4 v12, s[12:15], s24 offen offset:0 lds
    buffer_load_dwordx4 v13, s[12:15], s24 offen offset:896 lds
    s_mov_b64 exec, -1
    s_add_u32 m0, s44, 28672
    s_mov_b32 s24, 917504
    s_mov_b64 exec, s[46:47]
    buffer_load_dwordx4 v12, s[12:15], s24 offen offset:0 lds
    buffer_load_dwordx4 v13, s[12:15], s24 offen offset:896 lds
    s_mov_b64 exec, -1
    s_add_u32 m0, s42, 65536
    s_mov_b32 s25, 256
    buffer_load_dwordx4 v2, s[48:51], s25 offen offset:0 lds
    buffer_load_dwordx4 v3, s[48:51], s25 offen offset:1024 lds
    buffer_load_dwordx4 v4, s[48:51], s25 offen offset:2048 lds
    buffer_load_dwordx4 v5, s[48:51], s25 offen offset:3072 lds
    s_add_u32 m0, s43, 16384
    s_mov_b32 s25, 256
    buffer_load_dwordx4 v10, s[16:19], s25 offen offset:0 lds
    s_add_u32 m0, s43, 16384
    s_mov_b32 s25, 256
    buffer_load_dwordx4 v11, s[16:19], s25 offen offset:1024 lds
    s_waitcnt vmcnt(17)
    s_barrier
    s_waitcnt vmcnt(13)
    s_add_u32 m0, s42, 69632
    s_mov_b32 s25, 256
    buffer_load_dwordx4 v6, s[48:51], s25 offen offset:0 lds
    v_lshlrev_b32 v14, 16, v76
    v_and_b32 v15, s56, v76
    v_add_f32 v152, v14, v15
    v_mul_f32 v153, v14, v14
    v_fmac_f32 v153, v15, v15
    buffer_load_dwordx4 v7, s[48:51], s25 offen offset:1024 lds
    v_lshlrev_b32 v14, 16, v77
    v_and_b32 v15, s56, v77
    v_add_f32 v152, v152, v14
    v_fmac_f32 v153, v14, v14
    v_add_f32 v152, v152, v15
    buffer_load_dwordx4 v8, s[48:51], s25 offen offset:2048 lds
    v_fmac_f32 v153, v15, v15
    v_lshlrev_b32 v14, 16, v78
    v_and_b32 v15, s56, v78
    v_add_f32 v152, v152, v14
    v_fmac_f32 v153, v14, v14
    buffer_load_dwordx4 v9, s[48:51], s25 offen offset:3072 lds
    v_add_f32 v152, v152, v15
    v_fmac_f32 v153, v15, v15
    v_lshlrev_b32 v14, 16, v79
    v_and_b32 v15, s56, v79
    v_add_f32 v152, v152, v14
    s_add_u32 m0, s44, 0
    s_mov_b32 s24, 1146880
    s_mov_b64 exec, s[46:47]
    buffer_load_dwordx4 v12, s[12:15], s24 offen offset:0 lds
    buffer_load_dwordx4 v13, s[12:15], s24 offen offset:896 lds
    s_mov_b64 exec, -1
    v_fmac_f32 v153, v14, v14
    v_add_f32 v152, v152, v15
    v_fmac_f32 v153, v15, v15
    v_lshlrev_b32 v14, 16, v80
    v_and_b32 v15, s56, v80
    s_add_u32 m0, s44, 7168
    s_mov_b32 s24, 1376256
    s_mov_b64 exec, s[46:47]
    buffer_load_dwordx4 v12, s[12:15], s24 offen offset:0 lds
    buffer_load_dwordx4 v13, s[12:15], s24 offen offset:896 lds
    s_mov_b64 exec, -1
    v_add_f32 v152, v152, v14
    v_fmac_f32 v153, v14, v14
    v_add_f32 v152, v152, v15
    v_fmac_f32 v153, v15, v15
    v_lshlrev_b32 v14, 16, v81
    s_add_u32 m0, s43, 0
    s_mov_b32 s25, 384
    buffer_load_dwordx4 v10, s[16:19], s25 offen offset:0 lds
    v_and_b32 v15, s56, v81
    v_add_f32 v152, v152, v14
    v_fmac_f32 v153, v14, v14
    v_add_f32 v152, v152, v15
    s_add_u32 m0, s43, 0
    s_mov_b32 s25, 384
    buffer_load_dwordx4 v11, s[16:19], s25 offen offset:1024 lds
    s_waitcnt vmcnt(18)
    s_barrier
    s_add_u32 m0, s42, 0
    s_mov_b32 s25, 384
    buffer_load_dwordx4 v2, s[48:51], s25 offen offset:0 lds
    v_fmac_f32 v153, v15, v15
    v_lshlrev_b32 v14, 16, v82
    v_and_b32 v15, s56, v82
    v_add_f32 v152, v152, v14
    buffer_load_dwordx4 v3, s[48:51], s25 offen offset:1024 lds
    v_fmac_f32 v153, v14, v14
    v_add_f32 v152, v152, v15
    v_fmac_f32 v153, v15, v15
    v_lshlrev_b32 v14, 16, v83
    buffer_load_dwordx4 v4, s[48:51], s25 offen offset:2048 lds
    v_and_b32 v15, s56, v83
    v_add_f32 v152, v152, v14
    v_fmac_f32 v153, v14, v14
    v_add_f32 v152, v152, v15
    buffer_load_dwordx4 v5, s[48:51], s25 offen offset:3072 lds
    v_fmac_f32 v153, v15, v15
    v_lshlrev_b32 v14, 16, v84
    v_and_b32 v15, s56, v84
    v_add_f32 v154, v14, v15
    s_add_u32 m0, s42, 4096
    s_mov_b32 s25, 384
    buffer_load_dwordx4 v6, s[48:51], s25 offen offset:0 lds
    v_mul_f32 v155, v14, v14
    v_fmac_f32 v155, v15, v15
    v_lshlrev_b32 v14, 16, v85
    v_and_b32 v15, s56, v85
    buffer_load_dwordx4 v7, s[48:51], s25 offen offset:1024 lds
    v_add_f32 v154, v154, v14
    v_fmac_f32 v155, v14, v14
    v_add_f32 v154, v154, v15
    v_fmac_f32 v155, v15, v15
    buffer_load_dwordx4 v8, s[48:51], s25 offen offset:2048 lds
    v_lshlrev_b32 v14, 16, v86
    v_and_b32 v15, s56, v86
    v_add_f32 v154, v154, v14
    v_fmac_f32 v155, v14, v14
    buffer_load_dwordx4 v9, s[48:51], s25 offen offset:3072 lds
    v_add_f32 v154, v154, v15
    v_fmac_f32 v155, v15, v15
    v_lshlrev_b32 v14, 16, v87
    v_and_b32 v15, s56, v87
    s_add_u32 m0, s44, 14336
    s_mov_b32 s24, 1605632
    s_mov_b64 exec, s[46:47]
    buffer_load_dwordx4 v12, s[12:15], s24 offen offset:0 lds
    buffer_load_dwordx4 v13, s[12:15], s24 offen offset:896 lds
    s_mov_b64 exec, -1
    v_add_f32 v154, v154, v14
    v_fmac_f32 v155, v14, v14
    s_waitcnt vmcnt(16)
    s_barrier
    s_add_u32 m0, s44, 21504
    s_mov_b32 s24, 1835008
    s_mov_b64 exec, s[46:47]
    buffer_load_dwordx4 v12, s[12:15], s24 offen offset:0 lds
    buffer_load_dwordx4 v13, s[12:15], s24 offen offset:896 lds
    s_mov_b64 exec, -1
    v_add_f32 v154, v154, v15
    v_fmac_f32 v155, v15, v15
    v_lshlrev_b32 v14, 16, v88
    v_and_b32 v15, s56, v88
    v_add_f32 v154, v154, v14
    s_add_u32 m0, s42, 32768
    s_mov_b32 s25, 512
    buffer_load_dwordx4 v2, s[48:51], s25 offen offset:0 lds
    v_fmac_f32 v155, v14, v14
    v_add_f32 v154, v154, v15
    v_fmac_f32 v155, v15, v15
    v_lshlrev_b32 v14, 16, v89
    v_and_b32 v15, s56, v89
    buffer_load_dwordx4 v3, s[48:51], s25 offen offset:1024 lds
    v_add_f32 v154, v154, v14
    v_fmac_f32 v155, v14, v14
    v_add_f32 v154, v154, v15
    v_fmac_f32 v155, v15, v15
    v_lshlrev_b32 v14, 16, v90
    buffer_load_dwordx4 v4, s[48:51], s25 offen offset:2048 lds
    v_and_b32 v15, s56, v90
    v_add_f32 v154, v154, v14
    v_fmac_f32 v155, v14, v14
    v_add_f32 v154, v154, v15
    v_fmac_f32 v155, v15, v15
    buffer_load_dwordx4 v5, s[48:51], s25 offen offset:3072 lds
    v_lshlrev_b32 v14, 16, v91
    v_and_b32 v15, s56, v91
    v_add_f32 v154, v154, v14
    v_fmac_f32 v155, v14, v14
    v_add_f32 v154, v154, v15
    s_add_u32 m0, s43, 8192
    s_mov_b32 s25, 512
    buffer_load_dwordx4 v10, s[16:19], s25 offen offset:0 lds
    v_fmac_f32 v155, v15, v15
    v_add_f32_dpp v152, v152, v152 row_ror:8 row_mask:0xf bank_mask:0xf
    v_add_f32_dpp v153, v153, v153 row_ror:8 row_mask:0xf bank_mask:0xf
    v_add_f32_dpp v154, v154, v154 row_ror:8 row_mask:0xf bank_mask:0xf
    v_add_f32_dpp v155, v155, v155 row_ror:8 row_mask:0xf bank_mask:0xf
    s_add_u32 m0, s43, 8192
    s_mov_b32 s25, 512
    buffer_load_dwordx4 v11, s[16:19], s25 offen offset:1024 lds
    v_add_f32_dpp v152, v152, v152 row_ror:4 row_mask:0xf bank_mask:0xf
    v_add_f32_dpp v153, v153, v153 row_ror:4 row_mask:0xf bank_mask:0xf
    v_add_f32_dpp v154, v154, v154 row_ror:4 row_mask:0xf bank_mask:0xf
    v_add_f32_dpp v155, v155, v155 row_ror:4 row_mask:0xf bank_mask:0xf
    s_mov_b32 s24, 0
    s_mov_b64 exec, s[98:99]
    buffer_load_dwordx4 v[92:95], v168, s[12:15], s24 offen
    s_mov_b64 exec, -1
    s_mov_b32 s24, 28672
    s_mov_b64 exec, s[98:99]
    buffer_load_dwordx4 v[96:99], v168, s[12:15], s24 offen
    s_mov_b64 exec, -1
    s_waitcnt vmcnt(24)
    s_barrier
    s_add_u32 m0, s42, 36864
    s_mov_b32 s25, 512
    buffer_load_dwordx4 v6, s[48:51], s25 offen offset:0 lds
    v_add_f32_dpp v152, v152, v152 row_ror:2 row_mask:0xf bank_mask:0xf
    v_add_f32_dpp v153, v153, v153 row_ror:2 row_mask:0xf bank_mask:0xf
    v_add_f32_dpp v154, v154, v154 row_ror:2 row_mask:0xf bank_mask:0xf
    v_add_f32_dpp v155, v155, v155 row_ror:2 row_mask:0xf bank_mask:0xf
    v_add_f32_dpp v152, v152, v152 row_ror:1 row_mask:0xf bank_mask:0xf
    v_add_f32_dpp v153, v153, v153 row_ror:1 row_mask:0xf bank_mask:0xf
    v_add_f32_dpp v154, v154, v154 row_ror:1 row_mask:0xf bank_mask:0xf
    buffer_load_dwordx4 v7, s[48:51], s25 offen offset:1024 lds
    v_add_f32_dpp v155, v155, v155 row_ror:1 row_mask:0xf bank_mask:0xf
    v_mov_b32 v156, v152
    v_mov_b32 v157, v153
    v_mov_b32 v158, v154
    v_mov_b32 v159, v155
    v_permlane16_swap_b32 v152, v156
    v_permlane16_swap_b32 v153, v157
    buffer_load_dwordx4 v8, s[48:51], s25 offen offset:2048 lds
    v_permlane16_swap_b32 v154, v158
    v_permlane16_swap_b32 v155, v159
    v_add_f32 v152, v152, v156
    v_add_f32 v153, v153, v157
    v_add_f32 v154, v154, v158
    v_add_f32 v155, v155, v159
    v_mov_b32 v156, v152
    buffer_load_dwordx4 v9, s[48:51], s25 offen offset:3072 lds
    v_mov_b32 v157, v153
    v_mov_b32 v158, v154
    v_mov_b32 v159, v155
    v_permlane32_swap_b32 v152, v156
    v_permlane32_swap_b32 v153, v157
    v_permlane32_swap_b32 v154, v158
    v_permlane32_swap_b32 v155, v159
    s_add_u32 m0, s44, 28672
    s_mov_b32 s24, 2064384
    s_mov_b64 exec, s[46:47]
    buffer_load_dwordx4 v12, s[12:15], s24 offen offset:0 lds
    buffer_load_dwordx4 v13, s[12:15], s24 offen offset:896 lds
    s_mov_b64 exec, -1
    v_add_f32 v152, v152, v156
    v_add_f32 v153, v153, v157
    v_add_f32 v154, v154, v158
    v_add_f32 v155, v155, v159
    v_mul_f32 v160, 0x3a800000, v152
    v_mul_f32 v153, 0x3a800000, v153
    s_mov_b32 s24, 57344
    s_mov_b64 exec, s[98:99]
    buffer_load_dwordx4 v[100:103], v168, s[12:15], s24 offen
    s_mov_b64 exec, -1
    s_mov_b32 s24, 86016
    s_mov_b64 exec, s[98:99]
    buffer_load_dwordx4 v[104:107], v168, s[12:15], s24 offen
    s_mov_b64 exec, -1
    s_waitcnt vmcnt(20)
    s_barrier
    s_add_u32 m0, s44, 0
    s_mov_b32 s24, 2293760
    s_mov_b64 exec, s[46:47]
    buffer_load_dwordx4 v12, s[12:15], s24 offen offset:0 lds
    buffer_load_dwordx4 v13, s[12:15], s24 offen offset:896 lds
    s_mov_b64 exec, -1
    v_fma_f32 v153, -v160, v160, v153
    v_max_f32 v153, 0, v153
    v_add_f32 v152, 0x3727c5ac, v153
    s_add_u32 m0, s42, 65536
    s_mov_b32 s25, 640
    buffer_load_dwordx4 v2, s[48:51], s25 offen offset:0 lds
    v_rsq_f32 v161, v152
    v_mov_b32 v163, 0
    v_mul_f32 v152, v161, v161
    buffer_load_dwordx4 v3, s[48:51], s25 offen offset:1024 lds
    v_mul_f32 v152, v152, v153
    v_add_f32 v152, 0x3727c5ac, v152
    v_rsq_f32 v162, v152
    buffer_load_dwordx4 v4, s[48:51], s25 offen offset:2048 lds
    v_mul_f32 v164, 0x3a800000, v154
    v_mul_f32 v155, 0x3a800000, v155
    v_fma_f32 v155, -v164, v164, v155
    buffer_load_dwordx4 v5, s[48:51], s25 offen offset:3072 lds
    v_max_f32 v155, 0, v155
    v_add_f32 v154, 0x3727c5ac, v155
    v_rsq_f32 v165, v154
    s_add_u32 m0, s43, 16384
    s_mov_b32 s25, 640
    buffer_load_dwordx4 v10, s[16:19], s25 offen offset:0 lds
    v_mov_b32 v167, 0
    v_mul_f32 v154, v165, v165
    v_mul_f32 v154, v154, v155
    s_add_u32 m0, s43, 16384
    s_mov_b32 s25, 640
    buffer_load_dwordx4 v11, s[16:19], s25 offen offset:1024 lds
    v_add_f32 v154, 0x3727c5ac, v154
    v_rsq_f32 v166, v154
    s_mov_b32 s24, 114688
    s_mov_b64 exec, s[98:99]
    buffer_load_dwordx4 v[108:111], v168, s[12:15], s24 offen
    s_mov_b64 exec, -1
    s_mov_b32 s24, 143360
    s_mov_b64 exec, s[98:99]
    buffer_load_dwordx4 v[112:115], v168, s[12:15], s24 offen
    s_mov_b64 exec, -1
    s_waitcnt vmcnt(28)
    s_barrier
    s_waitcnt vmcnt(18)
    s_add_u32 m0, s42, 69632
    s_mov_b32 s25, 640
    buffer_load_dwordx4 v6, s[48:51], s25 offen offset:0 lds
    v_lshlrev_b32 v140, 16, v92
    v_and_b32 v141, s56, v92
    v_lshlrev_b32 v142, 16, v93
    v_and_b32 v143, s56, v93
    v_lshlrev_b32 v144, 16, v94
    buffer_load_dwordx4 v7, s[48:51], s25 offen offset:1024 lds
    v_and_b32 v145, s56, v94
    v_lshlrev_b32 v146, 16, v95
    v_and_b32 v147, s56, v95
    v_lshlrev_b32 v14, 16, v96
    v_and_b32 v15, s56, v96
    buffer_load_dwordx4 v8, s[48:51], s25 offen offset:2048 lds
    v_add_f32 v140, v140, v14
    v_add_f32 v141, v141, v15
    v_lshlrev_b32 v14, 16, v97
    v_and_b32 v15, s56, v97
    v_add_f32 v142, v142, v14
    buffer_load_dwordx4 v9, s[48:51], s25 offen offset:3072 lds
    v_add_f32 v143, v143, v15
    v_lshlrev_b32 v14, 16, v98
    v_and_b32 v15, s56, v98
    v_add_f32 v144, v144, v14
    v_add_f32 v145, v145, v15
    s_add_u32 m0, s44, 7168
    s_mov_b32 s24, 2523136
    s_mov_b64 exec, s[46:47]
    buffer_load_dwordx4 v12, s[12:15], s24 offen offset:0 lds
    buffer_load_dwordx4 v13, s[12:15], s24 offen offset:896 lds
    s_mov_b64 exec, -1
    v_lshlrev_b32 v14, 16, v99
    v_and_b32 v15, s56, v99
    v_add_f32 v146, v146, v14
    v_add_f32 v147, v147, v15
    s_mov_b32 s24, 172032
    s_mov_b64 exec, s[98:99]
    buffer_load_dwordx4 v[116:119], v168, s[12:15], s24 offen
    s_mov_b64 exec, -1
    s_mov_b32 s24, 200704
    s_mov_b64 exec, s[98:99]
    buffer_load_dwordx4 v[120:123], v168, s[12:15], s24 offen
    s_mov_b64 exec, -1
    s_lshl_b32 s24, s27, 4
    s_add_u32 s24, s24, 48234496
    s_mov_b64 exec, 1
    buffer_store_dwordx4 v[160:163], v170, s[8:11], s24 offen sc1
    buffer_store_dwordx4 v[164:167], v170, s[8:11], s24 offen offset:16 sc1
    s_mov_b64 exec, -1
    s_waitcnt vmcnt(24)
    s_barrier
    s_waitcnt vmcnt(20)
    s_add_u32 m0, s44, 14336
    s_mov_b32 s24, 2752512
    s_mov_b64 exec, s[46:47]
    buffer_load_dwordx4 v12, s[12:15], s24 offen offset:0 lds
    buffer_load_dwordx4 v13, s[12:15], s24 offen offset:896 lds
    s_mov_b64 exec, -1
    v_lshlrev_b32 v14, 16, v100
    v_and_b32 v15, s56, v100
    v_add_f32 v140, v140, v14
    v_add_f32 v141, v141, v15
    v_lshlrev_b32 v14, 16, v101
    s_add_u32 m0, s42, 0
    s_mov_b32 s25, 768
    buffer_load_dwordx4 v2, s[48:51], s25 offen offset:0 lds
    v_and_b32 v15, s56, v101
    v_add_f32 v142, v142, v14
    v_add_f32 v143, v143, v15
    v_lshlrev_b32 v14, 16, v102
    v_and_b32 v15, s56, v102
    buffer_load_dwordx4 v3, s[48:51], s25 offen offset:1024 lds
    v_add_f32 v144, v144, v14
    v_add_f32 v145, v145, v15
    v_lshlrev_b32 v14, 16, v103
    v_and_b32 v15, s56, v103
    v_add_f32 v146, v146, v14
    buffer_load_dwordx4 v4, s[48:51], s25 offen offset:2048 lds
    v_add_f32 v147, v147, v15
    v_lshlrev_b32 v14, 16, v104
    v_and_b32 v15, s56, v104
    v_add_f32 v140, v140, v14
    v_add_f32 v141, v141, v15
    buffer_load_dwordx4 v5, s[48:51], s25 offen offset:3072 lds
    v_lshlrev_b32 v14, 16, v105
    v_and_b32 v15, s56, v105
    v_add_f32 v142, v142, v14
    v_add_f32 v143, v143, v15
    v_lshlrev_b32 v14, 16, v106
    s_add_u32 m0, s43, 0
    s_mov_b32 s25, 768
    buffer_load_dwordx4 v10, s[16:19], s25 offen offset:0 lds
    v_and_b32 v15, s56, v106
    v_add_f32 v144, v144, v14
    v_add_f32 v145, v145, v15
    v_lshlrev_b32 v14, 16, v107
    v_and_b32 v15, s56, v107
    s_add_u32 m0, s43, 0
    s_mov_b32 s25, 768
    buffer_load_dwordx4 v11, s[16:19], s25 offen offset:1024 lds
    v_add_f32 v146, v146, v14
    v_add_f32 v147, v147, v15
    s_barrier
    s_waitcnt vmcnt(18)
    s_add_u32 m0, s42, 4096
    s_mov_b32 s25, 768
    buffer_load_dwordx4 v6, s[48:51], s25 offen offset:0 lds
    v_lshlrev_b32 v14, 16, v108
    v_and_b32 v15, s56, v108
    v_add_f32 v140, v140, v14
    v_add_f32 v141, v141, v15
    v_lshlrev_b32 v14, 16, v109
    v_and_b32 v15, s56, v109
    v_add_f32 v142, v142, v14
    buffer_load_dwordx4 v7, s[48:51], s25 offen offset:1024 lds
    v_add_f32 v143, v143, v15
    v_lshlrev_b32 v14, 16, v110
    v_and_b32 v15, s56, v110
    v_add_f32 v144, v144, v14
    v_add_f32 v145, v145, v15
    v_lshlrev_b32 v14, 16, v111
    v_and_b32 v15, s56, v111
    buffer_load_dwordx4 v8, s[48:51], s25 offen offset:2048 lds
    v_add_f32 v146, v146, v14
    v_add_f32 v147, v147, v15
    v_lshlrev_b32 v14, 16, v112
    v_and_b32 v15, s56, v112
    v_add_f32 v140, v140, v14
    v_add_f32 v141, v141, v15
    v_lshlrev_b32 v14, 16, v113
    buffer_load_dwordx4 v9, s[48:51], s25 offen offset:3072 lds
    v_and_b32 v15, s56, v113
    v_add_f32 v142, v142, v14
    v_add_f32 v143, v143, v15
    v_lshlrev_b32 v14, 16, v114
    v_and_b32 v15, s56, v114
    v_add_f32 v144, v144, v14
    v_add_f32 v145, v145, v15
    s_add_u32 m0, s44, 21504
    s_mov_b32 s24, 2981888
    s_mov_b64 exec, s[46:47]
    buffer_load_dwordx4 v12, s[12:15], s24 offen offset:0 lds
    buffer_load_dwordx4 v13, s[12:15], s24 offen offset:896 lds
    s_mov_b64 exec, -1
    v_lshlrev_b32 v14, 16, v115
    v_and_b32 v15, s56, v115
    v_add_f32 v146, v146, v14
    v_add_f32 v147, v147, v15
    s_mov_b32 s24, 0
    buffer_load_dwordx4 v[124:127], v169, s[16:19], s24 offen offset:0
    s_mov_b32 s24, 0
    buffer_load_dwordx4 v[128:131], v169, s[16:19], s24 offen offset:128
    s_waitcnt vmcnt(22)
    s_barrier
    s_waitcnt vmcnt(18)
    s_add_u32 m0, s44, 28672
    s_mov_b32 s24, 3211264
    s_mov_b64 exec, s[46:47]
    buffer_load_dwordx4 v12, s[12:15], s24 offen offset:0 lds
    buffer_load_dwordx4 v13, s[12:15], s24 offen offset:896 lds
    s_mov_b64 exec, -1
    v_lshlrev_b32 v14, 16, v116
    v_and_b32 v15, s56, v116
    v_add_f32 v140, v140, v14
    v_add_f32 v141, v141, v15
    v_lshlrev_b32 v14, 16, v117
    s_add_u32 m0, s42, 32768
    s_mov_b32 s25, 896
    buffer_load_dwordx4 v2, s[48:51], s25 offen offset:0 lds
    v_and_b32 v15, s56, v117
    v_add_f32 v142, v142, v14
    v_add_f32 v143, v143, v15
    v_lshlrev_b32 v14, 16, v118
    v_and_b32 v15, s56, v118
    buffer_load_dwordx4 v3, s[48:51], s25 offen offset:1024 lds
    v_add_f32 v144, v144, v14
    v_add_f32 v145, v145, v15
    v_lshlrev_b32 v14, 16, v119
    v_and_b32 v15, s56, v119
    v_add_f32 v146, v146, v14
    buffer_load_dwordx4 v4, s[48:51], s25 offen offset:2048 lds
    v_add_f32 v147, v147, v15
    v_lshlrev_b32 v14, 16, v120
    v_and_b32 v15, s56, v120
    v_add_f32 v140, v140, v14
    v_add_f32 v141, v141, v15
    buffer_load_dwordx4 v5, s[48:51], s25 offen offset:3072 lds
    v_lshlrev_b32 v14, 16, v121
    v_and_b32 v15, s56, v121
    v_add_f32 v142, v142, v14
    v_add_f32 v143, v143, v15
    v_lshlrev_b32 v14, 16, v122
    s_add_u32 m0, s43, 8192
    s_mov_b32 s25, 896
    buffer_load_dwordx4 v10, s[16:19], s25 offen offset:0 lds
    v_and_b32 v15, s56, v122
    v_add_f32 v144, v144, v14
    v_add_f32 v145, v145, v15
    v_lshlrev_b32 v14, 16, v123
    v_and_b32 v15, s56, v123
    s_add_u32 m0, s43, 8192
    s_mov_b32 s25, 896
    buffer_load_dwordx4 v11, s[16:19], s25 offen offset:1024 lds
    v_add_f32 v146, v146, v14
    v_add_f32 v147, v147, v15
    s_mov_b32 s24, 16384
    buffer_load_dwordx4 v[132:135], v169, s[16:19], s24 offen offset:0
    s_mov_b32 s24, 16384
    buffer_load_dwordx4 v[136:139], v169, s[16:19], s24 offen offset:128
    s_barrier
    s_add_u32 m0, s42, 36864
    s_mov_b32 s25, 896
    buffer_load_dwordx4 v6, s[48:51], s25 offen offset:0 lds
    v_mov_b32 v92, v140
    v_mov_b32 v93, v141
    v_mov_b32 v94, v142
    v_mov_b32 v95, v143
    v_mov_b32 v96, v144
    buffer_load_dwordx4 v7, s[48:51], s25 offen offset:1024 lds
    v_mov_b32 v97, v145
    v_mov_b32 v98, v146
    v_mov_b32 v99, v147
    v_permlane16_swap_b32 v140, v92
    v_permlane16_swap_b32 v141, v93
    buffer_load_dwordx4 v8, s[48:51], s25 offen offset:2048 lds
    v_permlane16_swap_b32 v142, v94
    v_permlane16_swap_b32 v143, v95
    v_permlane16_swap_b32 v144, v96
    v_permlane16_swap_b32 v145, v97
    v_permlane16_swap_b32 v146, v98
    buffer_load_dwordx4 v9, s[48:51], s25 offen offset:3072 lds
    v_permlane16_swap_b32 v147, v99
    v_add_f32 v140, v140, v92
    v_add_f32 v141, v141, v93
    v_add_f32 v142, v142, v94
    v_add_f32 v143, v143, v95
    s_add_u32 m0, s44, 0
    s_mov_b32 s24, 3440640
    s_mov_b64 exec, s[46:47]
    buffer_load_dwordx4 v12, s[12:15], s24 offen offset:0 lds
    buffer_load_dwordx4 v13, s[12:15], s24 offen offset:896 lds
    s_mov_b64 exec, -1
    v_add_f32 v144, v144, v96
    v_add_f32 v145, v145, v97
    v_add_f32 v146, v146, v98
    v_add_f32 v147, v147, v99
    s_waitcnt vmcnt(20)
    s_barrier
    s_add_u32 m0, s44, 7168
    s_mov_b32 s24, 3670016
    s_mov_b64 exec, s[46:47]
    buffer_load_dwordx4 v12, s[12:15], s24 offen offset:0 lds
    buffer_load_dwordx4 v13, s[12:15], s24 offen offset:896 lds
    s_mov_b64 exec, -1
    v_mov_b32 v92, v140
    v_mov_b32 v93, v141
    v_mov_b32 v94, v142
    v_mov_b32 v95, v143
    s_add_u32 m0, s42, 65536
    s_mov_b32 s25, 1024
    buffer_load_dwordx4 v2, s[48:51], s25 offen offset:0 lds
    v_mov_b32 v96, v144
    v_mov_b32 v97, v145
    v_mov_b32 v98, v146
    v_mov_b32 v99, v147
    buffer_load_dwordx4 v3, s[48:51], s25 offen offset:1024 lds
    v_permlane32_swap_b32 v140, v92
    v_permlane32_swap_b32 v141, v93
    v_permlane32_swap_b32 v142, v94
    v_permlane32_swap_b32 v143, v95
    buffer_load_dwordx4 v4, s[48:51], s25 offen offset:2048 lds
    v_permlane32_swap_b32 v144, v96
    v_permlane32_swap_b32 v145, v97
    v_permlane32_swap_b32 v146, v98
    v_permlane32_swap_b32 v147, v99
    buffer_load_dwordx4 v5, s[48:51], s25 offen offset:3072 lds
    v_add_f32 v140, v140, v92
    v_add_f32 v141, v141, v93
    v_add_f32 v142, v142, v94
    v_add_f32 v143, v143, v95
    s_add_u32 m0, s43, 16384
    s_mov_b32 s25, 1024
    buffer_load_dwordx4 v10, s[16:19], s25 offen offset:0 lds
    v_add_f32 v144, v144, v96
    v_add_f32 v145, v145, v97
    v_add_f32 v146, v146, v98
    v_add_f32 v147, v147, v99
    s_add_u32 m0, s43, 16384
    s_mov_b32 s25, 1024
    buffer_load_dwordx4 v11, s[16:19], s25 offen offset:1024 lds
    s_waitcnt vmcnt(26)
    s_barrier
    s_waitcnt vmcnt(14)
    s_add_u32 m0, s42, 69632
    s_mov_b32 s25, 1024
    buffer_load_dwordx4 v6, s[48:51], s25 offen offset:0 lds
    v_mov_b32 v148, 0
    v_lshlrev_b32 v14, 16, v124
    v_and_b32 v15, s56, v124
    v_add_f32 v148, v148, v14
    v_add_f32 v148, v148, v15
    v_lshlrev_b32 v14, 16, v125
    v_and_b32 v15, s56, v125
    buffer_load_dwordx4 v7, s[48:51], s25 offen offset:1024 lds
    v_add_f32 v148, v148, v14
    v_add_f32 v148, v148, v15
    v_lshlrev_b32 v14, 16, v126
    v_and_b32 v15, s56, v126
    v_add_f32 v148, v148, v14
    v_add_f32 v148, v148, v15
    v_lshlrev_b32 v14, 16, v127
    buffer_load_dwordx4 v8, s[48:51], s25 offen offset:2048 lds
    v_and_b32 v15, s56, v127
    v_add_f32 v148, v148, v14
    v_add_f32 v148, v148, v15
    v_lshlrev_b32 v14, 16, v128
    v_and_b32 v15, s56, v128
    v_add_f32 v148, v148, v14
    v_add_f32 v148, v148, v15
    buffer_load_dwordx4 v9, s[48:51], s25 offen offset:3072 lds
    v_lshlrev_b32 v14, 16, v129
    v_and_b32 v15, s56, v129
    v_add_f32 v148, v148, v14
    v_add_f32 v148, v148, v15
    v_lshlrev_b32 v14, 16, v130
    v_and_b32 v15, s56, v130
    v_add_f32 v148, v148, v14
    s_add_u32 m0, s44, 14336
    s_mov_b32 s24, 3899392
    s_mov_b64 exec, s[46:47]
    buffer_load_dwordx4 v12, s[12:15], s24 offen offset:0 lds
    buffer_load_dwordx4 v13, s[12:15], s24 offen offset:896 lds
    s_mov_b64 exec, -1
    v_add_f32 v148, v148, v15
    v_lshlrev_b32 v14, 16, v131
    v_and_b32 v15, s56, v131
    v_add_f32 v148, v148, v14
    v_add_f32 v148, v148, v15
    v_mov_b32 v149, 0
    s_waitcnt vmcnt(16)
    s_barrier
    s_add_u32 m0, s44, 21504
    s_mov_b32 s24, 4128768
    s_mov_b64 exec, s[46:47]
    buffer_load_dwordx4 v12, s[12:15], s24 offen offset:0 lds
    buffer_load_dwordx4 v13, s[12:15], s24 offen offset:896 lds
    s_mov_b64 exec, -1
    v_lshlrev_b32 v14, 16, v132
    v_and_b32 v15, s56, v132
    v_add_f32 v149, v149, v14
    v_add_f32 v149, v149, v15
    v_lshlrev_b32 v14, 16, v133
    s_add_u32 m0, s42, 0
    s_mov_b32 s25, 1152
    buffer_load_dwordx4 v2, s[48:51], s25 offen offset:0 lds
    v_and_b32 v15, s56, v133
    v_add_f32 v149, v149, v14
    v_add_f32 v149, v149, v15
    v_lshlrev_b32 v14, 16, v134
    v_and_b32 v15, s56, v134
    buffer_load_dwordx4 v3, s[48:51], s25 offen offset:1024 lds
    v_add_f32 v149, v149, v14
    v_add_f32 v149, v149, v15
    v_lshlrev_b32 v14, 16, v135
    v_and_b32 v15, s56, v135
    v_add_f32 v149, v149, v14
    buffer_load_dwordx4 v4, s[48:51], s25 offen offset:2048 lds
    v_add_f32 v149, v149, v15
    v_lshlrev_b32 v14, 16, v136
    v_and_b32 v15, s56, v136
    v_add_f32 v149, v149, v14
    v_add_f32 v149, v149, v15
    buffer_load_dwordx4 v5, s[48:51], s25 offen offset:3072 lds
    v_lshlrev_b32 v14, 16, v137
    v_and_b32 v15, s56, v137
    v_add_f32 v149, v149, v14
    v_add_f32 v149, v149, v15
    v_lshlrev_b32 v14, 16, v138
    s_add_u32 m0, s43, 0
    s_mov_b32 s25, 1152
    buffer_load_dwordx4 v10, s[16:19], s25 offen offset:0 lds
    v_and_b32 v15, s56, v138
    v_add_f32 v149, v149, v14
    v_add_f32 v149, v149, v15
    v_lshlrev_b32 v14, 16, v139
    v_and_b32 v15, s56, v139
    s_add_u32 m0, s43, 0
    s_mov_b32 s25, 1152
    buffer_load_dwordx4 v11, s[16:19], s25 offen offset:1024 lds
    v_add_f32 v149, v149, v14
    v_add_f32 v149, v149, v15
    v_add_f32_dpp v148, v148, v148 quad_perm:[1,0,3,2] row_mask:0xf bank_mask:0xf
    s_nop 0
    v_add_f32_dpp v149, v149, v149 quad_perm:[1,0,3,2] row_mask:0xf bank_mask:0xf
    v_add_f32_dpp v148, v148, v148 quad_perm:[2,3,0,1] row_mask:0xf bank_mask:0xf
    s_nop 0
    v_add_f32_dpp v149, v149, v149 quad_perm:[2,3,0,1] row_mask:0xf bank_mask:0xf
    v_add_f32_dpp v148, v148, v148 row_half_mirror row_mask:0xf bank_mask:0xf
    s_nop 0
    v_add_f32_dpp v149, v149, v149 row_half_mirror row_mask:0xf bank_mask:0xf
    s_lshl_b32 s24, s20, 10
    s_add_u32 s24, s24, 159744
    v_lshl_add_u32 v14, v180, 5, s24
    v_lshrrev_b32 v15, 3, v1
    s_lshl_b32 s25, s20, 6
    s_add_u32 s24, s24, s25
    s_add_u32 s24, s24, 448
    v_lshl_add_u32 v15, v15, 2, s24
    s_mov_b64 exec, 0x3fff
    ds_write_b128 v14, v[140:143]
    ds_write_b128 v14, v[144:147] offset:16
    s_mov_b32 exec_lo, 0x01010101
    s_mov_b32 exec_hi, 0x01010101
    ds_write_b32 v15, v148
    ds_write_b32 v15, v149 offset:32
    s_mov_b64 exec, -1
    s_waitcnt lgkmcnt(0)
    s_waitcnt vmcnt(22)
    s_barrier
    s_add_u32 m0, s42, 4096
    s_mov_b32 s25, 1152
    buffer_load_dwordx4 v6, s[48:51], s25 offen offset:0 lds
    buffer_load_dwordx4 v7, s[48:51], s25 offen offset:1024 lds
    buffer_load_dwordx4 v8, s[48:51], s25 offen offset:2048 lds
    buffer_load_dwordx4 v9, s[48:51], s25 offen offset:3072 lds
    s_add_u32 m0, s44, 28672
    s_mov_b32 s24, 4358144
    s_mov_b64 exec, s[46:47]
    buffer_load_dwordx4 v12, s[12:15], s24 offen offset:0 lds
    buffer_load_dwordx4 v13, s[12:15], s24 offen offset:896 lds
    s_mov_b64 exec, -1
    s_mul_i32 s24, s20, 176
    v_add_u32 v14, s24, v170
    v_add_u32 v15, 159744, v14
    s_lshl_b32 s24, s22, 3
    s_add_u32 s24, s24, s21
    s_lshl_b32 s24, s24, 10
    s_add_u32 s24, s24, 48496640
    s_mov_b64 exec, 0x7ff
    ds_read_b128 v[92:95], v15 offset:0
    ds_read_b128 v[96:99], v15 offset:1024
    ds_read_b128 v[100:103], v15 offset:2048
    ds_read_b128 v[104:107], v15 offset:3072
    s_waitcnt lgkmcnt(0)
    v_add_f32 v92, v92, v96
    v_add_f32 v93, v93, v97
    v_add_f32 v94, v94, v98
    v_add_f32 v95, v95, v99
    v_add_f32 v92, v92, v100
    v_add_f32 v93, v93, v101
    v_add_f32 v94, v94, v102
    v_add_f32 v95, v95, v103
    v_add_f32 v92, v92, v104
    v_add_f32 v93, v93, v105
    v_add_f32 v94, v94, v106
    v_add_f32 v95, v95, v107
    buffer_store_dwordx4 v[92:95], v14, s[8:11], s24 offen sc1
    s_mov_b64 exec, -1
    s_waitcnt vmcnt(17)
    s_barrier
    s_add_u32 m0, s44, 0
    s_mov_b32 s24, 4587520
    s_mov_b64 exec, s[46:47]
    buffer_load_dwordx4 v12, s[12:15], s24 offen offset:0 lds
    buffer_load_dwordx4 v13, s[12:15], s24 offen offset:896 lds
    s_mov_b64 exec, -1
    s_add_u32 m0, s42, 32768
    s_mov_b32 s25, 1280
    buffer_load_dwordx4 v2, s[48:51], s25 offen offset:0 lds
    buffer_load_dwordx4 v3, s[48:51], s25 offen offset:1024 lds
    buffer_load_dwordx4 v4, s[48:51], s25 offen offset:2048 lds
    buffer_load_dwordx4 v5, s[48:51], s25 offen offset:3072 lds
    s_add_u32 m0, s43, 8192
    s_mov_b32 s25, 1280
    buffer_load_dwordx4 v10, s[16:19], s25 offen offset:0 lds
    s_add_u32 m0, s43, 8192
    s_mov_b32 s25, 1280
    buffer_load_dwordx4 v11, s[16:19], s25 offen offset:1024 lds
    s_waitcnt vmcnt(23)
    s_barrier
    s_add_u32 m0, s42, 36864
    s_mov_b32 s25, 1280
    buffer_load_dwordx4 v6, s[48:51], s25 offen offset:0 lds
    buffer_load_dwordx4 v7, s[48:51], s25 offen offset:1024 lds
    buffer_load_dwordx4 v8, s[48:51], s25 offen offset:2048 lds
    buffer_load_dwordx4 v9, s[48:51], s25 offen offset:3072 lds
    s_add_u32 m0, s44, 7168
    s_mov_b32 s24, 4816896
    s_mov_b64 exec, s[46:47]
    buffer_load_dwordx4 v12, s[12:15], s24 offen offset:0 lds
    buffer_load_dwordx4 v13, s[12:15], s24 offen offset:896 lds
    s_mov_b64 exec, -1
    s_waitcnt vmcnt(14)
    s_barrier
    s_add_u32 m0, s44, 14336
    s_mov_b32 s24, 5046272
    s_mov_b64 exec, s[46:47]
    buffer_load_dwordx4 v12, s[12:15], s24 offen offset:0 lds
    buffer_load_dwordx4 v13, s[12:15], s24 offen offset:896 lds
    s_mov_b64 exec, -1
    s_add_u32 m0, s42, 65536
    s_mov_b32 s25, 1408
    buffer_load_dwordx4 v2, s[48:51], s25 offen offset:0 lds
    buffer_load_dwordx4 v3, s[48:51], s25 offen offset:1024 lds
    buffer_load_dwordx4 v4, s[48:51], s25 offen offset:2048 lds
    buffer_load_dwordx4 v5, s[48:51], s25 offen offset:3072 lds
    s_add_u32 m0, s43, 16384
    s_mov_b32 s25, 1408
    buffer_load_dwordx4 v10, s[16:19], s25 offen offset:0 lds
    s_add_u32 m0, s43, 16384
    s_mov_b32 s25, 1408
    buffer_load_dwordx4 v11, s[16:19], s25 offen offset:1024 lds
    s_barrier
    s_add_u32 m0, s42, 69632
    s_mov_b32 s25, 1408
    buffer_load_dwordx4 v6, s[48:51], s25 offen offset:0 lds
    buffer_load_dwordx4 v7, s[48:51], s25 offen offset:1024 lds
    buffer_load_dwordx4 v8, s[48:51], s25 offen offset:2048 lds
    buffer_load_dwordx4 v9, s[48:51], s25 offen offset:3072 lds
    s_add_u32 m0, s44, 21504
    s_mov_b32 s24, 5275648
    s_mov_b64 exec, s[46:47]
    buffer_load_dwordx4 v12, s[12:15], s24 offen offset:0 lds
    buffer_load_dwordx4 v13, s[12:15], s24 offen offset:896 lds
    s_mov_b64 exec, -1
    s_waitcnt vmcnt(16)
    s_barrier
    s_add_u32 m0, s44, 28672
    s_mov_b32 s24, 5505024
    s_mov_b64 exec, s[46:47]
    buffer_load_dwordx4 v12, s[12:15], s24 offen offset:0 lds
    buffer_load_dwordx4 v13, s[12:15], s24 offen offset:896 lds
    s_mov_b64 exec, -1
    s_add_u32 m0, s42, 0
    s_mov_b32 s25, 1536
    buffer_load_dwordx4 v2, s[48:51], s25 offen offset:0 lds
    buffer_load_dwordx4 v3, s[48:51], s25 offen offset:1024 lds
    buffer_load_dwordx4 v4, s[48:51], s25 offen offset:2048 lds
    buffer_load_dwordx4 v5, s[48:51], s25 offen offset:3072 lds
    s_add_u32 m0, s43, 0
    s_mov_b32 s25, 1536
    buffer_load_dwordx4 v10, s[16:19], s25 offen offset:0 lds
    s_add_u32 m0, s43, 0
    s_mov_b32 s25, 1536
    buffer_load_dwordx4 v11, s[16:19], s25 offen offset:1024 lds
    s_waitcnt vmcnt(22)
    s_barrier
    s_add_u32 m0, s42, 4096
    s_mov_b32 s25, 1536
    buffer_load_dwordx4 v6, s[48:51], s25 offen offset:0 lds
    buffer_load_dwordx4 v7, s[48:51], s25 offen offset:1024 lds
    buffer_load_dwordx4 v8, s[48:51], s25 offen offset:2048 lds
    buffer_load_dwordx4 v9, s[48:51], s25 offen offset:3072 lds
    s_add_u32 m0, s44, 0
    s_mov_b32 s24, 5734400
    s_mov_b64 exec, s[46:47]
    buffer_load_dwordx4 v12, s[12:15], s24 offen offset:0 lds
    buffer_load_dwordx4 v13, s[12:15], s24 offen offset:896 lds
    s_mov_b64 exec, -1
    s_waitcnt vmcnt(16)
    s_barrier
    s_add_u32 m0, s44, 7168
    s_mov_b32 s24, 5963776
    s_mov_b64 exec, s[46:47]
    buffer_load_dwordx4 v12, s[12:15], s24 offen offset:0 lds
    buffer_load_dwordx4 v13, s[12:15], s24 offen offset:896 lds
    s_mov_b64 exec, -1
    s_add_u32 m0, s42, 32768
    s_mov_b32 s25, 1664
    buffer_load_dwordx4 v2, s[48:51], s25 offen offset:0 lds
    buffer_load_dwordx4 v3, s[48:51], s25 offen offset:1024 lds
    buffer_load_dwordx4 v4, s[48:51], s25 offen offset:2048 lds
    buffer_load_dwordx4 v5, s[48:51], s25 offen offset:3072 lds
    s_add_u32 m0, s43, 8192
    s_mov_b32 s25, 1664
    buffer_load_dwordx4 v10, s[16:19], s25 offen offset:0 lds
    s_add_u32 m0, s43, 8192
    s_mov_b32 s25, 1664
    buffer_load_dwordx4 v11, s[16:19], s25 offen offset:1024 lds
    s_waitcnt vmcnt(22)
    s_barrier
    s_add_u32 m0, s42, 36864
    s_mov_b32 s25, 1664
    buffer_load_dwordx4 v6, s[48:51], s25 offen offset:0 lds
    buffer_load_dwordx4 v7, s[48:51], s25 offen offset:1024 lds
    buffer_load_dwordx4 v8, s[48:51], s25 offen offset:2048 lds
    buffer_load_dwordx4 v9, s[48:51], s25 offen offset:3072 lds
    s_add_u32 m0, s44, 14336
    s_mov_b32 s24, 6193152
    s_mov_b64 exec, s[46:47]
    buffer_load_dwordx4 v12, s[12:15], s24 offen offset:0 lds
    buffer_load_dwordx4 v13, s[12:15], s24 offen offset:896 lds
    s_mov_b64 exec, -1
    s_waitcnt vmcnt(16)
    s_barrier
    s_add_u32 m0, s44, 21504
    s_mov_b32 s24, 6422528
    s_mov_b64 exec, s[46:47]
    buffer_load_dwordx4 v12, s[12:15], s24 offen offset:0 lds
    buffer_load_dwordx4 v13, s[12:15], s24 offen offset:896 lds
    s_mov_b64 exec, -1
    s_add_u32 m0, s42, 65536
    s_mov_b32 s25, 1792
    buffer_load_dwordx4 v2, s[48:51], s25 offen offset:0 lds
    buffer_load_dwordx4 v3, s[48:51], s25 offen offset:1024 lds
    buffer_load_dwordx4 v4, s[48:51], s25 offen offset:2048 lds
    buffer_load_dwordx4 v5, s[48:51], s25 offen offset:3072 lds
    s_add_u32 m0, s43, 16384
    s_mov_b32 s25, 1792
    buffer_load_dwordx4 v10, s[16:19], s25 offen offset:0 lds
    s_add_u32 m0, s43, 16384
    s_mov_b32 s25, 1792
    buffer_load_dwordx4 v11, s[16:19], s25 offen offset:1024 lds
    s_waitcnt vmcnt(22)
    s_barrier
    s_add_u32 m0, s42, 69632
    s_mov_b32 s25, 1792
    buffer_load_dwordx4 v6, s[48:51], s25 offen offset:0 lds
    buffer_load_dwordx4 v7, s[48:51], s25 offen offset:1024 lds
    buffer_load_dwordx4 v8, s[48:51], s25 offen offset:2048 lds
    buffer_load_dwordx4 v9, s[48:51], s25 offen offset:3072 lds
    s_add_u32 m0, s44, 28672
    s_mov_b32 s24, 6651904
    s_mov_b64 exec, s[46:47]
    buffer_load_dwordx4 v12, s[12:15], s24 offen offset:0 lds
    buffer_load_dwordx4 v13, s[12:15], s24 offen offset:896 lds
    s_mov_b64 exec, -1
    s_waitcnt vmcnt(16)
    s_barrier
    s_add_u32 m0, s44, 0
    s_mov_b32 s24, 6881280
    s_mov_b64 exec, s[46:47]
    buffer_load_dwordx4 v12, s[12:15], s24 offen offset:0 lds
    buffer_load_dwordx4 v13, s[12:15], s24 offen offset:896 lds
    s_mov_b64 exec, -1
    s_add_u32 m0, s42, 0
    s_mov_b32 s25, 1920
    buffer_load_dwordx4 v2, s[48:51], s25 offen offset:0 lds
    buffer_load_dwordx4 v3, s[48:51], s25 offen offset:1024 lds
    buffer_load_dwordx4 v4, s[48:51], s25 offen offset:2048 lds
    buffer_load_dwordx4 v5, s[48:51], s25 offen offset:3072 lds
    s_add_u32 m0, s43, 0
    s_mov_b32 s25, 1920
    buffer_load_dwordx4 v10, s[16:19], s25 offen offset:0 lds
    s_add_u32 m0, s43, 0
    s_mov_b32 s25, 1920
    buffer_load_dwordx4 v11, s[16:19], s25 offen offset:1024 lds
    v_lshlrev_b32 v66, 7, v1
    v_mov_b32 v67, 128
    s_mov_b64 exec, 3
    global_load_dword v68, v66, s[96:97] sc1
    s_mov_b64 exec, -1
    s_waitcnt vmcnt(23)
    s_barrier
    s_add_u32 m0, s42, 4096
    s_mov_b32 s25, 1920
    buffer_load_dwordx4 v6, s[48:51], s25 offen offset:0 lds
    buffer_load_dwordx4 v7, s[48:51], s25 offen offset:1024 lds
    buffer_load_dwordx4 v8, s[48:51], s25 offen offset:2048 lds
    buffer_load_dwordx4 v9, s[48:51], s25 offen offset:3072 lds
    s_add_u32 m0, s44, 7168
    s_mov_b32 s24, 7110656
    s_mov_b64 exec, s[46:47]
    buffer_load_dwordx4 v12, s[12:15], s24 offen offset:0 lds
    buffer_load_dwordx4 v13, s[12:15], s24 offen offset:896 lds
    s_mov_b64 exec, -1
    s_waitcnt vmcnt(6)
    s_mov_b32 s57, 0
    s_mov_b64 exec, 3
K1_cnt_1:
    v_cmp_ne_u32 vcc, v68, v67
    s_cbranch_vccz K1_cnt_1_ok
    s_add_u32 s57, s57, 1
    s_cmp_gt_u32 s57, 0x40000
    s_cbranch_scc1 K1_cnt_1_ok
    s_sleep 2
    global_load_dword v68, v66, s[96:97] sc1
    s_waitcnt vmcnt(0)
    s_branch K1_cnt_1
K1_cnt_1_ok:
    s_mov_b64 exec, -1
    v_and_b32 v14, 15, v1
    v_lshrrev_b32 v16, 2, v14
    v_lshlrev_b32 v16, 4, v16
    v_and_b32 v17, 1, v14
    v_lshl_add_u32 v16, v17, 3, v16
    v_bfe_u32 v17, v14, 1, 1
    v_add_u32 v16, v16, v17
    v_add_u32 v16, s26, v16
    v_lshlrev_b32 v16, 4, v16
    s_mov_b32 s24, 48234496
    buffer_load_dwordx4 v[76:79], v16, s[8:11], s24 offen offset:0 sc1
    buffer_load_dwordx4 v[80:83], v16, s[8:11], s24 offen offset:32 sc1
    buffer_load_dwordx4 v[84:87], v16, s[8:11], s24 offen offset:64 sc1
    buffer_load_dwordx4 v[88:91], v16, s[8:11], s24 offen offset:96 sc1
    s_lshl_b32 s24, s22, 13
    s_add_u32 s24, s24, 48496640
    s_bfm_b64 exec, 44, 0
    buffer_load_dwordx4 v[92:95], v170, s[8:11], s24 offen sc1
    s_add_u32 s24, s24, 1024
    buffer_load_dwordx4 v[96:99], v170, s[8:11], s24 offen sc1
    s_add_u32 s24, s24, 1024
    buffer_load_dwordx4 v[100:103], v170, s[8:11], s24 offen sc1
    s_add_u32 s24, s24, 1024
    buffer_load_dwordx4 v[104:107], v170, s[8:11], s24 offen sc1
    s_add_u32 s24, s24, 1024
    buffer_load_dwordx4 v[108:111], v170, s[8:11], s24 offen sc1
    s_add_u32 s24, s24, 1024
    buffer_load_dwordx4 v[112:115], v170, s[8:11], s24 offen sc1
    s_add_u32 s24, s24, 1024
    buffer_load_dwordx4 v[116:119], v170, s[8:11], s24 offen sc1
    s_add_u32 s24, s24, 1024
    buffer_load_dwordx4 v[120:123], v170, s[8:11], s24 offen sc1
    s_add_u32 s24, s24, 1024
    s_mov_b64 exec, -1
    s_barrier
    s_mul_i32 s24, s20, 7168
    v_add_u32 v15, s24, v170
    s_lshl_b32 s24, s20, 11
    v_add_u32 v16, s24, v170
    ds_write_b128 v15, v[20:23] offset:32768
    ds_write_b128 v15, v[24:27] offset:33792
    ds_write_b128 v15, v[28:31] offset:34816
    ds_write_b128 v15, v[32:35] offset:35840
    ds_write_b128 v15, v[36:39] offset:36864
    s_barrier
    s_waitcnt vmcnt(0)
    v_add_f32 v92, v92, v96
    v_add_f32 v93, v93, v97
    v_add_f32 v94, v94, v98
    v_add_f32 v95, v95, v99
    v_add_f32 v92, v92, v100
    v_add_f32 v93, v93, v101
    v_add_f32 v94, v94, v102
    v_add_f32 v95, v95, v103
    v_add_f32 v92, v92, v104
    v_add_f32 v93, v93, v105
    v_add_f32 v94, v94, v106
    v_add_f32 v95, v95, v107
    v_add_f32 v92, v92, v108
    v_add_f32 v93, v93, v109
    v_add_f32 v94, v94, v110
    v_add_f32 v95, v95, v111
    v_add_f32 v92, v92, v112
    v_add_f32 v93, v93, v113
    v_add_f32 v94, v94, v114
    v_add_f32 v95, v95, v115
    v_add_f32 v92, v92, v116
    v_add_f32 v93, v93, v117
    v_add_f32 v94, v94, v118
    v_add_f32 v95, v95, v119
    v_add_f32 v92, v92, v120
    v_add_f32 v93, v93, v121
    v_add_f32 v94, v94, v122
    v_add_f32 v95, v95, v123
    s_barrier
    s_mul_i32 s24, s20, 7168
    v_add_u32 v15, s24, v170
    s_lshl_b32 s24, s20, 11
    v_add_u32 v16, s24, v170
    v_add_u32 v17, 147456, v16
    ds_write_b128 v17, v[48:51]
    v_add_u32 v17, 148480, v16
    ds_write_b128 v17, v[52:55]
    v_mul_f32 v172, v77, v78
    v_mul_f32 v176, -v76, v172
    v_mul_f32 v76, -v76, v77
    v_mul_f32 v173, v81, v82
    v_mul_f32 v177, -v80, v173
    v_mul_f32 v80, -v80, v81
    v_mul_f32 v174, v85, v86
    v_mul_f32 v178, -v84, v174
    v_mul_f32 v84, -v84, v85
    v_mul_f32 v175, v89, v90
    v_mul_f32 v179, -v88, v175
    v_mul_f32 v88, -v88, v89
    v_and_b32 v14, 15, v1
    s_lshl_b32 s24, s20, 9
    s_add_u32 s25, s24, 159744
    v_lshl_add_u32 v15, v14, 5, s25
    v_lshrrev_b32 v16, 2, v14
    v_lshlrev_b32 v16, 7, v16
    v_and_b32 v17, 3, v14
    v_lshl_add_u32 v16, v17, 2, v16
    s_add_u32 s25, s24, 161792
    v_add_u32 v16, s25, v16
    s_mov_b64 exec, 0xffff
    ds_write_b128 v15, v[172:175]
    ds_write_b128 v15, v[176:179] offset:16
    ds_write_b32 v16, v77 offset:0
    ds_write_b32 v16, v76 offset:16
    ds_write_b32 v16, v81 offset:32
    ds_write_b32 v16, v80 offset:48
    ds_write_b32 v16, v85 offset:64
    ds_write_b32 v16, v84 offset:80
    ds_write_b32 v16, v89 offset:96
    ds_write_b32 v16, v88 offset:112
    s_mov_b64 exec, -1
    s_barrier
    v_lshlrev_b32 v15, 5, v1
    v_subrev_u32 v16, 28, v1
    v_and_b32 v17, 3, v16
    v_lshlrev_b32 v17, 6, v17
    v_and_b32 v16, 12, v16
    v_add_u32 v16, v16, v17
    s_mov_b64 exec, 0xfffffff
    ds_write_b128 v15, v[92:95] offset:61440
    ds_write_b128 v15, v[72:75] offset:61456
    s_bfm_b64 exec, 16, 28
    ds_write_b32 v16, v92 offset:62336
    ds_write_b32 v16, v93 offset:62352
    ds_write_b32 v16, v94 offset:62368
    ds_write_b32 v16, v95 offset:62384
    s_mov_b64 exec, -1
    s_waitcnt lgkmcnt(0)
    s_barrier
    s_barrier
    s_cmp_eq_u32 s20, 0
    s_cbranch_scc0 K1_lnocarry
    v_cmp_gt_u32 s[48:49], s21, v69
    v_add_u32 v14, 4, v69
    v_cmp_gt_u32 s[50:51], s21, v14
    s_lshl_b32 s58, s22, 11
    s_add_u32 s58, s58, 48300032
    s_mov_b32 s59, 0
    v_mov_b32 v76, 0
    v_mov_b32 v77, 0
    v_mov_b32 v78, 0
    v_mov_b32 v79, 0
    v_mov_b32 v80, 0
    v_mov_b32 v81, 0
    v_mov_b32 v82, 0
    v_mov_b32 v83, 0
    s_cmp_eq_u32 s21, 0
    s_cbranch_scc1 K1_lhave
    s_sleep 16
K1_lpoll:
    s_mov_b64 exec, s[48:49]
    buffer_load_dwordx4 v[76:79], v170, s[8:11], s58 offen sc1
    s_mov_b64 exec, -1
    s_cmp_le_u32 s21, 4
    s_cbranch_scc1 K1_lone
    s_mov_b64 exec, s[50:51]
    buffer_load_dwordx4 v[80:83], v170, s[8:11], s58 offen offset:1024 sc1
    s_mov_b64 exec, -1
K1_lone:
    s_waitcnt vmcnt(0)
    v_max3_u32 v14, v76, v77, v78
    v_max3_u32 v14, v14, v79, v80
    v_max3_u32 v14, v14, v81, v82
    v_max_u32 v14, v14, v83
    v_cmp_eq_u32 vcc, -1, v14
    s_cbranch_vccz K1_lhave
    s_add_u32 s59, s59, 1
    s_cmp_gt_u32 s59, 0x40000
    s_cbranch_scc1 K1_lhave
    s_sleep 4
    s_branch K1_lpoll
K1_lhave:
    v_pk_mul_f32 v[92:93], v[40:41], v[76:77] op_sel:[1,0] op_sel_hi:[1,1]
    v_pk_fma_f32 v[92:93], v[76:77], v[40:41], v[92:93] op_sel:[1,0,0] op_sel_hi:[0,0,1] neg_lo:[1,0,0]
    v_pk_fma_f32 v[92:93], v[44:45], v[80:81], v[92:93] op_sel:[1,0,0] op_sel_hi:[1,1,1]
    v_pk_fma_f32 v[92:93], v[80:81], v[44:45], v[92:93] op_sel:[1,0,0] op_sel_hi:[0,0,1] neg_lo:[1,0,0]
    v_pk_mul_f32 v[94:95], v[42:43], v[78:79] op_sel:[1,0] op_sel_hi:[1,1]
    v_pk_fma_f32 v[94:95], v[78:79], v[42:43], v[94:95] op_sel:[1,0,0] op_sel_hi:[0,0,1] neg_lo:[1,0,0]
    v_pk_fma_f32 v[94:95], v[46:47], v[82:83], v[94:95] op_sel:[1,0,0] op_sel_hi:[1,1,1]
    v_pk_fma_f32 v[94:95], v[82:83], v[46:47], v[94:95] op_sel:[1,0,0] op_sel_hi:[0,0,1] neg_lo:[1,0,0]
    v_mov_b32 v96, v92
    v_mov_b32 v97, v93
    v_mov_b32 v98, v94
    v_mov_b32 v99, v95
    v_permlane16_swap_b32 v92, v96
    v_permlane16_swap_b32 v93, v97
    v_permlane16_swap_b32 v94, v98
    v_permlane16_swap_b32 v95, v99
    v_pk_add_f32 v[92:93], v[92:93], v[96:97]
    v_pk_add_f32 v[94:95], v[94:95], v[98:99]
    v_mov_b32 v96, v92
    v_mov_b32 v97, v93
    v_mov_b32 v98, v94
    v_mov_b32 v99, v95
    v_permlane32_swap_b32 v92, v96
    v_permlane32_swap_b32 v93, v97
    v_permlane32_swap_b32 v94, v98
    v_permlane32_swap_b32 v95, v99
    v_pk_add_f32 v[92:93], v[92:93], v[96:97]
    v_pk_add_f32 v[94:95], v[94:95], v[98:99]
    v_add_u32 v14, 155648, v170
    s_mov_b64 exec, 0xffff
    ds_write_b128 v14, v[92:95]
    s_mov_b64 exec, -1
    s_waitcnt lgkmcnt(0)
K1_lnocarry:
    s_branch K2_begin
K1_special:
    s_sub_u32 s24, s59, 3
    s_cmp_lt_u32 s24, 8
    s_cbranch_scc0 K1_nopf
    s_mov_b64 exec, 4095
    global_load_dword v247, v[244:245], off
    v_add_co_u32 v244, vcc, v244, v246
    s_nop 1
    v_addc_co_u32 v245, vcc, 0, v245, vcc
    s_mov_b64 exec, -1
K1_nopf:
    s_lshl_b32 s24, s20, 5
    s_add_u32 s24, s24, s59
    s_cmp_eq_u32 s24, s92
    s_cbranch_scc0 K1_back
    s_mov_b64 exec, 1
    global_atomic_add v2, v3, s[96:97] sc1
    s_mov_b64 exec, -1
    s_branch K1_back
K1_compute:
    s_getpc_b64 s[88:89]
K1_pc0:
    s_sub_u32 s88, s88, K1_pc0-K1_begin
    s_subb_u32 s89, s89, 0
    s_lshr_b32 s24, s2, 3
    s_lshl_b32 s24, s24, 2
    s_add_u32 s24, s24, s20
    s_mul_i32 s24, s24, 256
    v_lshl_add_u32 v2, v1, 7, s24
    s_mov_b64 exec, 3
    global_load_dword v3, v2, s[88:89]
    s_mov_b64 exec, -1
    s_setprio 1
    v_and_b32 v241, 15, v1
    v_lshrrev_b32 v242, 4, v1
    v_lshrrev_b32 v243, 1, v241
    v_xor_b32 v243, v243, v242
    v_lshlrev_b32 v243, 4, v243
    v_lshl_add_u32 v243, v241, 7, v243
    v_add_u32 v239, 98304, v243
    v_xor_b32 v240, 64, v239
    s_lshl_b32 s24, s20, 13
    v_add_u32 v236, s24, v243
    v_xor_b32 v237, 64, v236
    v_lshrrev_b32 v243, 1, v242
    v_lshlrev_b32 v243, 4, v243
    v_and_b32 v238, 1, v242
    v_lshl_add_u32 v243, v238, 2, v243
    v_bfe_u32 v238, v1, 2, 2
    v_add_u32 v243, v243, v238
    v_mul_u32_u24 v243, 224, v243
    v_and_b32 v238, 3, v1
    v_lshl_add_u32 v243, v238, 3, v243
    v_add_u32 v238, 122880, v243
    v_cmp_eq_u32 s[42:43], 1, v242
    v_cmp_eq_u32 s[44:45], 2, v242
    v_cmp_eq_u32 s[46:47], 3, v242
    v_cmp_gt_u32 s[48:49], s21, v242
    v_add_u32 v243, 4, v242
    v_cmp_gt_u32 s[50:51], s21, v243
    s_mov_b32 s52, 0xbdd2d3e8
    s_mov_b32 s53, 0xc0135761
    s_mov_b32 s54, 0
    s_mov_b32 s55, 0
    s_mov_b32 s86, 7168
    s_mov_b32 s87, 32768
    v_mov_b32 v4, 0
    v_mov_b32 v5, 0
    v_mov_b32 v6, 0
    v_mov_b32 v7, 0
    v_mov_b32 v8, 0
    v_mov_b32 v9, 0
    v_mov_b32 v10, 0
    v_mov_b32 v11, 0
    v_mov_b32 v12, 0
    v_mov_b32 v13, 0
    v_mov_b32 v14, 0
    v_mov_b32 v15, 0
    v_mov_b32 v16, 0
    v_mov_b32 v17, 0
    v_mov_b32 v18, 0
    v_mov_b32 v19, 0
    v_mov_b32 v20, 0
    v_mov_b32 v21, 0
    v_mov_b32 v22, 0
    v_mov_b32 v23, 0
    v_mov_b32 v24, 0
    v_mov_b32 v25, 0
    v_mov_b32 v26, 0
    v_mov_b32 v27, 0
    v_mov_b32 v28, 0
    v_mov_b32 v29, 0
    v_mov_b32 v30, 0
    v_mov_b32 v31, 0
    v_mov_b32 v32, 0
    v_mov_b32 v33, 0
    v_mov_b32 v34, 0
    v_mov_b32 v35, 0
    v_mov_b32 v36, 0
    v_mov_b32 v37, 0
    v_mov_b32 v38, 0
    v_mov_b32 v39, 0
    v_mov_b32 v40, 0
    v_mov_b32 v41, 0
    v_mov_b32 v42, 0
    v_mov_b32 v43, 0
    v_mov_b32 v44, 0
    v_mov_b32 v45, 0
    v_mov_b32 v46, 0
    v_mov_b32 v47, 0
    v_mov_b32 v48, 0
    v_mov_b32 v49, 0
    v_mov_b32 v50, 0
    v_mov_b32 v51, 0
    v_mov_b32 v52, 0
    v_mov_b32 v53, 0
    v_mov_b32 v54, 0
    v_mov_b32 v55, 0
    v_mov_b32 v56, 0
    v_mov_b32 v57, 0
    v_mov_b32 v58, 0
    v_mov_b32 v59, 0
    v_mov_b32 v60, 0
    v_mov_b32 v61, 0
    v_mov_b32 v62, 0
    v_mov_b32 v63, 0
    v_mov_b32 v64, 0
    v_mov_b32 v65, 0
    v_mov_b32 v66, 0
    v_mov_b32 v67, 0
    v_mov_b32 v68, 0
    v_mov_b32 v69, 0
    v_mov_b32 v70, 0
    v_mov_b32 v71, 0
    v_mov_b32 v72, 0
    v_mov_b32 v73, 0
    v_mov_b32 v74, 0
    v_mov_b32 v75, 0
    v_mov_b32 v76, 0
    v_mov_b32 v77, 0
    v_mov_b32 v78, 0
    v_mov_b32 v79, 0
    v_mov_b32 v80, 0
    v_mov_b32 v81, 0
    v_mov_b32 v82, 0
    v_mov_b32 v83, 0
    v_mov_b32 v84, 0
    v_mov_b32 v85, 0
    v_mov_b32 v86, 0
    v_mov_b32 v87, 0
    v_mov_b32 v88, 0
    v_mov_b32 v89, 0
    v_mov_b32 v90, 0
    v_mov_b32 v91, 0
    v_mov_b32 v92, 0
    v_mov_b32 v93, 0
    v_mov_b32 v94, 0
    v_mov_b32 v95, 0
    v_mov_b32 v96, 0
    v_mov_b32 v97, 0
    v_mov_b32 v98, 0
    v_mov_b32 v99, 0
    v_mov_b32 v100, 0
    v_mov_b32 v101, 0
    v_mov_b32 v102, 0
    v_mov_b32 v103, 0
    v_mov_b32 v104, 0
    v_mov_b32 v105, 0
    v_mov_b32 v106, 0
    v_mov_b32 v107, 0
    v_mov_b32 v108, 0
    v_mov_b32 v109, 0
    v_mov_b32 v110, 0
    v_mov_b32 v111, 0
    v_mov_b32 v112, 0
    v_mov_b32 v113, 0
    v_mov_b32 v114, 0
    v_mov_b32 v115, 0
    v_mov_b32 v116, 0
    v_mov_b32 v117, 0
    v_mov_b32 v118, 0
    v_mov_b32 v119, 0
    v_mov_b32 v120, 0
    v_mov_b32 v121, 0
    v_mov_b32 v122, 0
    v_mov_b32 v123, 0
    v_mov_b32 v124, 0
    v_mov_b32 v125, 0
    v_mov_b32 v126, 0
    v_mov_b32 v127, 0
    v_mov_b32 v128, 0
    v_mov_b32 v129, 0
    v_mov_b32 v130, 0
    v_mov_b32 v131, 0
    v_mov_b32 v132, 0
    v_mov_b32 v133, 0
    v_mov_b32 v134, 0
    v_mov_b32 v135, 0
    v_mov_b32 v136, 0
    v_mov_b32 v137, 0
    v_mov_b32 v138, 0
    v_mov_b32 v139, 0
    v_mov_b32 v140, 0
    v_mov_b32 v141, 0
    v_mov_b32 v142, 0
    v_mov_b32 v143, 0
    v_mov_b32 v144, 0
    v_mov_b32 v145, 0
    v_mov_b32 v146, 0
    v_mov_b32 v147, 0
    v_mov_b32 v148, 0
    v_mov_b32 v149, 0
    v_mov_b32 v150, 0
    v_mov_b32 v151, 0
    v_mov_b32 v152, 0
    v_mov_b32 v153, 0
    v_mov_b32 v154, 0
    v_mov_b32 v155, 0
    v_mov_b32 v156, 0
    v_mov_b32 v157, 0
    v_mov_b32 v158, 0
    v_mov_b32 v159, 0
    v_mov_b32 v160, 0
    v_mov_b32 v161, 0
    v_mov_b32 v162, 0
    v_mov_b32 v163, 0
    v_mov_b32 v164, 0
    v_mov_b32 v165, 0
    v_mov_b32 v166, 0
    v_mov_b32 v167, 0
    v_mov_b32 v168, 0
    v_mov_b32 v169, 0
    v_mov_b32 v170, 0
    v_mov_b32 v171, 0
    v_mov_b32 v172, 0
    v_mov_b32 v173, 0
    v_mov_b32 v174, 0
    v_mov_b32 v175, 0
    v_mov_b32 v176, 0
    v_mov_b32 v177, 0
    v_mov_b32 v178, 0
    v_mov_b32 v179, 0
    s_waitcnt lgkmcnt(0)
    s_getpc_b64 s[88:89]
K1_pcx:
    s_add_u32 s88, s88, K1_epi-K1_pcx
    s_addc_u32 s89, s89, 0
    s_lshr_b32 s24, s2, 3
    s_lshl_b32 s24, s24, 2
    s_add_u32 s24, s24, s20
    s_mul_i32 s24, s24, 448
    s_min_u32 s24, s24, 46848
    s_add_u32 s88, s88, s24
    s_addc_u32 s89, s89, 0
    s_lshl_b32 s24, s2, 2
    s_add_u32 s24, s24, s20
    s_lshl_b32 s25, s24, 11
    s_mul_i32 s24, s24, 7168
    s_add_u32 s80, s80, s25
    s_addc_u32 s81, s81, 0
    s_add_u32 s82, s82, s25
    s_addc_u32 s83, s83, 0
    s_add_u32 s84, s84, s24
    s_addc_u32 s85, s85, 0
    v_mov_b32 v244, s88
    v_mov_b32 v245, s89
    v_mov_b32 v246, 128
    v_mov_b32 v241, 0
    v_cmp_gt_u32 vcc, 11, v1
    v_mov_b32 v242, s84
    v_mov_b32 v243, s85
    v_cndmask_b32 v244, v244, v242, vcc
    v_cndmask_b32 v245, v245, v243, vcc
    v_mov_b32 v242, 896
    v_cndmask_b32 v246, v246, v242, vcc
    v_subrev_u32 v242, 4, v1
    v_cndmask_b32 v241, v241, v242, vcc
    v_cmp_gt_u32 vcc, 4, v1
    v_mov_b32 v242, s82
    v_mov_b32 v243, s83
    v_cndmask_b32 v244, v244, v242, vcc
    v_cndmask_b32 v245, v245, v243, vcc
    v_mov_b32 v242, 256
    v_cndmask_b32 v246, v246, v242, vcc
    v_and_b32 v242, 1, v1
    v_cndmask_b32 v241, v241, v242, vcc
    v_cmp_gt_u32 vcc, 2, v1
    v_mov_b32 v242, s80
    v_mov_b32 v243, s81
    v_cndmask_b32 v244, v244, v242, vcc
    v_cndmask_b32 v245, v245, v243, vcc
    v_lshlrev_b32 v241, 7, v241
    v_add_co_u32 v244, vcc, v244, v241
    s_nop 1
    v_addc_co_u32 v245, vcc, 0, v245, vcc
    s_bfe_u32 s24, s2, 0x10003
    s_lshl_b32 s25, s24, 7
    v_mov_b32 v2, s25
    s_add_u32 s92, s24, 6
    s_waitcnt vmcnt(0)
    v_mov_b32 v3, 1
    s_mov_b32 s8, s4
    s_mov_b32 s9, s5
    s_mov_b32 s10, 268435456
    s_mov_b32 s11, 131072
    s_barrier
    ds_read_b128 v[180:183], v236 offset:0
    ds_read_b64_tr_b16 v[212:213], v238 offset:0
    ds_read_b64_tr_b16 v[214:215], v238 offset:1792
    ds_read_b128 v[184:187], v236 offset:2048
    ds_read_b128 v[188:191], v236 offset:4096
    ds_read_b128 v[192:195], v236 offset:6144
    ds_read_b64_tr_b16 v[216:217], v238 offset:32
    ds_read_b64_tr_b16 v[218:219], v238 offset:1824
    ds_read_b64_tr_b16 v[220:221], v238 offset:64
    ds_read_b64_tr_b16 v[222:223], v238 offset:1856
    ds_read_b64_tr_b16 v[224:225], v238 offset:96
    ds_read_b64_tr_b16 v[226:227], v238 offset:1888
    s_lshl_b32 s93, 1, s92
    s_cmp_eq_u32 s20, 0
    s_cselect_b32 s93, s93, 0
    s_or_b32 s93, s93, 2040
    s_mov_b32 s59, 16
K1_loop:
    s_waitcnt lgkmcnt(9)
    v_mfma_f32_16x16x32_bf16 v[4:7], v[212:215], v[180:183], v[4:7]
    ds_read_b64_tr_b16 v[228:229], v238 offset:128
    s_waitcnt lgkmcnt(9)
    v_mfma_f32_16x16x32_bf16 v[8:11], v[212:215], v[184:187], v[8:11]
    ds_read_b64_tr_b16 v[230:231], v238 offset:1920
    s_waitcnt lgkmcnt(9)
    v_mfma_f32_16x16x32_bf16 v[12:15], v[212:215], v[188:191], v[12:15]
    ds_read_b128 v[232:235], v239 offset:6144
    s_waitcnt lgkmcnt(9)
    v_mfma_f32_16x16x32_bf16 v[16:19], v[212:215], v[192:195], v[16:19]
    s_waitcnt lgkmcnt(7)
    v_mfma_f32_16x16x32_bf16 v[32:35], v[216:219], v[192:195], v[32:35]
    ds_read_b64_tr_b16 v[212:213], v238 offset:160
    v_mfma_f32_16x16x32_bf16 v[28:31], v[216:219], v[188:191], v[28:31]
    ds_read_b64_tr_b16 v[214:215], v238 offset:1952
    v_mfma_f32_16x16x32_bf16 v[24:27], v[216:219], v[184:187], v[24:27]
    v_mfma_f32_16x16x32_bf16 v[20:23], v[216:219], v[180:183], v[20:23]
    s_waitcnt lgkmcnt(7)
    v_mfma_f32_16x16x32_bf16 v[36:39], v[220:223], v[180:183], v[36:39]
    ds_read_b64_tr_b16 v[216:217], v238 offset:192
    v_mfma_f32_16x16x32_bf16 v[40:43], v[220:223], v[184:187], v[40:43]
    ds_read_b64_tr_b16 v[218:219], v238 offset:1984
    v_mfma_f32_16x16x32_bf16 v[44:47], v[220:223], v[188:191], v[44:47]
    v_mfma_f32_16x16x32_bf16 v[48:51], v[220:223], v[192:195], v[48:51]
    s_waitcnt lgkmcnt(7)
    v_mfma_f32_16x16x32_bf16 v[64:67], v[224:227], v[192:195], v[64:67]
    ds_read_b128 v[220:223], v239 offset:0
    v_mfma_f32_16x16x32_bf16 v[60:63], v[224:227], v[188:191], v[60:63]
    v_mfma_f32_16x16x32_bf16 v[56:59], v[224:227], v[184:187], v[56:59]
    v_mfma_f32_16x16x32_bf16 v[52:55], v[224:227], v[180:183], v[52:55]
    s_waitcnt lgkmcnt(6)
    v_mfma_f32_16x16x32_bf16 v[68:71], v[228:231], v[180:183], v[68:71]
    ds_read_b128 v[224:227], v239 offset:2048
    v_mfma_f32_16x16x32_bf16 v[72:75], v[228:231], v[184:187], v[72:75]
    v_mfma_f32_16x16x32_bf16 v[76:79], v[228:231], v[188:191], v[76:79]
    v_mfma_f32_16x16x32_bf16 v[80:83], v[228:231], v[192:195], v[80:83]
    s_waitcnt lgkmcnt(4)
    v_mfma_f32_16x16x32_bf16 v[96:99], v[212:215], v[192:195], v[96:99]
    ds_read_b128 v[228:231], v239 offset:4096
    v_mfma_f32_16x16x32_bf16 v[92:95], v[212:215], v[188:191], v[92:95]
    v_mfma_f32_16x16x32_bf16 v[88:91], v[212:215], v[184:187], v[88:91]
    v_mfma_f32_16x16x32_bf16 v[84:87], v[212:215], v[180:183], v[84:87]
    s_waitcnt lgkmcnt(3)
    v_mfma_f32_16x16x32_bf16 v[100:103], v[216:219], v[180:183], v[100:103]
    s_add_u32 s54, s54, 7168
    s_cmp_eq_u32 s54, 35840
    s_cselect_b32 s56, 4294938624, s86
    s_cselect_b32 s54, 0, s54
    v_mfma_f32_16x16x32_bf16 v[104:107], v[216:219], v[184:187], v[104:107]
    v_add_u32 v238, s56, v238
    v_mfma_f32_16x16x32_bf16 v[108:111], v[216:219], v[188:191], v[108:111]
    s_bitcmp1_b32 s93, s59
    v_mfma_f32_16x16x32_bf16 v[112:115], v[216:219], v[192:195], v[112:115]
    s_waitcnt lgkmcnt(2)
    v_mfma_f32_16x16x32_bf16 v[128:131], v[192:195], v[220:223], v[128:131]
    v_mfma_f32_16x16x32_bf16 v[124:127], v[188:191], v[220:223], v[124:127]
    v_mfma_f32_16x16x32_bf16 v[120:123], v[184:187], v[220:223], v[120:123]
    v_mfma_f32_16x16x32_bf16 v[116:119], v[180:183], v[220:223], v[116:119]
    s_cbranch_scc1 K1_special
K1_back:
    s_waitcnt lgkmcnt(0)
    s_barrier
    v_mfma_f32_16x16x32_bf16 v[132:135], v[180:183], v[224:227], v[132:135]
    ds_read_b128 v[196:199], v237 offset:0
    v_mfma_f32_16x16x32_bf16 v[136:139], v[184:187], v[224:227], v[136:139]
    ds_read_b64_tr_b16 v[212:213], v238 offset:0
    v_mfma_f32_16x16x32_bf16 v[140:143], v[188:191], v[224:227], v[140:143]
    ds_read_b64_tr_b16 v[214:215], v238 offset:1792
    v_mfma_f32_16x16x32_bf16 v[144:147], v[192:195], v[224:227], v[144:147]
    ds_read_b128 v[200:203], v237 offset:2048
    v_mfma_f32_16x16x32_bf16 v[160:163], v[192:195], v[228:231], v[160:163]
    ds_read_b128 v[204:207], v237 offset:4096
    v_mfma_f32_16x16x32_bf16 v[156:159], v[188:191], v[228:231], v[156:159]
    ds_read_b128 v[208:211], v237 offset:6144
    v_mfma_f32_16x16x32_bf16 v[152:155], v[184:187], v[228:231], v[152:155]
    ds_read_b64_tr_b16 v[216:217], v238 offset:32
    v_mfma_f32_16x16x32_bf16 v[148:151], v[180:183], v[228:231], v[148:151]
    ds_read_b64_tr_b16 v[218:219], v238 offset:1824
    v_mfma_f32_16x16x32_bf16 v[164:167], v[180:183], v[232:235], v[164:167]
    ds_read_b64_tr_b16 v[220:221], v238 offset:64
    v_mfma_f32_16x16x32_bf16 v[168:171], v[184:187], v[232:235], v[168:171]
    ds_read_b64_tr_b16 v[222:223], v238 offset:1856
    v_mfma_f32_16x16x32_bf16 v[172:175], v[188:191], v[232:235], v[172:175]
    ds_read_b64_tr_b16 v[224:225], v238 offset:96
    v_mfma_f32_16x16x32_bf16 v[176:179], v[192:195], v[232:235], v[176:179]
    ds_read_b64_tr_b16 v[226:227], v238 offset:1888
    s_waitcnt lgkmcnt(9)
    v_mfma_f32_16x16x32_bf16 v[4:7], v[212:215], v[196:199], v[4:7]
    ds_read_b64_tr_b16 v[228:229], v238 offset:128
    s_waitcnt lgkmcnt(9)
    v_mfma_f32_16x16x32_bf16 v[8:11], v[212:215], v[200:203], v[8:11]
    ds_read_b64_tr_b16 v[230:231], v238 offset:1920
    s_waitcnt lgkmcnt(9)
    v_mfma_f32_16x16x32_bf16 v[12:15], v[212:215], v[204:207], v[12:15]
    ds_read_b128 v[232:235], v240 offset:6144
    s_waitcnt lgkmcnt(9)
    v_mfma_f32_16x16x32_bf16 v[16:19], v[212:215], v[208:211], v[16:19]
    s_waitcnt lgkmcnt(7)
    v_mfma_f32_16x16x32_bf16 v[32:35], v[216:219], v[208:211], v[32:35]
    ds_read_b64_tr_b16 v[212:213], v238 offset:160
    v_mfma_f32_16x16x32_bf16 v[28:31], v[216:219], v[204:207], v[28:31]
    ds_read_b64_tr_b16 v[214:215], v238 offset:1952
    v_mfma_f32_16x16x32_bf16 v[24:27], v[216:219], v[200:203], v[24:27]
    v_mfma_f32_16x16x32_bf16 v[20:23], v[216:219], v[196:199], v[20:23]
    s_waitcnt lgkmcnt(7)
    v_mfma_f32_16x16x32_bf16 v[36:39], v[220:223], v[196:199], v[36:39]
    ds_read_b64_tr_b16 v[216:217], v238 offset:192
    v_mfma_f32_16x16x32_bf16 v[40:43], v[220:223], v[200:203], v[40:43]
    ds_read_b64_tr_b16 v[218:219], v238 offset:1984
    v_mfma_f32_16x16x32_bf16 v[44:47], v[220:223], v[204:207], v[44:47]
    v_mfma_f32_16x16x32_bf16 v[48:51], v[220:223], v[208:211], v[48:51]
    s_waitcnt lgkmcnt(7)
    v_mfma_f32_16x16x32_bf16 v[64:67], v[224:227], v[208:211], v[64:67]
    ds_read_b128 v[220:223], v240 offset:0
    v_mfma_f32_16x16x32_bf16 v[60:63], v[224:227], v[204:207], v[60:63]
    v_mfma_f32_16x16x32_bf16 v[56:59], v[224:227], v[200:203], v[56:59]
    v_mfma_f32_16x16x32_bf16 v[52:55], v[224:227], v[196:199], v[52:55]
    s_waitcnt lgkmcnt(6)
    v_mfma_f32_16x16x32_bf16 v[68:71], v[228:231], v[196:199], v[68:71]
    ds_read_b128 v[224:227], v240 offset:2048
    v_mfma_f32_16x16x32_bf16 v[72:75], v[228:231], v[200:203], v[72:75]
    v_mfma_f32_16x16x32_bf16 v[76:79], v[228:231], v[204:207], v[76:79]
    v_mfma_f32_16x16x32_bf16 v[80:83], v[228:231], v[208:211], v[80:83]
    s_waitcnt lgkmcnt(4)
    v_mfma_f32_16x16x32_bf16 v[96:99], v[212:215], v[208:211], v[96:99]
    ds_read_b128 v[228:231], v240 offset:4096
    v_mfma_f32_16x16x32_bf16 v[92:95], v[212:215], v[204:207], v[92:95]
    v_mfma_f32_16x16x32_bf16 v[88:91], v[212:215], v[200:203], v[88:91]
    v_mfma_f32_16x16x32_bf16 v[84:87], v[212:215], v[196:199], v[84:87]
    s_waitcnt lgkmcnt(3)
    v_mfma_f32_16x16x32_bf16 v[100:103], v[216:219], v[196:199], v[100:103]
    s_add_u32 s54, s54, 7168
    s_cmp_eq_u32 s54, 35840
    s_cselect_b32 s56, 4294938624, s86
    s_cselect_b32 s54, 0, s54
    v_mfma_f32_16x16x32_bf16 v[104:107], v[216:219], v[200:203], v[104:107]
    v_add_u32 v238, s56, v238
    v_mfma_f32_16x16x32_bf16 v[108:111], v[216:219], v[204:207], v[108:111]
    s_add_u32 s55, s55, 32768
    s_cmp_eq_u32 s55, 98304
    s_cselect_b32 s57, 4294901760, s87
    s_cselect_b32 s55, 0, s55
    s_ashr_i32 s58, s57, 2
    v_mfma_f32_16x16x32_bf16 v[112:115], v[216:219], v[208:211], v[112:115]
    v_add_u32 v236, s57, v236
    s_waitcnt lgkmcnt(2)
    v_mfma_f32_16x16x32_bf16 v[128:131], v[208:211], v[220:223], v[128:131]
    v_add_u32 v237, s57, v237
    v_mfma_f32_16x16x32_bf16 v[124:127], v[204:207], v[220:223], v[124:127]
    v_add_u32 v239, s58, v239
    v_mfma_f32_16x16x32_bf16 v[120:123], v[200:203], v[220:223], v[120:123]
    v_add_u32 v240, s58, v240
    v_mfma_f32_16x16x32_bf16 v[116:119], v[196:199], v[220:223], v[116:119]
    s_sub_u32 s59, s59, 1
    s_waitcnt lgkmcnt(0)
    s_barrier
    v_mfma_f32_16x16x32_bf16 v[132:135], v[196:199], v[224:227], v[132:135]
    ds_read_b128 v[180:183], v236 offset:0
    v_mfma_f32_16x16x32_bf16 v[136:139], v[200:203], v[224:227], v[136:139]
    ds_read_b64_tr_b16 v[212:213], v238 offset:0
    v_mfma_f32_16x16x32_bf16 v[140:143], v[204:207], v[224:227], v[140:143]
    ds_read_b64_tr_b16 v[214:215], v238 offset:1792
    v_mfma_f32_16x16x32_bf16 v[144:147], v[208:211], v[224:227], v[144:147]
    ds_read_b128 v[184:187], v236 offset:2048
    v_mfma_f32_16x16x32_bf16 v[160:163], v[208:211], v[228:231], v[160:163]
    ds_read_b128 v[188:191], v236 offset:4096
    v_mfma_f32_16x16x32_bf16 v[156:159], v[204:207], v[228:231], v[156:159]
    ds_read_b128 v[192:195], v236 offset:6144
    v_mfma_f32_16x16x32_bf16 v[152:155], v[200:203], v[228:231], v[152:155]
    ds_read_b64_tr_b16 v[216:217], v238 offset:32
    v_mfma_f32_16x16x32_bf16 v[148:151], v[196:199], v[228:231], v[148:151]
    ds_read_b64_tr_b16 v[218:219], v238 offset:1824
    s_cmp_lg_u32 s59, 0
    v_mfma_f32_16x16x32_bf16 v[164:167], v[196:199], v[232:235], v[164:167]
    ds_read_b64_tr_b16 v[220:221], v238 offset:64
    v_mfma_f32_16x16x32_bf16 v[168:171], v[200:203], v[232:235], v[168:171]
    ds_read_b64_tr_b16 v[222:223], v238 offset:1856
    v_mfma_f32_16x16x32_bf16 v[172:175], v[204:207], v[232:235], v[172:175]
    ds_read_b64_tr_b16 v[224:225], v238 offset:96
    v_mfma_f32_16x16x32_bf16 v[176:179], v[208:211], v[232:235], v[176:179]
    ds_read_b64_tr_b16 v[226:227], v238 offset:1888
    s_cbranch_scc1 K1_loop
K1_epi:
    s_waitcnt vmcnt(0) lgkmcnt(0)
    v_lshlrev_b32 v2, 4, v1
    v_and_b32 v3, 0xf0, v2
    s_mul_i32 s24, s20, 7168
    v_add_u32 v216, s24, v2
    s_lshl_b32 s24, s20, 11
    s_add_u32 s24, s24, 147456
    v_add_u32 v217, s24, v2
    s_lshl_b32 s24, s20, 9
    s_add_u32 s25, s24, 159744
    v_lshl_add_u32 v218, v3, 1, s25
    v_and_b32 v219, 48, v1
    v_lshlrev_b32 v219, 1, v219
    s_add_u32 s25, s24, 161792
    v_lshl_add_u32 v236, v219, 2, s25
    ds_read_b128 v[244:247], v218
    ds_read_b128 v[248:251], v218 offset:16
    ds_read_b128 v[188:191], v219 offset:61440
    ds_read_b128 v[192:195], v219 offset:61456
    ds_read_b128 v[196:199], v219 offset:61568
    ds_read_b128 v[200:203], v219 offset:61584
    ds_read_b128 v[180:183], v216 offset:32768
    ds_read_b128 v[184:187], v216 offset:33792
    ds_read_b128 v[252:255], v3 offset:62336
    v_mov_b32 v237, v216
    v_mov_b32 v238, v217
    v_mov_b32 v0, v219
    s_mul_i32 s57, s21, 96
    s_add_u32 s57, s57, s22
    s_lshl_b32 s57, s57, 4
    s_lshl_b32 s25, s20, 2
    s_add_u32 s57, s57, s25
    s_lshl_b32 s57, s57, 10
    s_add_u32 s57, s57, 4194304
    s_lshl_b32 s59, s21, 4
    s_lshr_b32 s25, s22, 1
    s_add_u32 s59, s59, s25
    s_lshl_b32 s59, s59, 4
    s_lshl_b32 s25, s20, 2
    s_add_u32 s59, s59, s25
    s_and_b32 s25, s22, 1
    s_add_u32 s59, s59, s25
    s_lshl_b32 s59, s59, 10
    s_add_u32 s59, s59, 16777216
    s_lshl_b32 s58, s22, 11
    s_add_u32 s58, s58, 48300032
    s_waitcnt lgkmcnt(3)
    v_pk_fma_f32 v[228:229], v[248:249], v[188:189], v[192:193] op_sel:[0,0,0] op_sel_hi:[0,1,1]
    v_pk_fma_f32 v[4:5], v[244:245], v[4:5], v[228:229] op_sel:[0,0,0] op_sel_hi:[0,1,1]
    v_pk_mul_f32 v[228:229], v[4:5], v[4:5]
    v_pk_fma_f32 v[228:229], v[228:229], s[52:53], s[52:53] op_sel:[0,0,1] op_sel_hi:[1,0,1]
    v_pk_mul_f32 v[228:229], v[228:229], v[4:5]
    v_exp_f32 v232, v228
    v_exp_f32 v233, v229
    v_pk_fma_f32 v[230:231], v[248:249], v[190:191], v[194:195] op_sel:[0,0,0] op_sel_hi:[0,1,1]
    v_pk_fma_f32 v[6:7], v[244:245], v[6:7], v[230:231] op_sel:[0,0,0] op_sel_hi:[0,1,1]
    v_pk_mul_f32 v[230:231], v[6:7], v[6:7]
    v_pk_fma_f32 v[230:231], v[230:231], s[52:53], s[52:53] op_sel:[0,0,1] op_sel_hi:[1,0,1]
    v_pk_mul_f32 v[230:231], v[230:231], v[6:7]
    v_exp_f32 v234, v230
    v_exp_f32 v235, v231
    v_pk_add_f32 v[232:233], v[232:233], 1.0
    v_rcp_f32 v232, v232
    v_rcp_f32 v233, v233
    v_pk_add_f32 v[234:235], v[234:235], 1.0
    v_rcp_f32 v234, v234
    v_rcp_f32 v235, v235
    v_pk_mul_f32 v[4:5], v[4:5], v[232:233]
    v_pk_mul_f32 v[6:7], v[6:7], v[234:235]
    v_cvt_pk_bf16_f32 v220, v4, v5
    v_cvt_pk_bf16_f32 v221, v6, v7
    v_pk_fma_f32 v[228:229], v[248:249], v[196:197], v[200:201] op_sel:[0,0,0] op_sel_hi:[0,1,1]
    v_pk_fma_f32 v[20:21], v[244:245], v[20:21], v[228:229] op_sel:[0,0,0] op_sel_hi:[0,1,1]
    v_pk_mul_f32 v[228:229], v[20:21], v[20:21]
    v_pk_fma_f32 v[228:229], v[228:229], s[52:53], s[52:53] op_sel:[0,0,1] op_sel_hi:[1,0,1]
    v_pk_mul_f32 v[228:229], v[228:229], v[20:21]
    v_exp_f32 v232, v228
    v_exp_f32 v233, v229
    v_pk_fma_f32 v[230:231], v[248:249], v[198:199], v[202:203] op_sel:[0,0,0] op_sel_hi:[0,1,1]
    v_pk_fma_f32 v[22:23], v[244:245], v[22:23], v[230:231] op_sel:[0,0,0] op_sel_hi:[0,1,1]
    v_pk_mul_f32 v[230:231], v[22:23], v[22:23]
    v_pk_fma_f32 v[230:231], v[230:231], s[52:53], s[52:53] op_sel:[0,0,1] op_sel_hi:[1,0,1]
    v_pk_mul_f32 v[230:231], v[230:231], v[22:23]
    v_exp_f32 v234, v230
    v_exp_f32 v235, v231
    v_pk_add_f32 v[232:233], v[232:233], 1.0
    v_rcp_f32 v232, v232
    v_rcp_f32 v233, v233
    v_pk_add_f32 v[234:235], v[234:235], 1.0
    v_rcp_f32 v234, v234
    v_rcp_f32 v235, v235
    v_pk_mul_f32 v[20:21], v[20:21], v[232:233]
    v_pk_mul_f32 v[22:23], v[22:23], v[234:235]
    v_cvt_pk_bf16_f32 v222, v20, v21
    v_cvt_pk_bf16_f32 v223, v22, v23
    buffer_store_dwordx4 v[220:223], v2, s[8:11], s57 offen offset:0 sc1
    v_pk_fma_f32 v[228:229], v[248:249], v[188:189], v[192:193] op_sel:[1,0,0] op_sel_hi:[1,1,1]
    v_pk_fma_f32 v[8:9], v[244:245], v[8:9], v[228:229] op_sel:[1,0,0] op_sel_hi:[1,1,1]
    v_pk_mul_f32 v[228:229], v[8:9], v[8:9]
    v_pk_fma_f32 v[228:229], v[228:229], s[52:53], s[52:53] op_sel:[0,0,1] op_sel_hi:[1,0,1]
    v_pk_mul_f32 v[228:229], v[228:229], v[8:9]
    v_exp_f32 v232, v228
    v_exp_f32 v233, v229
    v_pk_fma_f32 v[230:231], v[248:249], v[190:191], v[194:195] op_sel:[1,0,0] op_sel_hi:[1,1,1]
    v_pk_fma_f32 v[10:11], v[244:245], v[10:11], v[230:231] op_sel:[1,0,0] op_sel_hi:[1,1,1]
    v_pk_mul_f32 v[230:231], v[10:11], v[10:11]
    v_pk_fma_f32 v[230:231], v[230:231], s[52:53], s[52:53] op_sel:[0,0,1] op_sel_hi:[1,0,1]
    v_pk_mul_f32 v[230:231], v[230:231], v[10:11]
    v_exp_f32 v234, v230
    v_exp_f32 v235, v231
    v_pk_add_f32 v[232:233], v[232:233], 1.0
    v_rcp_f32 v232, v232
    v_rcp_f32 v233, v233
    v_pk_add_f32 v[234:235], v[234:235], 1.0
    v_rcp_f32 v234, v234
    v_rcp_f32 v235, v235
    v_pk_mul_f32 v[8:9], v[8:9], v[232:233]
    v_pk_mul_f32 v[10:11], v[10:11], v[234:235]
    v_cvt_pk_bf16_f32 v224, v8, v9
    v_cvt_pk_bf16_f32 v225, v10, v11
    v_pk_fma_f32 v[228:229], v[248:249], v[196:197], v[200:201] op_sel:[1,0,0] op_sel_hi:[1,1,1]
    v_pk_fma_f32 v[24:25], v[244:245], v[24:25], v[228:229] op_sel:[1,0,0] op_sel_hi:[1,1,1]
    v_pk_mul_f32 v[228:229], v[24:25], v[24:25]
    v_pk_fma_f32 v[228:229], v[228:229], s[52:53], s[52:53] op_sel:[0,0,1] op_sel_hi:[1,0,1]
    v_pk_mul_f32 v[228:229], v[228:229], v[24:25]
    v_exp_f32 v232, v228
    v_exp_f32 v233, v229
    v_pk_fma_f32 v[230:231], v[248:249], v[198:199], v[202:203] op_sel:[1,0,0] op_sel_hi:[1,1,1]
    v_pk_fma_f32 v[26:27], v[244:245], v[26:27], v[230:231] op_sel:[1,0,0] op_sel_hi:[1,1,1]
    v_pk_mul_f32 v[230:231], v[26:27], v[26:27]
    v_pk_fma_f32 v[230:231], v[230:231], s[52:53], s[52:53] op_sel:[0,0,1] op_sel_hi:[1,0,1]
    v_pk_mul_f32 v[230:231], v[230:231], v[26:27]
    v_exp_f32 v234, v230
    v_exp_f32 v235, v231
    v_pk_add_f32 v[232:233], v[232:233], 1.0
    v_rcp_f32 v232, v232
    v_rcp_f32 v233, v233
    v_pk_add_f32 v[234:235], v[234:235], 1.0
    v_rcp_f32 v234, v234
    v_rcp_f32 v235, v235
    v_pk_mul_f32 v[24:25], v[24:25], v[232:233]
    v_pk_mul_f32 v[26:27], v[26:27], v[234:235]
    v_cvt_pk_bf16_f32 v226, v24, v25
    v_cvt_pk_bf16_f32 v227, v26, v27
    buffer_store_dwordx4 v[224:227], v2, s[8:11], s57 offen offset:1024 sc1
    v_pk_fma_f32 v[228:229], v[250:251], v[188:189], v[192:193] op_sel:[0,0,0] op_sel_hi:[0,1,1]
    v_pk_fma_f32 v[12:13], v[246:247], v[12:13], v[228:229] op_sel:[0,0,0] op_sel_hi:[0,1,1]
    v_pk_mul_f32 v[228:229], v[12:13], v[12:13]
    v_pk_fma_f32 v[228:229], v[228:229], s[52:53], s[52:53] op_sel:[0,0,1] op_sel_hi:[1,0,1]
    v_pk_mul_f32 v[228:229], v[228:229], v[12:13]
    v_exp_f32 v232, v228
    v_exp_f32 v233, v229
    v_pk_fma_f32 v[230:231], v[250:251], v[190:191], v[194:195] op_sel:[0,0,0] op_sel_hi:[0,1,1]
    v_pk_fma_f32 v[14:15], v[246:247], v[14:15], v[230:231] op_sel:[0,0,0] op_sel_hi:[0,1,1]
    v_pk_mul_f32 v[230:231], v[14:15], v[14:15]
    v_pk_fma_f32 v[230:231], v[230:231], s[52:53], s[52:53] op_sel:[0,0,1] op_sel_hi:[1,0,1]
    v_pk_mul_f32 v[230:231], v[230:231], v[14:15]
    v_exp_f32 v234, v230
    v_exp_f32 v235, v231
    v_pk_add_f32 v[232:233], v[232:233], 1.0
    v_rcp_f32 v232, v232
    v_rcp_f32 v233, v233
    v_pk_add_f32 v[234:235], v[234:235], 1.0
    v_rcp_f32 v234, v234
    v_rcp_f32 v235, v235
    v_pk_mul_f32 v[12:13], v[12:13], v[232:233]
    v_pk_mul_f32 v[14:15], v[14:15], v[234:235]
    v_cvt_pk_bf16_f32 v220, v12, v13
    v_cvt_pk_bf16_f32 v221, v14, v15
    v_pk_fma_f32 v[228:229], v[250:251], v[196:197], v[200:201] op_sel:[0,0,0] op_sel_hi:[0,1,1]
    v_pk_fma_f32 v[28:29], v[246:247], v[28:29], v[228:229] op_sel:[0,0,0] op_sel_hi:[0,1,1]
    v_pk_mul_f32 v[228:229], v[28:29], v[28:29]
    v_pk_fma_f32 v[228:229], v[228:229], s[52:53], s[52:53] op_sel:[0,0,1] op_sel_hi:[1,0,1]
    v_pk_mul_f32 v[228:229], v[228:229], v[28:29]
    v_exp_f32 v232, v228
    v_exp_f32 v233, v229
    v_pk_fma_f32 v[230:231], v[250:251], v[198:199], v[202:203] op_sel:[0,0,0] op_sel_hi:[0,1,1]
    v_pk_fma_f32 v[30:31], v[246:247], v[30:31], v[230:231] op_sel:[0,0,0] op_sel_hi:[0,1,1]
    v_pk_mul_f32 v[230:231], v[30:31], v[30:31]
    v_pk_fma_f32 v[230:231], v[230:231], s[52:53], s[52:53] op_sel:[0,0,1] op_sel_hi:[1,0,1]
    v_pk_mul_f32 v[230:231], v[230:231], v[30:31]
    v_exp_f32 v234, v230
    v_exp_f32 v235, v231
    v_pk_add_f32 v[232:233], v[232:233], 1.0
    v_rcp_f32 v232, v232
    v_rcp_f32 v233, v233
    v_pk_add_f32 v[234:235], v[234:235], 1.0
    v_rcp_f32 v234, v234
    v_rcp_f32 v235, v235
    v_pk_mul_f32 v[28:29], v[28:29], v[232:233]
    v_pk_mul_f32 v[30:31], v[30:31], v[234:235]
    v_cvt_pk_bf16_f32 v222, v28, v29
    v_cvt_pk_bf16_f32 v223, v30, v31
    buffer_store_dwordx4 v[220:223], v2, s[8:11], s57 offen offset:2048 sc1
    v_pk_fma_f32 v[228:229], v[250:251], v[188:189], v[192:193] op_sel:[1,0,0] op_sel_hi:[1,1,1]
    v_pk_fma_f32 v[16:17], v[246:247], v[16:17], v[228:229] op_sel:[1,0,0] op_sel_hi:[1,1,1]
    v_pk_mul_f32 v[228:229], v[16:17], v[16:17]
    v_pk_fma_f32 v[228:229], v[228:229], s[52:53], s[52:53] op_sel:[0,0,1] op_sel_hi:[1,0,1]
    v_pk_mul_f32 v[228:229], v[228:229], v[16:17]
    v_exp_f32 v232, v228
    v_exp_f32 v233, v229
    v_pk_fma_f32 v[230:231], v[250:251], v[190:191], v[194:195] op_sel:[1,0,0] op_sel_hi:[1,1,1]
    v_pk_fma_f32 v[18:19], v[246:247], v[18:19], v[230:231] op_sel:[1,0,0] op_sel_hi:[1,1,1]
    v_pk_mul_f32 v[230:231], v[18:19], v[18:19]
    v_pk_fma_f32 v[230:231], v[230:231], s[52:53], s[52:53] op_sel:[0,0,1] op_sel_hi:[1,0,1]
    v_pk_mul_f32 v[230:231], v[230:231], v[18:19]
    v_exp_f32 v234, v230
    v_exp_f32 v235, v231
    v_pk_add_f32 v[232:233], v[232:233], 1.0
    v_rcp_f32 v232, v232
    v_rcp_f32 v233, v233
    v_pk_add_f32 v[234:235], v[234:235], 1.0
    v_rcp_f32 v234, v234
    v_rcp_f32 v235, v235
    v_pk_mul_f32 v[16:17], v[16:17], v[232:233]
    v_pk_mul_f32 v[18:19], v[18:19], v[234:235]
    v_cvt_pk_bf16_f32 v224, v16, v17
    v_cvt_pk_bf16_f32 v225, v18, v19
    v_pk_fma_f32 v[228:229], v[250:251], v[196:197], v[200:201] op_sel:[1,0,0] op_sel_hi:[1,1,1]
    v_pk_fma_f32 v[32:33], v[246:247], v[32:33], v[228:229] op_sel:[1,0,0] op_sel_hi:[1,1,1]
    v_pk_mul_f32 v[228:229], v[32:33], v[32:33]
    v_pk_fma_f32 v[228:229], v[228:229], s[52:53], s[52:53] op_sel:[0,0,1] op_sel_hi:[1,0,1]
    v_pk_mul_f32 v[228:229], v[228:229], v[32:33]
    v_exp_f32 v232, v228
    v_exp_f32 v233, v229
    v_pk_fma_f32 v[230:231], v[250:251], v[198:199], v[202:203] op_sel:[1,0,0] op_sel_hi:[1,1,1]
    v_pk_fma_f32 v[34:35], v[246:247], v[34:35], v[230:231] op_sel:[1,0,0] op_sel_hi:[1,1,1]
    v_pk_mul_f32 v[230:231], v[34:35], v[34:35]
    v_pk_fma_f32 v[230:231], v[230:231], s[52:53], s[52:53] op_sel:[0,0,1] op_sel_hi:[1,0,1]
    v_pk_mul_f32 v[230:231], v[230:231], v[34:35]
    v_exp_f32 v234, v230
    v_exp_f32 v235, v231
    v_pk_add_f32 v[232:233], v[232:233], 1.0
    v_rcp_f32 v232, v232
    v_rcp_f32 v233, v233
    v_pk_add_f32 v[234:235], v[234:235], 1.0
    v_rcp_f32 v234, v234
    v_rcp_f32 v235, v235
    v_pk_mul_f32 v[32:33], v[32:33], v[232:233]
    v_pk_mul_f32 v[34:35], v[34:35], v[234:235]
    v_cvt_pk_bf16_f32 v226, v32, v33
    v_cvt_pk_bf16_f32 v227, v34, v35
    buffer_store_dwordx4 v[224:227], v2, s[8:11], s57 offen offset:3072 sc1
    s_add_u32 s57, s57, 524288
    ds_read_b128 v[12:15], v0 offset:61696
    ds_read_b128 v[16:19], v0 offset:61712
    ds_read_b128 v[28:31], v0 offset:61824
    ds_read_b128 v[32:35], v0 offset:61840
    ds_read_b128 v[196:199], v237 offset:34816
    ds_read_b128 v[200:203], v237 offset:35840
    ds_read_b128 v[188:191], v238 offset:0
    ds_read_b128 v[192:195], v238 offset:1024
    ds_read_b128 v[220:223], v236 offset:0
    s_nop 1
    ds_read_b128 v[224:227], v236 offset:16
    ds_read_b128 v[228:231], v236 offset:32
    ds_read_b128 v[232:235], v236 offset:48
    s_waitcnt lgkmcnt(2)
    v_pk_mul_f32 v[212:213], v[252:253], v[224:225] op_sel:[0,0] op_sel_hi:[0,1]
    v_pk_fma_f32 v[116:117], v[116:117], v[220:221], v[212:213]
    v_pk_mul_f32 v[214:215], v[252:253], v[226:227] op_sel:[0,0] op_sel_hi:[0,1]
    v_pk_fma_f32 v[118:119], v[118:119], v[222:223], v[214:215]
    v_pk_mul_f32 v[212:213], v[252:253], v[224:225] op_sel:[1,0] op_sel_hi:[1,1]
    v_pk_fma_f32 v[132:133], v[132:133], v[220:221], v[212:213]
    v_pk_mul_f32 v[214:215], v[252:253], v[226:227] op_sel:[1,0] op_sel_hi:[1,1]
    v_pk_fma_f32 v[134:135], v[134:135], v[222:223], v[214:215]
    v_pk_mul_f32 v[212:213], v[254:255], v[224:225] op_sel:[0,0] op_sel_hi:[0,1]
    v_pk_fma_f32 v[148:149], v[148:149], v[220:221], v[212:213]
    v_pk_mul_f32 v[214:215], v[254:255], v[226:227] op_sel:[0,0] op_sel_hi:[0,1]
    v_pk_fma_f32 v[150:151], v[150:151], v[222:223], v[214:215]
    v_pk_mul_f32 v[212:213], v[254:255], v[224:225] op_sel:[1,0] op_sel_hi:[1,1]
    v_pk_fma_f32 v[164:165], v[164:165], v[220:221], v[212:213]
    v_pk_mul_f32 v[214:215], v[254:255], v[226:227] op_sel:[1,0] op_sel_hi:[1,1]
    v_pk_fma_f32 v[166:167], v[166:167], v[222:223], v[214:215]
    ds_read_b128 v[220:223], v236 offset:64
    ds_read_b128 v[224:227], v236 offset:80
    s_waitcnt lgkmcnt(2)
    v_pk_mul_f32 v[212:213], v[252:253], v[232:233] op_sel:[0,0] op_sel_hi:[0,1]
    v_pk_fma_f32 v[120:121], v[120:121], v[228:229], v[212:213]
    v_pk_mul_f32 v[214:215], v[252:253], v[234:235] op_sel:[0,0] op_sel_hi:[0,1]
    v_pk_fma_f32 v[122:123], v[122:123], v[230:231], v[214:215]
    v_pk_mul_f32 v[212:213], v[252:253], v[232:233] op_sel:[1,0] op_sel_hi:[1,1]
    v_pk_fma_f32 v[136:137], v[136:137], v[228:229], v[212:213]
    v_pk_mul_f32 v[214:215], v[252:253], v[234:235] op_sel:[1,0] op_sel_hi:[1,1]
    v_pk_fma_f32 v[138:139], v[138:139], v[230:231], v[214:215]
    v_pk_mul_f32 v[212:213], v[254:255], v[232:233] op_sel:[0,0] op_sel_hi:[0,1]
    v_pk_fma_f32 v[152:153], v[152:153], v[228:229], v[212:213]
    v_pk_mul_f32 v[214:215], v[254:255], v[234:235] op_sel:[0,0] op_sel_hi:[0,1]
    v_pk_fma_f32 v[154:155], v[154:155], v[230:231], v[214:215]
    v_pk_mul_f32 v[212:213], v[254:255], v[232:233] op_sel:[1,0] op_sel_hi:[1,1]
    v_pk_fma_f32 v[168:169], v[168:169], v[228:229], v[212:213]
    v_pk_mul_f32 v[214:215], v[254:255], v[234:235] op_sel:[1,0] op_sel_hi:[1,1]
    v_pk_fma_f32 v[170:171], v[170:171], v[230:231], v[214:215]
    ds_read_b128 v[228:231], v236 offset:96
    ds_read_b128 v[232:235], v236 offset:112
    s_waitcnt lgkmcnt(2)
    v_pk_mul_f32 v[212:213], v[252:253], v[224:225] op_sel:[0,0] op_sel_hi:[0,1]
    v_pk_fma_f32 v[124:125], v[124:125], v[220:221], v[212:213]
    v_pk_mul_f32 v[214:215], v[252:253], v[226:227] op_sel:[0,0] op_sel_hi:[0,1]
    v_pk_fma_f32 v[126:127], v[126:127], v[222:223], v[214:215]
    v_pk_mul_f32 v[212:213], v[252:253], v[224:225] op_sel:[1,0] op_sel_hi:[1,1]
    v_pk_fma_f32 v[140:141], v[140:141], v[220:221], v[212:213]
    v_pk_mul_f32 v[214:215], v[252:253], v[226:227] op_sel:[1,0] op_sel_hi:[1,1]
    v_pk_fma_f32 v[142:143], v[142:143], v[222:223], v[214:215]
    v_pk_mul_f32 v[212:213], v[254:255], v[224:225] op_sel:[0,0] op_sel_hi:[0,1]
    v_pk_fma_f32 v[156:157], v[156:157], v[220:221], v[212:213]
    v_pk_mul_f32 v[214:215], v[254:255], v[226:227] op_sel:[0,0] op_sel_hi:[0,1]
    v_pk_fma_f32 v[158:159], v[158:159], v[222:223], v[214:215]
    v_pk_mul_f32 v[212:213], v[254:255], v[224:225] op_sel:[1,0] op_sel_hi:[1,1]
    v_pk_fma_f32 v[172:173], v[172:173], v[220:221], v[212:213]
    v_pk_mul_f32 v[214:215], v[254:255], v[226:227] op_sel:[1,0] op_sel_hi:[1,1]
    v_pk_fma_f32 v[174:175], v[174:175], v[222:223], v[214:215]
    s_waitcnt lgkmcnt(0)
    v_pk_mul_f32 v[212:213], v[252:253], v[232:233] op_sel:[0,0] op_sel_hi:[0,1]
    v_pk_fma_f32 v[128:129], v[128:129], v[228:229], v[212:213]
    v_pk_mul_f32 v[214:215], v[252:253], v[234:235] op_sel:[0,0] op_sel_hi:[0,1]
    v_pk_fma_f32 v[130:131], v[130:131], v[230:231], v[214:215]
    v_pk_mul_f32 v[212:213], v[252:253], v[232:233] op_sel:[1,0] op_sel_hi:[1,1]
    v_pk_fma_f32 v[144:145], v[144:145], v[228:229], v[212:213]
    v_pk_mul_f32 v[214:215], v[252:253], v[234:235] op_sel:[1,0] op_sel_hi:[1,1]
    v_pk_fma_f32 v[146:147], v[146:147], v[230:231], v[214:215]
    v_pk_mul_f32 v[212:213], v[254:255], v[232:233] op_sel:[0,0] op_sel_hi:[0,1]
    v_pk_fma_f32 v[160:161], v[160:161], v[228:229], v[212:213]
    v_pk_mul_f32 v[214:215], v[254:255], v[234:235] op_sel:[0,0] op_sel_hi:[0,1]
    v_pk_fma_f32 v[162:163], v[162:163], v[230:231], v[214:215]
    v_pk_mul_f32 v[212:213], v[254:255], v[232:233] op_sel:[1,0] op_sel_hi:[1,1]
    v_pk_fma_f32 v[176:177], v[176:177], v[228:229], v[212:213]
    v_pk_mul_f32 v[214:215], v[254:255], v[234:235] op_sel:[1,0] op_sel_hi:[1,1]
    v_pk_fma_f32 v[178:179], v[178:179], v[230:231], v[214:215]
    v_pk_fma_f32 v[212:213], v[148:149], v[180:181], v[118:119] op_sel_hi:[1,0,1] neg_lo:[1,0,0] neg_hi:[1,0,0]
    v_pk_fma_f32 v[214:215], v[116:117], v[180:181], v[150:151] op_sel_hi:[1,0,1]
    v_pk_fma_f32 v[204:205], v[180:181], v[116:117], v[212:213] op_sel:[1,0,0] op_sel_hi:[1,1,1]
    v_pk_fma_f32 v[208:209], v[180:181], v[148:149], v[214:215] op_sel:[1,0,0] op_sel_hi:[1,1,1]
    v_pk_fma_f32 v[212:213], v[208:209], v[180:181], v[120:121] op_sel_hi:[1,0,1] neg_lo:[1,0,0] neg_hi:[1,0,0]
    v_pk_fma_f32 v[214:215], v[204:205], v[180:181], v[152:153] op_sel_hi:[1,0,1]
    v_pk_fma_f32 v[204:205], v[180:181], v[204:205], v[212:213] op_sel:[1,0,0] op_sel_hi:[1,1,1]
    v_pk_fma_f32 v[208:209], v[180:181], v[208:209], v[214:215] op_sel:[1,0,0] op_sel_hi:[1,1,1]
    v_pk_fma_f32 v[212:213], v[208:209], v[180:181], v[122:123] op_sel_hi:[1,0,1] neg_lo:[1,0,0] neg_hi:[1,0,0]
    v_pk_fma_f32 v[214:215], v[204:205], v[180:181], v[154:155] op_sel_hi:[1,0,1]
    v_pk_fma_f32 v[204:205], v[180:181], v[204:205], v[212:213] op_sel:[1,0,0] op_sel_hi:[1,1,1]
    v_pk_fma_f32 v[208:209], v[180:181], v[208:209], v[214:215] op_sel:[1,0,0] op_sel_hi:[1,1,1]
    v_pk_fma_f32 v[212:213], v[208:209], v[180:181], v[124:125] op_sel_hi:[1,0,1] neg_lo:[1,0,0] neg_hi:[1,0,0]
    v_pk_fma_f32 v[214:215], v[204:205], v[180:181], v[156:157] op_sel_hi:[1,0,1]
    v_pk_fma_f32 v[204:205], v[180:181], v[204:205], v[212:213] op_sel:[1,0,0] op_sel_hi:[1,1,1]
    v_pk_fma_f32 v[208:209], v[180:181], v[208:209], v[214:215] op_sel:[1,0,0] op_sel_hi:[1,1,1]
    v_pk_fma_f32 v[212:213], v[208:209], v[180:181], v[126:127] op_sel_hi:[1,0,1] neg_lo:[1,0,0] neg_hi:[1,0,0]
    v_pk_fma_f32 v[214:215], v[204:205], v[180:181], v[158:159] op_sel_hi:[1,0,1]
    v_pk_fma_f32 v[204:205], v[180:181], v[204:205], v[212:213] op_sel:[1,0,0] op_sel_hi:[1,1,1]
    v_pk_fma_f32 v[208:209], v[180:181], v[208:209], v[214:215] op_sel:[1,0,0] op_sel_hi:[1,1,1]
    v_pk_fma_f32 v[212:213], v[208:209], v[180:181], v[128:129] op_sel_hi:[1,0,1] neg_lo:[1,0,0] neg_hi:[1,0,0]
    v_pk_fma_f32 v[214:215], v[204:205], v[180:181], v[160:161] op_sel_hi:[1,0,1]
    v_pk_fma_f32 v[204:205], v[180:181], v[204:205], v[212:213] op_sel:[1,0,0] op_sel_hi:[1,1,1]
    v_pk_fma_f32 v[208:209], v[180:181], v[208:209], v[214:215] op_sel:[1,0,0] op_sel_hi:[1,1,1]
    v_pk_fma_f32 v[212:213], v[208:209], v[180:181], v[130:131] op_sel_hi:[1,0,1] neg_lo:[1,0,0] neg_hi:[1,0,0]
    v_pk_fma_f32 v[214:215], v[204:205], v[180:181], v[162:163] op_sel_hi:[1,0,1]
    v_pk_fma_f32 v[204:205], v[180:181], v[204:205], v[212:213] op_sel:[1,0,0] op_sel_hi:[1,1,1]
    v_pk_fma_f32 v[208:209], v[180:181], v[208:209], v[214:215] op_sel:[1,0,0] op_sel_hi:[1,1,1]
    v_fma_f32 v216, v204, v185, v205
    v_fma_f32 v217, v208, v185, v209
    v_fma_f32 v216, -v208, v184, v216
    v_fma_f32 v217, v204, v184, v217
    v_pk_fma_f32 v[212:213], v[164:165], v[182:183], v[134:135] op_sel_hi:[1,0,1] neg_lo:[1,0,0] neg_hi:[1,0,0]
    v_pk_fma_f32 v[214:215], v[132:133], v[182:183], v[166:167] op_sel_hi:[1,0,1]
    v_pk_fma_f32 v[206:207], v[182:183], v[132:133], v[212:213] op_sel:[1,0,0] op_sel_hi:[1,1,1]
    v_pk_fma_f32 v[210:211], v[182:183], v[164:165], v[214:215] op_sel:[1,0,0] op_sel_hi:[1,1,1]
    v_pk_fma_f32 v[212:213], v[210:211], v[182:183], v[136:137] op_sel_hi:[1,0,1] neg_lo:[1,0,0] neg_hi:[1,0,0]
    v_pk_fma_f32 v[214:215], v[206:207], v[182:183], v[168:169] op_sel_hi:[1,0,1]
    v_pk_fma_f32 v[206:207], v[182:183], v[206:207], v[212:213] op_sel:[1,0,0] op_sel_hi:[1,1,1]
    v_pk_fma_f32 v[210:211], v[182:183], v[210:211], v[214:215] op_sel:[1,0,0] op_sel_hi:[1,1,1]
    v_pk_fma_f32 v[212:213], v[210:211], v[182:183], v[138:139] op_sel_hi:[1,0,1] neg_lo:[1,0,0] neg_hi:[1,0,0]
    v_pk_fma_f32 v[214:215], v[206:207], v[182:183], v[170:171] op_sel_hi:[1,0,1]
    v_pk_fma_f32 v[206:207], v[182:183], v[206:207], v[212:213] op_sel:[1,0,0] op_sel_hi:[1,1,1]
    v_pk_fma_f32 v[210:211], v[182:183], v[210:211], v[214:215] op_sel:[1,0,0] op_sel_hi:[1,1,1]
    v_pk_fma_f32 v[212:213], v[210:211], v[182:183], v[140:141] op_sel_hi:[1,0,1] neg_lo:[1,0,0] neg_hi:[1,0,0]
    v_pk_fma_f32 v[214:215], v[206:207], v[182:183], v[172:173] op_sel_hi:[1,0,1]
    v_pk_fma_f32 v[206:207], v[182:183], v[206:207], v[212:213] op_sel:[1,0,0] op_sel_hi:[1,1,1]
    v_pk_fma_f32 v[210:211], v[182:183], v[210:211], v[214:215] op_sel:[1,0,0] op_sel_hi:[1,1,1]
    v_pk_fma_f32 v[212:213], v[210:211], v[182:183], v[142:143] op_sel_hi:[1,0,1] neg_lo:[1,0,0] neg_hi:[1,0,0]
    v_pk_fma_f32 v[214:215], v[206:207], v[182:183], v[174:175] op_sel_hi:[1,0,1]
    v_pk_fma_f32 v[206:207], v[182:183], v[206:207], v[212:213] op_sel:[1,0,0] op_sel_hi:[1,1,1]
    v_pk_fma_f32 v[210:211], v[182:183], v[210:211], v[214:215] op_sel:[1,0,0] op_sel_hi:[1,1,1]
    v_pk_fma_f32 v[212:213], v[210:211], v[182:183], v[144:145] op_sel_hi:[1,0,1] neg_lo:[1,0,0] neg_hi:[1,0,0]
    v_pk_fma_f32 v[214:215], v[206:207], v[182:183], v[176:177] op_sel_hi:[1,0,1]
    v_pk_fma_f32 v[206:207], v[182:183], v[206:207], v[212:213] op_sel:[1,0,0] op_sel_hi:[1,1,1]
    v_pk_fma_f32 v[210:211], v[182:183], v[210:211], v[214:215] op_sel:[1,0,0] op_sel_hi:[1,1,1]
    v_pk_fma_f32 v[212:213], v[210:211], v[182:183], v[146:147] op_sel_hi:[1,0,1] neg_lo:[1,0,0] neg_hi:[1,0,0]
    v_pk_fma_f32 v[214:215], v[206:207], v[182:183], v[178:179] op_sel_hi:[1,0,1]
    v_pk_fma_f32 v[206:207], v[182:183], v[206:207], v[212:213] op_sel:[1,0,0] op_sel_hi:[1,1,1]
    v_pk_fma_f32 v[210:211], v[182:183], v[210:211], v[214:215] op_sel:[1,0,0] op_sel_hi:[1,1,1]
    v_fma_f32 v218, v206, v187, v207
    v_fma_f32 v219, v210, v187, v211
    v_fma_f32 v218, -v210, v186, v218
    v_fma_f32 v219, v206, v186, v219
    s_lshl_b32 s91, s21, 7
    s_add_u32 s91, s91, s22
    s_lshl_b32 s91, s91, 2
    s_add_u32 s91, s91, s20
    s_lshl_b32 s91, s91, 2
    s_add_u32 s91, s91, 48431104
    v_mov_b32 v212, 1
    v_mov_b32 v214, 0
    s_waitcnt vmcnt(0)
    s_mov_b64 exec, 1
    buffer_store_dword v212, v214, s[8:11], s91 offen offset:1024 sc1
    s_mov_b64 exec, -1
    s_nop 0
    s_lshl_b32 s24, s20, 10
    s_add_u32 s24, s24, 65536
    v_add_u32 v212, s24, v2
    v_add_u32 v214, s24, v3
    ds_write_b128 v212, v[216:219]
    ds_read_b128 v[220:223], v214 offset:0
    ds_read_b128 v[224:227], v214 offset:256
    ds_read_b128 v[228:231], v214 offset:512
    ds_read_b128 v[232:235], v214 offset:768
    s_waitcnt lgkmcnt(0)
    v_pk_fma_f32 v[224:225], v[188:189], v[220:221], v[224:225] op_sel:[1,0,0] op_sel_hi:[1,1,1]
    v_pk_fma_f32 v[224:225], v[220:221], v[188:189], v[224:225] op_sel:[1,0,0] op_sel_hi:[0,0,1] neg_lo:[1,0,0]
    v_pk_fma_f32 v[226:227], v[190:191], v[222:223], v[226:227] op_sel:[1,0,0] op_sel_hi:[1,1,1]
    v_pk_fma_f32 v[226:227], v[222:223], v[190:191], v[226:227] op_sel:[1,0,0] op_sel_hi:[0,0,1] neg_lo:[1,0,0]
    v_pk_fma_f32 v[228:229], v[188:189], v[224:225], v[228:229] op_sel:[1,0,0] op_sel_hi:[1,1,1]
    v_pk_fma_f32 v[228:229], v[224:225], v[188:189], v[228:229] op_sel:[1,0,0] op_sel_hi:[0,0,1] neg_lo:[1,0,0]
    v_pk_fma_f32 v[230:231], v[190:191], v[226:227], v[230:231] op_sel:[1,0,0] op_sel_hi:[1,1,1]
    v_pk_fma_f32 v[230:231], v[226:227], v[190:191], v[230:231] op_sel:[1,0,0] op_sel_hi:[0,0,1] neg_lo:[1,0,0]
    v_pk_fma_f32 v[232:233], v[188:189], v[228:229], v[232:233] op_sel:[1,0,0] op_sel_hi:[1,1,1]
    v_pk_fma_f32 v[232:233], v[228:229], v[188:189], v[232:233] op_sel:[1,0,0] op_sel_hi:[0,0,1] neg_lo:[1,0,0]
    v_pk_fma_f32 v[234:235], v[190:191], v[230:231], v[234:235] op_sel:[1,0,0] op_sel_hi:[1,1,1]
    v_pk_fma_f32 v[234:235], v[230:231], v[190:191], v[234:235] op_sel:[1,0,0] op_sel_hi:[0,0,1] neg_lo:[1,0,0]
    v_cndmask_b32 v236, 0, v220, s[42:43]
    v_cndmask_b32 v237, 0, v221, s[42:43]
    v_cndmask_b32 v238, 0, v222, s[42:43]
    v_cndmask_b32 v239, 0, v223, s[42:43]
    v_cndmask_b32 v236, v236, v224, s[44:45]
    v_cndmask_b32 v237, v237, v225, s[44:45]
    v_cndmask_b32 v238, v238, v226, s[44:45]
    v_cndmask_b32 v239, v239, v227, s[44:45]
    v_cndmask_b32 v236, v236, v228, s[46:47]
    v_cndmask_b32 v237, v237, v229, s[46:47]
    v_cndmask_b32 v238, v238, v230, s[46:47]
    v_cndmask_b32 v239, v239, v231, s[46:47]
    s_lshl_b32 s24, s20, 8
    s_add_u32 s24, s24, 69632
    v_add_u32 v214, s24, v3
    ds_write_b128 v214, v[232:235]
    v_add_u32 v214, 69632, v3
    v_mov_b32 v240, 0
    v_mov_b32 v241, 0
    v_mov_b32 v242, 0
    v_mov_b32 v243, 0
    s_waitcnt lgkmcnt(0)
    s_barrier
    ds_read_b128 v[220:223], v214 offset:0
    ds_read_b128 v[224:227], v214 offset:256
    ds_read_b128 v[228:231], v214 offset:512
    s_cmp_le_u32 s20, 0
    s_cbranch_scc1 K1_chain_2
    s_waitcnt lgkmcnt(2)
    v_pk_fma_f32 v[220:221], v[192:193], v[240:241], v[220:221] op_sel:[1,0,0] op_sel_hi:[1,1,1]
    v_pk_fma_f32 v[220:221], v[240:241], v[192:193], v[220:221] op_sel:[1,0,0] op_sel_hi:[0,0,1] neg_lo:[1,0,0]
    v_pk_fma_f32 v[222:223], v[194:195], v[242:243], v[222:223] op_sel:[1,0,0] op_sel_hi:[1,1,1]
    v_pk_fma_f32 v[222:223], v[242:243], v[194:195], v[222:223] op_sel:[1,0,0] op_sel_hi:[0,0,1] neg_lo:[1,0,0]
    v_pk_mov_b32 v[240:241], v[220:221], v[220:221] op_sel:[0,1]
    v_pk_mov_b32 v[242:243], v[222:223], v[222:223] op_sel:[0,1]
    s_cmp_le_u32 s20, 1
    s_cbranch_scc1 K1_chain_2
    s_waitcnt lgkmcnt(1)
    v_pk_fma_f32 v[224:225], v[192:193], v[240:241], v[224:225] op_sel:[1,0,0] op_sel_hi:[1,1,1]
    v_pk_fma_f32 v[224:225], v[240:241], v[192:193], v[224:225] op_sel:[1,0,0] op_sel_hi:[0,0,1] neg_lo:[1,0,0]
    v_pk_fma_f32 v[226:227], v[194:195], v[242:243], v[226:227] op_sel:[1,0,0] op_sel_hi:[1,1,1]
    v_pk_fma_f32 v[226:227], v[242:243], v[194:195], v[226:227] op_sel:[1,0,0] op_sel_hi:[0,0,1] neg_lo:[1,0,0]
    v_pk_mov_b32 v[240:241], v[224:225], v[224:225] op_sel:[0,1]
    v_pk_mov_b32 v[242:243], v[226:227], v[226:227] op_sel:[0,1]
    s_cmp_le_u32 s20, 2
    s_cbranch_scc1 K1_chain_2
    s_waitcnt lgkmcnt(0)
    v_pk_fma_f32 v[228:229], v[192:193], v[240:241], v[228:229] op_sel:[1,0,0] op_sel_hi:[1,1,1]
    v_pk_fma_f32 v[228:229], v[240:241], v[192:193], v[228:229] op_sel:[1,0,0] op_sel_hi:[0,0,1] neg_lo:[1,0,0]
    v_pk_fma_f32 v[230:231], v[194:195], v[242:243], v[230:231] op_sel:[1,0,0] op_sel_hi:[1,1,1]
    v_pk_fma_f32 v[230:231], v[242:243], v[194:195], v[230:231] op_sel:[1,0,0] op_sel_hi:[0,0,1] neg_lo:[1,0,0]
    v_pk_mov_b32 v[240:241], v[228:229], v[228:229] op_sel:[0,1]
    v_pk_mov_b32 v[242:243], v[230:231], v[230:231] op_sel:[0,1]
    v_pk_fma_f32 v[232:233], v[192:193], v[240:241], v[232:233] op_sel:[1,0,0] op_sel_hi:[1,1,1]
    v_pk_fma_f32 v[232:233], v[240:241], v[192:193], v[232:233] op_sel:[1,0,0] op_sel_hi:[0,0,1] neg_lo:[1,0,0]
    v_pk_fma_f32 v[234:235], v[194:195], v[242:243], v[234:235] op_sel:[1,0,0] op_sel_hi:[1,1,1]
    v_pk_fma_f32 v[234:235], v[242:243], v[194:195], v[234:235] op_sel:[1,0,0] op_sel_hi:[0,0,1] neg_lo:[1,0,0]
    s_mov_b32 s24, 0xfffffffe
    v_min_u32 v232, s24, v232
    v_min_u32 v233, s24, v233
    v_min_u32 v234, s24, v234
    v_min_u32 v235, s24, v235
    s_lshl_b32 s24, s22, 3
    s_add_u32 s24, s24, s21
    s_lshl_b32 s24, s24, 8
    s_add_u32 s24, s24, 48300032
    s_mov_b64 exec, 0xffff
    buffer_store_dwordx4 v[232:235], v2, s[8:11], s24 offen sc1
    s_mov_b64 exec, -1
K1_chain_2:
    s_waitcnt lgkmcnt(0)
    v_pk_fma_f32 v[236:237], v[196:197], v[240:241], v[236:237] op_sel:[1,0,0] op_sel_hi:[1,1,1]
    v_pk_fma_f32 v[236:237], v[240:241], v[196:197], v[236:237] op_sel:[1,0,0] op_sel_hi:[0,0,1] neg_lo:[1,0,0]
    v_pk_fma_f32 v[238:239], v[198:199], v[242:243], v[238:239] op_sel:[1,0,0] op_sel_hi:[1,1,1]
    v_pk_fma_f32 v[238:239], v[242:243], v[198:199], v[238:239] op_sel:[1,0,0] op_sel_hi:[0,0,1] neg_lo:[1,0,0]
    s_mul_i32 s24, s20, 7168
    v_add_u32 v216, s24, v2
    ds_read_b128 v[188:191], v216 offset:36864
    s_waitcnt lgkmcnt(0)
    v_pk_fma_f32 v[228:229], v[248:249], v[12:13], v[16:17] op_sel:[0,0,0] op_sel_hi:[0,1,1]
    v_pk_fma_f32 v[36:37], v[244:245], v[36:37], v[228:229] op_sel:[0,0,0] op_sel_hi:[0,1,1]
    v_pk_mul_f32 v[228:229], v[36:37], v[36:37]
    v_pk_fma_f32 v[228:229], v[228:229], s[52:53], s[52:53] op_sel:[0,0,1] op_sel_hi:[1,0,1]
    v_pk_mul_f32 v[228:229], v[228:229], v[36:37]
    v_exp_f32 v232, v228
    v_exp_f32 v233, v229
    v_pk_fma_f32 v[230:231], v[248:249], v[14:15], v[18:19] op_sel:[0,0,0] op_sel_hi:[0,1,1]
    v_pk_fma_f32 v[38:39], v[244:245], v[38:39], v[230:231] op_sel:[0,0,0] op_sel_hi:[0,1,1]
    v_pk_mul_f32 v[230:231], v[38:39], v[38:39]
    v_pk_fma_f32 v[230:231], v[230:231], s[52:53], s[52:53] op_sel:[0,0,1] op_sel_hi:[1,0,1]
    v_pk_mul_f32 v[230:231], v[230:231], v[38:39]
    v_exp_f32 v234, v230
    v_exp_f32 v235, v231
    v_pk_add_f32 v[232:233], v[232:233], 1.0
    v_rcp_f32 v232, v232
    v_rcp_f32 v233, v233
    v_pk_add_f32 v[234:235], v[234:235], 1.0
    v_rcp_f32 v234, v234
    v_rcp_f32 v235, v235
    v_pk_mul_f32 v[36:37], v[36:37], v[232:233]
    v_pk_mul_f32 v[38:39], v[38:39], v[234:235]
    v_cvt_pk_bf16_f32 v220, v36, v37
    v_cvt_pk_bf16_f32 v221, v38, v39
    v_pk_fma_f32 v[228:229], v[248:249], v[28:29], v[32:33] op_sel:[0,0,0] op_sel_hi:[0,1,1]
    v_pk_fma_f32 v[52:53], v[244:245], v[52:53], v[228:229] op_sel:[0,0,0] op_sel_hi:[0,1,1]
    v_pk_mul_f32 v[228:229], v[52:53], v[52:53]
    v_pk_fma_f32 v[228:229], v[228:229], s[52:53], s[52:53] op_sel:[0,0,1] op_sel_hi:[1,0,1]
    v_pk_mul_f32 v[228:229], v[228:229], v[52:53]
    v_exp_f32 v232, v228
    v_exp_f32 v233, v229
    v_pk_fma_f32 v[230:231], v[248:249], v[30:31], v[34:35] op_sel:[0,0,0] op_sel_hi:[0,1,1]
    v_pk_fma_f32 v[54:55], v[244:245], v[54:55], v[230:231] op_sel:[0,0,0] op_sel_hi:[0,1,1]
    v_pk_mul_f32 v[230:231], v[54:55], v[54:55]
    v_pk_fma_f32 v[230:231], v[230:231], s[52:53], s[52:53] op_sel:[0,0,1] op_sel_hi:[1,0,1]
    v_pk_mul_f32 v[230:231], v[230:231], v[54:55]
    v_exp_f32 v234, v230
    v_exp_f32 v235, v231
    v_pk_add_f32 v[232:233], v[232:233], 1.0
    v_rcp_f32 v232, v232
    v_rcp_f32 v233, v233
    v_pk_add_f32 v[234:235], v[234:235], 1.0
    v_rcp_f32 v234, v234
    v_rcp_f32 v235, v235
    v_pk_mul_f32 v[52:53], v[52:53], v[232:233]
    v_pk_mul_f32 v[54:55], v[54:55], v[234:235]
    v_cvt_pk_bf16_f32 v222, v52, v53
    v_cvt_pk_bf16_f32 v223, v54, v55
    buffer_store_dwordx4 v[220:223], v2, s[8:11], s57 offen offset:0 sc1
    v_pk_fma_f32 v[228:229], v[248:249], v[12:13], v[16:17] op_sel:[1,0,0] op_sel_hi:[1,1,1]
    v_pk_fma_f32 v[40:41], v[244:245], v[40:41], v[228:229] op_sel:[1,0,0] op_sel_hi:[1,1,1]
    v_pk_mul_f32 v[228:229], v[40:41], v[40:41]
    v_pk_fma_f32 v[228:229], v[228:229], s[52:53], s[52:53] op_sel:[0,0,1] op_sel_hi:[1,0,1]
    v_pk_mul_f32 v[228:229], v[228:229], v[40:41]
    v_exp_f32 v232, v228
    v_exp_f32 v233, v229
    v_pk_fma_f32 v[230:231], v[248:249], v[14:15], v[18:19] op_sel:[1,0,0] op_sel_hi:[1,1,1]
    v_pk_fma_f32 v[42:43], v[244:245], v[42:43], v[230:231] op_sel:[1,0,0] op_sel_hi:[1,1,1]
    v_pk_mul_f32 v[230:231], v[42:43], v[42:43]
    v_pk_fma_f32 v[230:231], v[230:231], s[52:53], s[52:53] op_sel:[0,0,1] op_sel_hi:[1,0,1]
    v_pk_mul_f32 v[230:231], v[230:231], v[42:43]
    v_exp_f32 v234, v230
    v_exp_f32 v235, v231
    v_pk_add_f32 v[232:233], v[232:233], 1.0
    v_rcp_f32 v232, v232
    v_rcp_f32 v233, v233
    v_pk_add_f32 v[234:235], v[234:235], 1.0
    v_rcp_f32 v234, v234
    v_rcp_f32 v235, v235
    v_pk_mul_f32 v[40:41], v[40:41], v[232:233]
    v_pk_mul_f32 v[42:43], v[42:43], v[234:235]
    v_cvt_pk_bf16_f32 v224, v40, v41
    v_cvt_pk_bf16_f32 v225, v42, v43
    v_pk_fma_f32 v[228:229], v[248:249], v[28:29], v[32:33] op_sel:[1,0,0] op_sel_hi:[1,1,1]
    v_pk_fma_f32 v[56:57], v[244:245], v[56:57], v[228:229] op_sel:[1,0,0] op_sel_hi:[1,1,1]
    v_pk_mul_f32 v[228:229], v[56:57], v[56:57]
    v_pk_fma_f32 v[228:229], v[228:229], s[52:53], s[52:53] op_sel:[0,0,1] op_sel_hi:[1,0,1]
    v_pk_mul_f32 v[228:229], v[228:229], v[56:57]
    v_exp_f32 v232, v228
    v_exp_f32 v233, v229
    v_pk_fma_f32 v[230:231], v[248:249], v[30:31], v[34:35] op_sel:[1,0,0] op_sel_hi:[1,1,1]
    v_pk_fma_f32 v[58:59], v[244:245], v[58:59], v[230:231] op_sel:[1,0,0] op_sel_hi:[1,1,1]
    v_pk_mul_f32 v[230:231], v[58:59], v[58:59]
    v_pk_fma_f32 v[230:231], v[230:231], s[52:53], s[52:53] op_sel:[0,0,1] op_sel_hi:[1,0,1]
    v_pk_mul_f32 v[230:231], v[230:231], v[58:59]
    v_exp_f32 v234, v230
    v_exp_f32 v235, v231
    v_pk_add_f32 v[232:233], v[232:233], 1.0
    v_rcp_f32 v232, v232
    v_rcp_f32 v233, v233
    v_pk_add_f32 v[234:235], v[234:235], 1.0
    v_rcp_f32 v234, v234
    v_rcp_f32 v235, v235
    v_pk_mul_f32 v[56:57], v[56:57], v[232:233]
    v_pk_mul_f32 v[58:59], v[58:59], v[234:235]
    v_cvt_pk_bf16_f32 v226, v56, v57
    v_cvt_pk_bf16_f32 v227, v58, v59
    buffer_store_dwordx4 v[224:227], v2, s[8:11], s57 offen offset:1024 sc1
    v_pk_fma_f32 v[228:229], v[250:251], v[12:13], v[16:17] op_sel:[0,0,0] op_sel_hi:[0,1,1]
    v_pk_fma_f32 v[44:45], v[246:247], v[44:45], v[228:229] op_sel:[0,0,0] op_sel_hi:[0,1,1]
    v_pk_mul_f32 v[228:229], v[44:45], v[44:45]
    v_pk_fma_f32 v[228:229], v[228:229], s[52:53], s[52:53] op_sel:[0,0,1] op_sel_hi:[1,0,1]
    v_pk_mul_f32 v[228:229], v[228:229], v[44:45]
    v_exp_f32 v232, v228
    v_exp_f32 v233, v229
    v_pk_fma_f32 v[230:231], v[250:251], v[14:15], v[18:19] op_sel:[0,0,0] op_sel_hi:[0,1,1]
    v_pk_fma_f32 v[46:47], v[246:247], v[46:47], v[230:231] op_sel:[0,0,0] op_sel_hi:[0,1,1]
    v_pk_mul_f32 v[230:231], v[46:47], v[46:47]
    v_pk_fma_f32 v[230:231], v[230:231], s[52:53], s[52:53] op_sel:[0,0,1] op_sel_hi:[1,0,1]
    v_pk_mul_f32 v[230:231], v[230:231], v[46:47]
    v_exp_f32 v234, v230
    v_exp_f32 v235, v231
    v_pk_add_f32 v[232:233], v[232:233], 1.0
    v_rcp_f32 v232, v232
    v_rcp_f32 v233, v233
    v_pk_add_f32 v[234:235], v[234:235], 1.0
    v_rcp_f32 v234, v234
    v_rcp_f32 v235, v235
    v_pk_mul_f32 v[44:45], v[44:45], v[232:233]
    v_pk_mul_f32 v[46:47], v[46:47], v[234:235]
    v_cvt_pk_bf16_f32 v220, v44, v45
    v_cvt_pk_bf16_f32 v221, v46, v47
    v_pk_fma_f32 v[228:229], v[250:251], v[28:29], v[32:33] op_sel:[0,0,0] op_sel_hi:[0,1,1]
    v_pk_fma_f32 v[60:61], v[246:247], v[60:61], v[228:229] op_sel:[0,0,0] op_sel_hi:[0,1,1]
    v_pk_mul_f32 v[228:229], v[60:61], v[60:61]
    v_pk_fma_f32 v[228:229], v[228:229], s[52:53], s[52:53] op_sel:[0,0,1] op_sel_hi:[1,0,1]
    v_pk_mul_f32 v[228:229], v[228:229], v[60:61]
    v_exp_f32 v232, v228
    v_exp_f32 v233, v229
    v_pk_fma_f32 v[230:231], v[250:251], v[30:31], v[34:35] op_sel:[0,0,0] op_sel_hi:[0,1,1]
    v_pk_fma_f32 v[62:63], v[246:247], v[62:63], v[230:231] op_sel:[0,0,0] op_sel_hi:[0,1,1]
    v_pk_mul_f32 v[230:231], v[62:63], v[62:63]
    v_pk_fma_f32 v[230:231], v[230:231], s[52:53], s[52:53] op_sel:[0,0,1] op_sel_hi:[1,0,1]
    v_pk_mul_f32 v[230:231], v[230:231], v[62:63]
    v_exp_f32 v234, v230
    v_exp_f32 v235, v231
    v_pk_add_f32 v[232:233], v[232:233], 1.0
    v_rcp_f32 v232, v232
    v_rcp_f32 v233, v233
    v_pk_add_f32 v[234:235], v[234:235], 1.0
    v_rcp_f32 v234, v234
    v_rcp_f32 v235, v235
    v_pk_mul_f32 v[60:61], v[60:61], v[232:233]
    v_pk_mul_f32 v[62:63], v[62:63], v[234:235]
    v_cvt_pk_bf16_f32 v222, v60, v61
    v_cvt_pk_bf16_f32 v223, v62, v63
    buffer_store_dwordx4 v[220:223], v2, s[8:11], s57 offen offset:2048 sc1
    v_pk_fma_f32 v[228:229], v[250:251], v[12:13], v[16:17] op_sel:[1,0,0] op_sel_hi:[1,1,1]
    v_pk_fma_f32 v[48:49], v[246:247], v[48:49], v[228:229] op_sel:[1,0,0] op_sel_hi:[1,1,1]
    v_pk_mul_f32 v[228:229], v[48:49], v[48:49]
    v_pk_fma_f32 v[228:229], v[228:229], s[52:53], s[52:53] op_sel:[0,0,1] op_sel_hi:[1,0,1]
    v_pk_mul_f32 v[228:229], v[228:229], v[48:49]
    v_exp_f32 v232, v228
    v_exp_f32 v233, v229
    v_pk_fma_f32 v[230:231], v[250:251], v[14:15], v[18:19] op_sel:[1,0,0] op_sel_hi:[1,1,1]
    v_pk_fma_f32 v[50:51], v[246:247], v[50:51], v[230:231] op_sel:[1,0,0] op_sel_hi:[1,1,1]
    v_pk_mul_f32 v[230:231], v[50:51], v[50:51]
    v_pk_fma_f32 v[230:231], v[230:231], s[52:53], s[52:53] op_sel:[0,0,1] op_sel_hi:[1,0,1]
    v_pk_mul_f32 v[230:231], v[230:231], v[50:51]
    v_exp_f32 v234, v230
    v_exp_f32 v235, v231
    v_pk_add_f32 v[232:233], v[232:233], 1.0
    v_rcp_f32 v232, v232
    v_rcp_f32 v233, v233
    v_pk_add_f32 v[234:235], v[234:235], 1.0
    v_rcp_f32 v234, v234
    v_rcp_f32 v235, v235
    v_pk_mul_f32 v[48:49], v[48:49], v[232:233]
    v_pk_mul_f32 v[50:51], v[50:51], v[234:235]
    v_cvt_pk_bf16_f32 v224, v48, v49
    v_cvt_pk_bf16_f32 v225, v50, v51
    v_pk_fma_f32 v[228:229], v[250:251], v[28:29], v[32:33] op_sel:[1,0,0] op_sel_hi:[1,1,1]
    v_pk_fma_f32 v[64:65], v[246:247], v[64:65], v[228:229] op_sel:[1,0,0] op_sel_hi:[1,1,1]
    v_pk_mul_f32 v[228:229], v[64:65], v[64:65]
    v_pk_fma_f32 v[228:229], v[228:229], s[52:53], s[52:53] op_sel:[0,0,1] op_sel_hi:[1,0,1]
    v_pk_mul_f32 v[228:229], v[228:229], v[64:65]
    v_exp_f32 v232, v228
    v_exp_f32 v233, v229
    v_pk_fma_f32 v[230:231], v[250:251], v[30:31], v[34:35] op_sel:[1,0,0] op_sel_hi:[1,1,1]
    v_pk_fma_f32 v[66:67], v[246:247], v[66:67], v[230:231] op_sel:[1,0,0] op_sel_hi:[1,1,1]
    v_pk_mul_f32 v[230:231], v[66:67], v[66:67]
    v_pk_fma_f32 v[230:231], v[230:231], s[52:53], s[52:53] op_sel:[0,0,1] op_sel_hi:[1,0,1]
    v_pk_mul_f32 v[230:231], v[230:231], v[66:67]
    v_exp_f32 v234, v230
    v_exp_f32 v235, v231
    v_pk_add_f32 v[232:233], v[232:233], 1.0
    v_rcp_f32 v232, v232
    v_rcp_f32 v233, v233
    v_pk_add_f32 v[234:235], v[234:235], 1.0
    v_rcp_f32 v234, v234
    v_rcp_f32 v235, v235
    v_pk_mul_f32 v[64:65], v[64:65], v[232:233]
    v_pk_mul_f32 v[66:67], v[66:67], v[234:235]
    v_cvt_pk_bf16_f32 v226, v64, v65
    v_cvt_pk_bf16_f32 v227, v66, v67
    buffer_store_dwordx4 v[224:227], v2, s[8:11], s57 offen offset:3072 sc1
    s_add_u32 s57, s57, 524288
    ds_read_b128 v[12:15], v0 offset:61952
    ds_read_b128 v[16:19], v0 offset:61968
    ds_read_b128 v[28:31], v0 offset:62080
    ds_read_b128 v[32:35], v0 offset:62096
    s_waitcnt lgkmcnt(0)
    v_pk_fma_f32 v[228:229], v[248:249], v[12:13], v[16:17] op_sel:[0,0,0] op_sel_hi:[0,1,1]
    v_pk_fma_f32 v[68:69], v[244:245], v[68:69], v[228:229] op_sel:[0,0,0] op_sel_hi:[0,1,1]
    v_pk_mul_f32 v[228:229], v[68:69], v[68:69]
    v_pk_fma_f32 v[228:229], v[228:229], s[52:53], s[52:53] op_sel:[0,0,1] op_sel_hi:[1,0,1]
    v_pk_mul_f32 v[228:229], v[228:229], v[68:69]
    v_exp_f32 v232, v228
    v_exp_f32 v233, v229
    v_pk_fma_f32 v[230:231], v[248:249], v[14:15], v[18:19] op_sel:[0,0,0] op_sel_hi:[0,1,1]
    v_pk_fma_f32 v[70:71], v[244:245], v[70:71], v[230:231] op_sel:[0,0,0] op_sel_hi:[0,1,1]
    v_pk_mul_f32 v[230:231], v[70:71], v[70:71]
    v_pk_fma_f32 v[230:231], v[230:231], s[52:53], s[52:53] op_sel:[0,0,1] op_sel_hi:[1,0,1]
    v_pk_mul_f32 v[230:231], v[230:231], v[70:71]
    v_exp_f32 v234, v230
    v_exp_f32 v235, v231
    v_pk_add_f32 v[232:233], v[232:233], 1.0
    v_rcp_f32 v232, v232
    v_rcp_f32 v233, v233
    v_pk_add_f32 v[234:235], v[234:235], 1.0
    v_rcp_f32 v234, v234
    v_rcp_f32 v235, v235
    v_pk_mul_f32 v[68:69], v[68:69], v[232:233]
    v_pk_mul_f32 v[70:71], v[70:71], v[234:235]
    v_cvt_pk_bf16_f32 v220, v68, v69
    v_cvt_pk_bf16_f32 v221, v70, v71
    v_pk_fma_f32 v[228:229], v[248:249], v[28:29], v[32:33] op_sel:[0,0,0] op_sel_hi:[0,1,1]
    v_pk_fma_f32 v[84:85], v[244:245], v[84:85], v[228:229] op_sel:[0,0,0] op_sel_hi:[0,1,1]
    v_pk_mul_f32 v[228:229], v[84:85], v[84:85]
    v_pk_fma_f32 v[228:229], v[228:229], s[52:53], s[52:53] op_sel:[0,0,1] op_sel_hi:[1,0,1]
    v_pk_mul_f32 v[228:229], v[228:229], v[84:85]
    v_exp_f32 v232, v228
    v_exp_f32 v233, v229
    v_pk_fma_f32 v[230:231], v[248:249], v[30:31], v[34:35] op_sel:[0,0,0] op_sel_hi:[0,1,1]
    v_pk_fma_f32 v[86:87], v[244:245], v[86:87], v[230:231] op_sel:[0,0,0] op_sel_hi:[0,1,1]
    v_pk_mul_f32 v[230:231], v[86:87], v[86:87]
    v_pk_fma_f32 v[230:231], v[230:231], s[52:53], s[52:53] op_sel:[0,0,1] op_sel_hi:[1,0,1]
    v_pk_mul_f32 v[230:231], v[230:231], v[86:87]
    v_exp_f32 v234, v230
    v_exp_f32 v235, v231
    v_pk_add_f32 v[232:233], v[232:233], 1.0
    v_rcp_f32 v232, v232
    v_rcp_f32 v233, v233
    v_pk_add_f32 v[234:235], v[234:235], 1.0
    v_rcp_f32 v234, v234
    v_rcp_f32 v235, v235
    v_pk_mul_f32 v[84:85], v[84:85], v[232:233]
    v_pk_mul_f32 v[86:87], v[86:87], v[234:235]
    v_cvt_pk_bf16_f32 v222, v84, v85
    v_cvt_pk_bf16_f32 v223, v86, v87
    buffer_store_dwordx4 v[220:223], v2, s[8:11], s57 offen offset:0 sc1
    v_pk_fma_f32 v[228:229], v[248:249], v[12:13], v[16:17] op_sel:[1,0,0] op_sel_hi:[1,1,1]
    v_pk_fma_f32 v[72:73], v[244:245], v[72:73], v[228:229] op_sel:[1,0,0] op_sel_hi:[1,1,1]
    v_pk_mul_f32 v[228:229], v[72:73], v[72:73]
    v_pk_fma_f32 v[228:229], v[228:229], s[52:53], s[52:53] op_sel:[0,0,1] op_sel_hi:[1,0,1]
    v_pk_mul_f32 v[228:229], v[228:229], v[72:73]
    v_exp_f32 v232, v228
    v_exp_f32 v233, v229
    v_pk_fma_f32 v[230:231], v[248:249], v[14:15], v[18:19] op_sel:[1,0,0] op_sel_hi:[1,1,1]
    v_pk_fma_f32 v[74:75], v[244:245], v[74:75], v[230:231] op_sel:[1,0,0] op_sel_hi:[1,1,1]
    v_pk_mul_f32 v[230:231], v[74:75], v[74:75]
    v_pk_fma_f32 v[230:231], v[230:231], s[52:53], s[52:53] op_sel:[0,0,1] op_sel_hi:[1,0,1]
    v_pk_mul_f32 v[230:231], v[230:231], v[74:75]
    v_exp_f32 v234, v230
    v_exp_f32 v235, v231
    v_pk_add_f32 v[232:233], v[232:233], 1.0
    v_rcp_f32 v232, v232
    v_rcp_f32 v233, v233
    v_pk_add_f32 v[234:235], v[234:235], 1.0
    v_rcp_f32 v234, v234
    v_rcp_f32 v235, v235
    v_pk_mul_f32 v[72:73], v[72:73], v[232:233]
    v_pk_mul_f32 v[74:75], v[74:75], v[234:235]
    v_cvt_pk_bf16_f32 v224, v72, v73
    v_cvt_pk_bf16_f32 v225, v74, v75
    v_pk_fma_f32 v[228:229], v[248:249], v[28:29], v[32:33] op_sel:[1,0,0] op_sel_hi:[1,1,1]
    v_pk_fma_f32 v[88:89], v[244:245], v[88:89], v[228:229] op_sel:[1,0,0] op_sel_hi:[1,1,1]
    v_pk_mul_f32 v[228:229], v[88:89], v[88:89]
    v_pk_fma_f32 v[228:229], v[228:229], s[52:53], s[52:53] op_sel:[0,0,1] op_sel_hi:[1,0,1]
    v_pk_mul_f32 v[228:229], v[228:229], v[88:89]
    v_exp_f32 v232, v228
    v_exp_f32 v233, v229
    v_pk_fma_f32 v[230:231], v[248:249], v[30:31], v[34:35] op_sel:[1,0,0] op_sel_hi:[1,1,1]
    v_pk_fma_f32 v[90:91], v[244:245], v[90:91], v[230:231] op_sel:[1,0,0] op_sel_hi:[1,1,1]
    v_pk_mul_f32 v[230:231], v[90:91], v[90:91]
    v_pk_fma_f32 v[230:231], v[230:231], s[52:53], s[52:53] op_sel:[0,0,1] op_sel_hi:[1,0,1]
    v_pk_mul_f32 v[230:231], v[230:231], v[90:91]
    v_exp_f32 v234, v230
    v_exp_f32 v235, v231
    v_pk_add_f32 v[232:233], v[232:233], 1.0
    v_rcp_f32 v232, v232
    v_rcp_f32 v233, v233
    v_pk_add_f32 v[234:235], v[234:235], 1.0
    v_rcp_f32 v234, v234
    v_rcp_f32 v235, v235
    v_pk_mul_f32 v[88:89], v[88:89], v[232:233]
    v_pk_mul_f32 v[90:91], v[90:91], v[234:235]
    v_cvt_pk_bf16_f32 v226, v88, v89
    v_cvt_pk_bf16_f32 v227, v90, v91
    buffer_store_dwordx4 v[224:227], v2, s[8:11], s57 offen offset:1024 sc1
    v_pk_fma_f32 v[228:229], v[250:251], v[12:13], v[16:17] op_sel:[0,0,0] op_sel_hi:[0,1,1]
    v_pk_fma_f32 v[76:77], v[246:247], v[76:77], v[228:229] op_sel:[0,0,0] op_sel_hi:[0,1,1]
    v_pk_mul_f32 v[228:229], v[76:77], v[76:77]
    v_pk_fma_f32 v[228:229], v[228:229], s[52:53], s[52:53] op_sel:[0,0,1] op_sel_hi:[1,0,1]
    v_pk_mul_f32 v[228:229], v[228:229], v[76:77]
    v_exp_f32 v232, v228
    v_exp_f32 v233, v229
    v_pk_fma_f32 v[230:231], v[250:251], v[14:15], v[18:19] op_sel:[0,0,0] op_sel_hi:[0,1,1]
    v_pk_fma_f32 v[78:79], v[246:247], v[78:79], v[230:231] op_sel:[0,0,0] op_sel_hi:[0,1,1]
    v_pk_mul_f32 v[230:231], v[78:79], v[78:79]
    v_pk_fma_f32 v[230:231], v[230:231], s[52:53], s[52:53] op_sel:[0,0,1] op_sel_hi:[1,0,1]
    v_pk_mul_f32 v[230:231], v[230:231], v[78:79]
    v_exp_f32 v234, v230
    v_exp_f32 v235, v231
    v_pk_add_f32 v[232:233], v[232:233], 1.0
    v_rcp_f32 v232, v232
    v_rcp_f32 v233, v233
    v_pk_add_f32 v[234:235], v[234:235], 1.0
    v_rcp_f32 v234, v234
    v_rcp_f32 v235, v235
    v_pk_mul_f32 v[76:77], v[76:77], v[232:233]
    v_pk_mul_f32 v[78:79], v[78:79], v[234:235]
    v_cvt_pk_bf16_f32 v220, v76, v77
    v_cvt_pk_bf16_f32 v221, v78, v79
    v_pk_fma_f32 v[228:229], v[250:251], v[28:29], v[32:33] op_sel:[0,0,0] op_sel_hi:[0,1,1]
    v_pk_fma_f32 v[92:93], v[246:247], v[92:93], v[228:229] op_sel:[0,0,0] op_sel_hi:[0,1,1]
    v_pk_mul_f32 v[228:229], v[92:93], v[92:93]
    v_pk_fma_f32 v[228:229], v[228:229], s[52:53], s[52:53] op_sel:[0,0,1] op_sel_hi:[1,0,1]
    v_pk_mul_f32 v[228:229], v[228:229], v[92:93]
    v_exp_f32 v232, v228
    v_exp_f32 v233, v229
    v_pk_fma_f32 v[230:231], v[250:251], v[30:31], v[34:35] op_sel:[0,0,0] op_sel_hi:[0,1,1]
    v_pk_fma_f32 v[94:95], v[246:247], v[94:95], v[230:231] op_sel:[0,0,0] op_sel_hi:[0,1,1]
    v_pk_mul_f32 v[230:231], v[94:95], v[94:95]
    v_pk_fma_f32 v[230:231], v[230:231], s[52:53], s[52:53] op_sel:[0,0,1] op_sel_hi:[1,0,1]
    v_pk_mul_f32 v[230:231], v[230:231], v[94:95]
    v_exp_f32 v234, v230
    v_exp_f32 v235, v231
    v_pk_add_f32 v[232:233], v[232:233], 1.0
    v_rcp_f32 v232, v232
    v_rcp_f32 v233, v233
    v_pk_add_f32 v[234:235], v[234:235], 1.0
    v_rcp_f32 v234, v234
    v_rcp_f32 v235, v235
    v_pk_mul_f32 v[92:93], v[92:93], v[232:233]
    v_pk_mul_f32 v[94:95], v[94:95], v[234:235]
    v_cvt_pk_bf16_f32 v222, v92, v93
    v_cvt_pk_bf16_f32 v223, v94, v95
    buffer_store_dwordx4 v[220:223], v2, s[8:11], s57 offen offset:2048 sc1
    v_pk_fma_f32 v[228:229], v[250:251], v[12:13], v[16:17] op_sel:[1,0,0] op_sel_hi:[1,1,1]
    v_pk_fma_f32 v[80:81], v[246:247], v[80:81], v[228:229] op_sel:[1,0,0] op_sel_hi:[1,1,1]
    v_pk_mul_f32 v[228:229], v[80:81], v[80:81]
    v_pk_fma_f32 v[228:229], v[228:229], s[52:53], s[52:53] op_sel:[0,0,1] op_sel_hi:[1,0,1]
    v_pk_mul_f32 v[228:229], v[228:229], v[80:81]
    v_exp_f32 v232, v228
    v_exp_f32 v233, v229
    v_pk_fma_f32 v[230:231], v[250:251], v[14:15], v[18:19] op_sel:[1,0,0] op_sel_hi:[1,1,1]
    v_pk_fma_f32 v[82:83], v[246:247], v[82:83], v[230:231] op_sel:[1,0,0] op_sel_hi:[1,1,1]
    v_pk_mul_f32 v[230:231], v[82:83], v[82:83]
    v_pk_fma_f32 v[230:231], v[230:231], s[52:53], s[52:53] op_sel:[0,0,1] op_sel_hi:[1,0,1]
    v_pk_mul_f32 v[230:231], v[230:231], v[82:83]
    v_exp_f32 v234, v230
    v_exp_f32 v235, v231
    v_pk_add_f32 v[232:233], v[232:233], 1.0
    v_rcp_f32 v232, v232
    v_rcp_f32 v233, v233
    v_pk_add_f32 v[234:235], v[234:235], 1.0
    v_rcp_f32 v234, v234
    v_rcp_f32 v235, v235
    v_pk_mul_f32 v[80:81], v[80:81], v[232:233]
    v_pk_mul_f32 v[82:83], v[82:83], v[234:235]
    v_cvt_pk_bf16_f32 v224, v80, v81
    v_cvt_pk_bf16_f32 v225, v82, v83
    v_pk_fma_f32 v[228:229], v[250:251], v[28:29], v[32:33] op_sel:[1,0,0] op_sel_hi:[1,1,1]
    v_pk_fma_f32 v[96:97], v[246:247], v[96:97], v[228:229] op_sel:[1,0,0] op_sel_hi:[1,1,1]
    v_pk_mul_f32 v[228:229], v[96:97], v[96:97]
    v_pk_fma_f32 v[228:229], v[228:229], s[52:53], s[52:53] op_sel:[0,0,1] op_sel_hi:[1,0,1]
    v_pk_mul_f32 v[228:229], v[228:229], v[96:97]
    v_exp_f32 v232, v228
    v_exp_f32 v233, v229
    v_pk_fma_f32 v[230:231], v[250:251], v[30:31], v[34:35] op_sel:[1,0,0] op_sel_hi:[1,1,1]
    v_pk_fma_f32 v[98:99], v[246:247], v[98:99], v[230:231] op_sel:[1,0,0] op_sel_hi:[1,1,1]
    v_pk_mul_f32 v[230:231], v[98:99], v[98:99]
    v_pk_fma_f32 v[230:231], v[230:231], s[52:53], s[52:53] op_sel:[0,0,1] op_sel_hi:[1,0,1]
    v_pk_mul_f32 v[230:231], v[230:231], v[98:99]
    v_exp_f32 v234, v230
    v_exp_f32 v235, v231
    v_pk_add_f32 v[232:233], v[232:233], 1.0
    v_rcp_f32 v232, v232
    v_rcp_f32 v233, v233
    v_pk_add_f32 v[234:235], v[234:235], 1.0
    v_rcp_f32 v234, v234
    v_rcp_f32 v235, v235
    v_pk_mul_f32 v[96:97], v[96:97], v[232:233]
    v_pk_mul_f32 v[98:99], v[98:99], v[234:235]
    v_cvt_pk_bf16_f32 v226, v96, v97
    v_cvt_pk_bf16_f32 v227, v98, v99
    buffer_store_dwordx4 v[224:227], v2, s[8:11], s57 offen offset:3072 sc1
    s_add_u32 s57, s57, 524288
    ds_read_b128 v[12:15], v0 offset:62208
    ds_read_b128 v[16:19], v0 offset:62224
    s_waitcnt lgkmcnt(0)
    v_pk_fma_f32 v[228:229], v[248:249], v[12:13], v[16:17] op_sel:[0,0,0] op_sel_hi:[0,1,1]
    v_pk_fma_f32 v[100:101], v[244:245], v[100:101], v[228:229] op_sel:[0,0,0] op_sel_hi:[0,1,1]
    v_pk_mul_f32 v[228:229], v[100:101], v[100:101]
    v_pk_fma_f32 v[228:229], v[228:229], s[52:53], s[52:53] op_sel:[0,0,1] op_sel_hi:[1,0,1]
    v_pk_mul_f32 v[228:229], v[228:229], v[100:101]
    v_exp_f32 v232, v228
    v_exp_f32 v233, v229
    v_pk_fma_f32 v[230:231], v[248:249], v[14:15], v[18:19] op_sel:[0,0,0] op_sel_hi:[0,1,1]
    v_pk_fma_f32 v[102:103], v[244:245], v[102:103], v[230:231] op_sel:[0,0,0] op_sel_hi:[0,1,1]
    v_pk_mul_f32 v[230:231], v[102:103], v[102:103]
    v_pk_fma_f32 v[230:231], v[230:231], s[52:53], s[52:53] op_sel:[0,0,1] op_sel_hi:[1,0,1]
    v_pk_mul_f32 v[230:231], v[230:231], v[102:103]
    v_exp_f32 v234, v230
    v_exp_f32 v235, v231
    v_pk_add_f32 v[232:233], v[232:233], 1.0
    v_rcp_f32 v232, v232
    v_rcp_f32 v233, v233
    v_pk_add_f32 v[234:235], v[234:235], 1.0
    v_rcp_f32 v234, v234
    v_rcp_f32 v235, v235
    v_pk_mul_f32 v[100:101], v[100:101], v[232:233]
    v_pk_mul_f32 v[102:103], v[102:103], v[234:235]
    v_cvt_pk_bf16_f32 v220, v100, v101
    v_cvt_pk_bf16_f32 v221, v102, v103
    v_pk_fma_f32 v[228:229], v[248:249], v[12:13], v[16:17] op_sel:[1,0,0] op_sel_hi:[1,1,1]
    v_pk_fma_f32 v[104:105], v[244:245], v[104:105], v[228:229] op_sel:[1,0,0] op_sel_hi:[1,1,1]
    v_pk_mul_f32 v[228:229], v[104:105], v[104:105]
    v_pk_fma_f32 v[228:229], v[228:229], s[52:53], s[52:53] op_sel:[0,0,1] op_sel_hi:[1,0,1]
    v_pk_mul_f32 v[228:229], v[228:229], v[104:105]
    v_exp_f32 v232, v228
    v_exp_f32 v233, v229
    v_pk_fma_f32 v[230:231], v[248:249], v[14:15], v[18:19] op_sel:[1,0,0] op_sel_hi:[1,1,1]
    v_pk_fma_f32 v[106:107], v[244:245], v[106:107], v[230:231] op_sel:[1,0,0] op_sel_hi:[1,1,1]
    v_pk_mul_f32 v[230:231], v[106:107], v[106:107]
    v_pk_fma_f32 v[230:231], v[230:231], s[52:53], s[52:53] op_sel:[0,0,1] op_sel_hi:[1,0,1]
    v_pk_mul_f32 v[230:231], v[230:231], v[106:107]
    v_exp_f32 v234, v230
    v_exp_f32 v235, v231
    v_pk_add_f32 v[232:233], v[232:233], 1.0
    v_rcp_f32 v232, v232
    v_rcp_f32 v233, v233
    v_pk_add_f32 v[234:235], v[234:235], 1.0
    v_rcp_f32 v234, v234
    v_rcp_f32 v235, v235
    v_pk_mul_f32 v[104:105], v[104:105], v[232:233]
    v_pk_mul_f32 v[106:107], v[106:107], v[234:235]
    v_cvt_pk_bf16_f32 v222, v104, v105
    v_cvt_pk_bf16_f32 v223, v106, v107
    buffer_store_dwordx4 v[220:223], v2, s[8:11], s59 offen offset:0 sc1
    v_pk_fma_f32 v[228:229], v[250:251], v[12:13], v[16:17] op_sel:[0,0,0] op_sel_hi:[0,1,1]
    v_pk_fma_f32 v[108:109], v[246:247], v[108:109], v[228:229] op_sel:[0,0,0] op_sel_hi:[0,1,1]
    v_pk_mul_f32 v[228:229], v[108:109], v[108:109]
    v_pk_fma_f32 v[228:229], v[228:229], s[52:53], s[52:53] op_sel:[0,0,1] op_sel_hi:[1,0,1]
    v_pk_mul_f32 v[228:229], v[228:229], v[108:109]
    v_exp_f32 v232, v228
    v_exp_f32 v233, v229
    v_pk_fma_f32 v[230:231], v[250:251], v[14:15], v[18:19] op_sel:[0,0,0] op_sel_hi:[0,1,1]
    v_pk_fma_f32 v[110:111], v[246:247], v[110:111], v[230:231] op_sel:[0,0,0] op_sel_hi:[0,1,1]
    v_pk_mul_f32 v[230:231], v[110:111], v[110:111]
    v_pk_fma_f32 v[230:231], v[230:231], s[52:53], s[52:53] op_sel:[0,0,1] op_sel_hi:[1,0,1]
    v_pk_mul_f32 v[230:231], v[230:231], v[110:111]
    v_exp_f32 v234, v230
    v_exp_f32 v235, v231
    v_pk_add_f32 v[232:233], v[232:233], 1.0
    v_rcp_f32 v232, v232
    v_rcp_f32 v233, v233
    v_pk_add_f32 v[234:235], v[234:235], 1.0
    v_rcp_f32 v234, v234
    v_rcp_f32 v235, v235
    v_pk_mul_f32 v[108:109], v[108:109], v[232:233]
    v_pk_mul_f32 v[110:111], v[110:111], v[234:235]
    v_cvt_pk_bf16_f32 v224, v108, v109
    v_cvt_pk_bf16_f32 v225, v110, v111
    v_pk_fma_f32 v[228:229], v[250:251], v[12:13], v[16:17] op_sel:[1,0,0] op_sel_hi:[1,1,1]
    v_pk_fma_f32 v[112:113], v[246:247], v[112:113], v[228:229] op_sel:[1,0,0] op_sel_hi:[1,1,1]
    v_pk_mul_f32 v[228:229], v[112:113], v[112:113]
    v_pk_fma_f32 v[228:229], v[228:229], s[52:53], s[52:53] op_sel:[0,0,1] op_sel_hi:[1,0,1]
    v_pk_mul_f32 v[228:229], v[228:229], v[112:113]
    v_exp_f32 v232, v228
    v_exp_f32 v233, v229
    v_pk_fma_f32 v[230:231], v[250:251], v[14:15], v[18:19] op_sel:[1,0,0] op_sel_hi:[1,1,1]
    v_pk_fma_f32 v[114:115], v[246:247], v[114:115], v[230:231] op_sel:[1,0,0] op_sel_hi:[1,1,1]
    v_pk_mul_f32 v[230:231], v[114:115], v[114:115]
    v_pk_fma_f32 v[230:231], v[230:231], s[52:53], s[52:53] op_sel:[0,0,1] op_sel_hi:[1,0,1]
    v_pk_mul_f32 v[230:231], v[230:231], v[114:115]
    v_exp_f32 v234, v230
    v_exp_f32 v235, v231
    v_pk_add_f32 v[232:233], v[232:233], 1.0
    v_rcp_f32 v232, v232
    v_rcp_f32 v233, v233
    v_pk_add_f32 v[234:235], v[234:235], 1.0
    v_rcp_f32 v234, v234
    v_rcp_f32 v235, v235
    v_pk_mul_f32 v[112:113], v[112:113], v[232:233]
    v_pk_mul_f32 v[114:115], v[114:115], v[234:235]
    v_cvt_pk_bf16_f32 v226, v112, v113
    v_cvt_pk_bf16_f32 v227, v114, v115
    buffer_store_dwordx4 v[224:227], v2, s[8:11], s59 offen offset:2048 sc1
    v_pk_mul_f32 v[212:213], v[148:149], v[200:201] op_sel_hi:[1,0]
    v_pk_mul_f32 v[214:215], v[116:117], v[200:201] op_sel_hi:[1,0]
    v_pk_fma_f32 v[116:117], v[200:201], v[116:117], v[212:213] op_sel:[1,0,0] op_sel_hi:[1,1,1] neg_lo:[0,0,1] neg_hi:[0,0,1]
    v_pk_fma_f32 v[148:149], v[200:201], v[148:149], v[214:215] op_sel:[1,0,0] op_sel_hi:[1,1,1]
    v_pk_mul_f32 v[212:213], v[150:151], v[200:201] op_sel_hi:[1,0]
    v_pk_mul_f32 v[214:215], v[118:119], v[200:201] op_sel_hi:[1,0]
    v_pk_fma_f32 v[118:119], v[200:201], v[118:119], v[212:213] op_sel:[1,0,0] op_sel_hi:[1,1,1] neg_lo:[0,0,1] neg_hi:[0,0,1]
    v_pk_fma_f32 v[150:151], v[200:201], v[150:151], v[214:215] op_sel:[1,0,0] op_sel_hi:[1,1,1]
    v_pk_mul_f32 v[212:213], v[152:153], v[200:201] op_sel_hi:[1,0]
    v_pk_mul_f32 v[214:215], v[120:121], v[200:201] op_sel_hi:[1,0]
    v_pk_fma_f32 v[120:121], v[200:201], v[120:121], v[212:213] op_sel:[1,0,0] op_sel_hi:[1,1,1] neg_lo:[0,0,1] neg_hi:[0,0,1]
    v_pk_fma_f32 v[152:153], v[200:201], v[152:153], v[214:215] op_sel:[1,0,0] op_sel_hi:[1,1,1]
    v_pk_mul_f32 v[212:213], v[154:155], v[200:201] op_sel_hi:[1,0]
    v_pk_mul_f32 v[214:215], v[122:123], v[200:201] op_sel_hi:[1,0]
    v_pk_fma_f32 v[122:123], v[200:201], v[122:123], v[212:213] op_sel:[1,0,0] op_sel_hi:[1,1,1] neg_lo:[0,0,1] neg_hi:[0,0,1]
    v_pk_fma_f32 v[154:155], v[200:201], v[154:155], v[214:215] op_sel:[1,0,0] op_sel_hi:[1,1,1]
    v_pk_mul_f32 v[212:213], v[156:157], v[200:201] op_sel_hi:[1,0]
    v_pk_mul_f32 v[214:215], v[124:125], v[200:201] op_sel_hi:[1,0]
    v_pk_fma_f32 v[124:125], v[200:201], v[124:125], v[212:213] op_sel:[1,0,0] op_sel_hi:[1,1,1] neg_lo:[0,0,1] neg_hi:[0,0,1]
    v_pk_fma_f32 v[156:157], v[200:201], v[156:157], v[214:215] op_sel:[1,0,0] op_sel_hi:[1,1,1]
    v_pk_mul_f32 v[212:213], v[158:159], v[200:201] op_sel_hi:[1,0]
    v_pk_mul_f32 v[214:215], v[126:127], v[200:201] op_sel_hi:[1,0]
    v_pk_fma_f32 v[126:127], v[200:201], v[126:127], v[212:213] op_sel:[1,0,0] op_sel_hi:[1,1,1] neg_lo:[0,0,1] neg_hi:[0,0,1]
    v_pk_fma_f32 v[158:159], v[200:201], v[158:159], v[214:215] op_sel:[1,0,0] op_sel_hi:[1,1,1]
    v_pk_mul_f32 v[212:213], v[160:161], v[200:201] op_sel_hi:[1,0]
    v_pk_mul_f32 v[214:215], v[128:129], v[200:201] op_sel_hi:[1,0]
    v_pk_fma_f32 v[128:129], v[200:201], v[128:129], v[212:213] op_sel:[1,0,0] op_sel_hi:[1,1,1] neg_lo:[0,0,1] neg_hi:[0,0,1]
    v_pk_fma_f32 v[160:161], v[200:201], v[160:161], v[214:215] op_sel:[1,0,0] op_sel_hi:[1,1,1]
    v_pk_mul_f32 v[212:213], v[162:163], v[200:201] op_sel_hi:[1,0]
    v_pk_mul_f32 v[214:215], v[130:131], v[200:201] op_sel_hi:[1,0]
    v_pk_fma_f32 v[130:131], v[200:201], v[130:131], v[212:213] op_sel:[1,0,0] op_sel_hi:[1,1,1] neg_lo:[0,0,1] neg_hi:[0,0,1]
    v_pk_fma_f32 v[162:163], v[200:201], v[162:163], v[214:215] op_sel:[1,0,0] op_sel_hi:[1,1,1]
    v_pk_mul_f32 v[212:213], v[200:201], v[236:237] op_sel:[1,0] op_sel_hi:[1,1]
    v_pk_fma_f32 v[212:213], v[236:237], v[200:201], v[212:213] op_sel:[1,0,0] op_sel_hi:[0,0,1] neg_lo:[1,0,0]
    v_mov_b32 v236, v212
    v_mov_b32 v237, v213
    v_mul_f32 v212, v208, v200
    v_mul_f32 v208, v208, v201
    v_fmac_f32 v208, v204, v200
    v_fma_f32 v204, v204, v201, -v212
    v_pk_mul_f32 v[212:213], v[164:165], v[202:203] op_sel_hi:[1,0]
    v_pk_mul_f32 v[214:215], v[132:133], v[202:203] op_sel_hi:[1,0]
    v_pk_fma_f32 v[132:133], v[202:203], v[132:133], v[212:213] op_sel:[1,0,0] op_sel_hi:[1,1,1] neg_lo:[0,0,1] neg_hi:[0,0,1]
    v_pk_fma_f32 v[164:165], v[202:203], v[164:165], v[214:215] op_sel:[1,0,0] op_sel_hi:[1,1,1]
    v_pk_mul_f32 v[212:213], v[166:167], v[202:203] op_sel_hi:[1,0]
    v_pk_mul_f32 v[214:215], v[134:135], v[202:203] op_sel_hi:[1,0]
    v_pk_fma_f32 v[134:135], v[202:203], v[134:135], v[212:213] op_sel:[1,0,0] op_sel_hi:[1,1,1] neg_lo:[0,0,1] neg_hi:[0,0,1]
    v_pk_fma_f32 v[166:167], v[202:203], v[166:167], v[214:215] op_sel:[1,0,0] op_sel_hi:[1,1,1]
    v_pk_mul_f32 v[212:213], v[168:169], v[202:203] op_sel_hi:[1,0]
    v_pk_mul_f32 v[214:215], v[136:137], v[202:203] op_sel_hi:[1,0]
    v_pk_fma_f32 v[136:137], v[202:203], v[136:137], v[212:213] op_sel:[1,0,0] op_sel_hi:[1,1,1] neg_lo:[0,0,1] neg_hi:[0,0,1]
    v_pk_fma_f32 v[168:169], v[202:203], v[168:169], v[214:215] op_sel:[1,0,0] op_sel_hi:[1,1,1]
    v_pk_mul_f32 v[212:213], v[170:171], v[202:203] op_sel_hi:[1,0]
    v_pk_mul_f32 v[214:215], v[138:139], v[202:203] op_sel_hi:[1,0]
    v_pk_fma_f32 v[138:139], v[202:203], v[138:139], v[212:213] op_sel:[1,0,0] op_sel_hi:[1,1,1] neg_lo:[0,0,1] neg_hi:[0,0,1]
    v_pk_fma_f32 v[170:171], v[202:203], v[170:171], v[214:215] op_sel:[1,0,0] op_sel_hi:[1,1,1]
    v_pk_mul_f32 v[212:213], v[172:173], v[202:203] op_sel_hi:[1,0]
    v_pk_mul_f32 v[214:215], v[140:141], v[202:203] op_sel_hi:[1,0]
    v_pk_fma_f32 v[140:141], v[202:203], v[140:141], v[212:213] op_sel:[1,0,0] op_sel_hi:[1,1,1] neg_lo:[0,0,1] neg_hi:[0,0,1]
    v_pk_fma_f32 v[172:173], v[202:203], v[172:173], v[214:215] op_sel:[1,0,0] op_sel_hi:[1,1,1]
    v_pk_mul_f32 v[212:213], v[174:175], v[202:203] op_sel_hi:[1,0]
    v_pk_mul_f32 v[214:215], v[142:143], v[202:203] op_sel_hi:[1,0]
    v_pk_fma_f32 v[142:143], v[202:203], v[142:143], v[212:213] op_sel:[1,0,0] op_sel_hi:[1,1,1] neg_lo:[0,0,1] neg_hi:[0,0,1]
    v_pk_fma_f32 v[174:175], v[202:203], v[174:175], v[214:215] op_sel:[1,0,0] op_sel_hi:[1,1,1]
    v_pk_mul_f32 v[212:213], v[176:177], v[202:203] op_sel_hi:[1,0]
    v_pk_mul_f32 v[214:215], v[144:145], v[202:203] op_sel_hi:[1,0]
    v_pk_fma_f32 v[144:145], v[202:203], v[144:145], v[212:213] op_sel:[1,0,0] op_sel_hi:[1,1,1] neg_lo:[0,0,1] neg_hi:[0,0,1]
    v_pk_fma_f32 v[176:177], v[202:203], v[176:177], v[214:215] op_sel:[1,0,0] op_sel_hi:[1,1,1]
    v_pk_mul_f32 v[212:213], v[178:179], v[202:203] op_sel_hi:[1,0]
    v_pk_mul_f32 v[214:215], v[146:147], v[202:203] op_sel_hi:[1,0]
    v_pk_fma_f32 v[146:147], v[202:203], v[146:147], v[212:213] op_sel:[1,0,0] op_sel_hi:[1,1,1] neg_lo:[0,0,1] neg_hi:[0,0,1]
    v_pk_fma_f32 v[178:179], v[202:203], v[178:179], v[214:215] op_sel:[1,0,0] op_sel_hi:[1,1,1]
    v_pk_mul_f32 v[212:213], v[202:203], v[238:239] op_sel:[1,0] op_sel_hi:[1,1]
    v_pk_fma_f32 v[212:213], v[238:239], v[202:203], v[212:213] op_sel:[1,0,0] op_sel_hi:[0,0,1] neg_lo:[1,0,0]
    v_mov_b32 v238, v212
    v_mov_b32 v239, v213
    v_mul_f32 v212, v210, v202
    v_mul_f32 v210, v210, v203
    v_fmac_f32 v210, v206, v202
    v_fma_f32 v206, v206, v203, -v212
    s_barrier
    v_add_u32 v212, 155648, v3
    ds_read_b128 v[20:23], v212
    v_mov_b32 v217, 1
    v_mov_b32 v218, 0
    s_lshl_b32 s24, s21, 5
    s_and_b32 s25, s22, 0x1e
    s_add_u32 s24, s24, s25
    s_lshl_b32 s24, s24, 1
    s_and_b32 s25, s22, 1
    s_add_u32 s24, s24, s25
    s_lshl_b32 s24, s24, 2
    s_add_u32 s24, s24, s20
    s_lshl_b32 s24, s24, 12
    s_add_u32 s57, s24, 18874368
    s_add_u32 s58, s57, 32768
    v_lshlrev_b32 v212, 2, v3
    v_and_b32 v213, 48, v1
    v_add_u32 v216, v212, v213
    s_mov_b32 s42, 0xff00ff00
    s_mov_b32 s43, 0xff00ff00
    s_waitcnt lgkmcnt(0)
    v_pk_fma_f32 v[236:237], v[188:189], v[20:21], v[236:237] op_sel:[1,0,0] op_sel_hi:[1,1,1]
    v_pk_fma_f32 v[236:237], v[20:21], v[188:189], v[236:237] op_sel:[1,0,0] op_sel_hi:[0,0,1] neg_lo:[1,0,0]
    v_mov_b32 v228, v236
    v_mov_b32 v230, v237
    v_fma_f32 v229, v236, v185, v204
    v_fma_f32 v231, v237, v185, v208
    v_fma_f32 v229, -v237, v184, v229
    v_fma_f32 v231, v236, v184, v231
    v_pk_fma_f32 v[116:117], v[230:231], v[180:181], v[116:117] op_sel_hi:[1,0,1] neg_lo:[1,0,0] neg_hi:[1,0,0]
    v_pk_fma_f32 v[148:149], v[228:229], v[180:181], v[148:149] op_sel_hi:[1,0,1]
    v_pk_fma_f32 v[116:117], v[180:181], v[228:229], v[116:117] op_sel:[1,0,0] op_sel_hi:[1,1,1]
    v_pk_fma_f32 v[148:149], v[180:181], v[230:231], v[148:149] op_sel:[1,0,0] op_sel_hi:[1,1,1]
    v_pk_fma_f32 v[118:119], v[148:149], v[180:181], v[118:119] op_sel_hi:[1,0,1] neg_lo:[1,0,0] neg_hi:[1,0,0]
    v_pk_fma_f32 v[150:151], v[116:117], v[180:181], v[150:151] op_sel_hi:[1,0,1]
    v_pk_fma_f32 v[118:119], v[180:181], v[116:117], v[118:119] op_sel:[1,0,0] op_sel_hi:[1,1,1]
    v_pk_fma_f32 v[150:151], v[180:181], v[148:149], v[150:151] op_sel:[1,0,0] op_sel_hi:[1,1,1]
    v_pk_fma_f32 v[120:121], v[150:151], v[180:181], v[120:121] op_sel_hi:[1,0,1] neg_lo:[1,0,0] neg_hi:[1,0,0]
    v_pk_fma_f32 v[152:153], v[118:119], v[180:181], v[152:153] op_sel_hi:[1,0,1]
    v_pk_fma_f32 v[120:121], v[180:181], v[118:119], v[120:121] op_sel:[1,0,0] op_sel_hi:[1,1,1]
    v_pk_fma_f32 v[152:153], v[180:181], v[150:151], v[152:153] op_sel:[1,0,0] op_sel_hi:[1,1,1]
    v_pk_fma_f32 v[122:123], v[152:153], v[180:181], v[122:123] op_sel_hi:[1,0,1] neg_lo:[1,0,0] neg_hi:[1,0,0]
    v_pk_fma_f32 v[154:155], v[120:121], v[180:181], v[154:155] op_sel_hi:[1,0,1]
    v_pk_fma_f32 v[122:123], v[180:181], v[120:121], v[122:123] op_sel:[1,0,0] op_sel_hi:[1,1,1]
    v_pk_fma_f32 v[154:155], v[180:181], v[152:153], v[154:155] op_sel:[1,0,0] op_sel_hi:[1,1,1]
    v_cvt_pk_bf16_f32 v36, v116, v117
    v_cvt_pk_bf16_f32 v37, v118, v119
    v_cvt_pk_bf16_f32 v38, v120, v121
    v_cvt_pk_bf16_f32 v39, v122, v123
    s_mov_b64 exec, s[42:43]
    v_swap_b32 v36, v38
    v_swap_b32 v37, v39
    s_mov_b64 exec, -1
    buffer_store_dwordx4 v[36:39], v216, s[8:11], s57 offen offset:0 sc1
    v_cvt_pk_bf16_f32 v40, -v148, -v149
    v_cvt_pk_bf16_f32 v41, -v150, -v151
    v_cvt_pk_bf16_f32 v42, -v152, -v153
    v_cvt_pk_bf16_f32 v43, -v154, -v155
    s_mov_b64 exec, s[42:43]
    v_swap_b32 v40, v42
    v_swap_b32 v41, v43
    s_mov_b64 exec, -1
    buffer_store_dwordx4 v[40:43], v216, s[8:11], s58 offen offset:0 sc1
    v_pk_fma_f32 v[124:125], v[154:155], v[180:181], v[124:125] op_sel_hi:[1,0,1] neg_lo:[1,0,0] neg_hi:[1,0,0]
    v_pk_fma_f32 v[156:157], v[122:123], v[180:181], v[156:157] op_sel_hi:[1,0,1]
    v_pk_fma_f32 v[124:125], v[180:181], v[122:123], v[124:125] op_sel:[1,0,0] op_sel_hi:[1,1,1]
    v_pk_fma_f32 v[156:157], v[180:181], v[154:155], v[156:157] op_sel:[1,0,0] op_sel_hi:[1,1,1]
    v_pk_fma_f32 v[126:127], v[156:157], v[180:181], v[126:127] op_sel_hi:[1,0,1] neg_lo:[1,0,0] neg_hi:[1,0,0]
    v_pk_fma_f32 v[158:159], v[124:125], v[180:181], v[158:159] op_sel_hi:[1,0,1]
    v_pk_fma_f32 v[126:127], v[180:181], v[124:125], v[126:127] op_sel:[1,0,0] op_sel_hi:[1,1,1]
    v_pk_fma_f32 v[158:159], v[180:181], v[156:157], v[158:159] op_sel:[1,0,0] op_sel_hi:[1,1,1]
    v_pk_fma_f32 v[128:129], v[158:159], v[180:181], v[128:129] op_sel_hi:[1,0,1] neg_lo:[1,0,0] neg_hi:[1,0,0]
    v_pk_fma_f32 v[160:161], v[126:127], v[180:181], v[160:161] op_sel_hi:[1,0,1]
    v_pk_fma_f32 v[128:129], v[180:181], v[126:127], v[128:129] op_sel:[1,0,0] op_sel_hi:[1,1,1]
    v_pk_fma_f32 v[160:161], v[180:181], v[158:159], v[160:161] op_sel:[1,0,0] op_sel_hi:[1,1,1]
    v_pk_fma_f32 v[130:131], v[160:161], v[180:181], v[130:131] op_sel_hi:[1,0,1] neg_lo:[1,0,0] neg_hi:[1,0,0]
    v_pk_fma_f32 v[162:163], v[128:129], v[180:181], v[162:163] op_sel_hi:[1,0,1]
    v_pk_fma_f32 v[130:131], v[180:181], v[128:129], v[130:131] op_sel:[1,0,0] op_sel_hi:[1,1,1]
    v_pk_fma_f32 v[162:163], v[180:181], v[160:161], v[162:163] op_sel:[1,0,0] op_sel_hi:[1,1,1]
    v_cvt_pk_bf16_f32 v44, v124, v125
    v_cvt_pk_bf16_f32 v45, v126, v127
    v_cvt_pk_bf16_f32 v46, v128, v129
    v_cvt_pk_bf16_f32 v47, v130, v131
    s_mov_b64 exec, s[42:43]
    v_swap_b32 v44, v46
    v_swap_b32 v45, v47
    s_mov_b64 exec, -1
    buffer_store_dwordx4 v[44:47], v216, s[8:11], s57 offen offset:2048 sc1
    s_waitcnt vmcnt(3)
    s_mov_b64 exec, 1
    buffer_store_dword v217, v218, s[8:11], s91 offen sc1
    s_mov_b64 exec, -1
    v_cvt_pk_bf16_f32 v48, -v156, -v157
    v_cvt_pk_bf16_f32 v49, -v158, -v159
    v_cvt_pk_bf16_f32 v50, -v160, -v161
    v_cvt_pk_bf16_f32 v51, -v162, -v163
    s_mov_b64 exec, s[42:43]
    v_swap_b32 v48, v50
    v_swap_b32 v49, v51
    s_mov_b64 exec, -1
    buffer_store_dwordx4 v[48:51], v216, s[8:11], s58 offen offset:2048 sc1
    v_pk_fma_f32 v[238:239], v[190:191], v[22:23], v[238:239] op_sel:[1,0,0] op_sel_hi:[1,1,1]
    v_pk_fma_f32 v[238:239], v[22:23], v[190:191], v[238:239] op_sel:[1,0,0] op_sel_hi:[0,0,1] neg_lo:[1,0,0]
    v_mov_b32 v228, v238
    v_mov_b32 v230, v239
    v_fma_f32 v229, v238, v187, v206
    v_fma_f32 v231, v239, v187, v210
    v_fma_f32 v229, -v239, v186, v229
    v_fma_f32 v231, v238, v186, v231
    v_pk_fma_f32 v[132:133], v[230:231], v[182:183], v[132:133] op_sel_hi:[1,0,1] neg_lo:[1,0,0] neg_hi:[1,0,0]
    v_pk_fma_f32 v[164:165], v[228:229], v[182:183], v[164:165] op_sel_hi:[1,0,1]
    v_pk_fma_f32 v[132:133], v[182:183], v[228:229], v[132:133] op_sel:[1,0,0] op_sel_hi:[1,1,1]
    v_pk_fma_f32 v[164:165], v[182:183], v[230:231], v[164:165] op_sel:[1,0,0] op_sel_hi:[1,1,1]
    v_pk_fma_f32 v[134:135], v[164:165], v[182:183], v[134:135] op_sel_hi:[1,0,1] neg_lo:[1,0,0] neg_hi:[1,0,0]
    v_pk_fma_f32 v[166:167], v[132:133], v[182:183], v[166:167] op_sel_hi:[1,0,1]
    v_pk_fma_f32 v[134:135], v[182:183], v[132:133], v[134:135] op_sel:[1,0,0] op_sel_hi:[1,1,1]
    v_pk_fma_f32 v[166:167], v[182:183], v[164:165], v[166:167] op_sel:[1,0,0] op_sel_hi:[1,1,1]
    v_pk_fma_f32 v[136:137], v[166:167], v[182:183], v[136:137] op_sel_hi:[1,0,1] neg_lo:[1,0,0] neg_hi:[1,0,0]
    v_pk_fma_f32 v[168:169], v[134:135], v[182:183], v[168:169] op_sel_hi:[1,0,1]
    v_pk_fma_f32 v[136:137], v[182:183], v[134:135], v[136:137] op_sel:[1,0,0] op_sel_hi:[1,1,1]
    v_pk_fma_f32 v[168:169], v[182:183], v[166:167], v[168:169] op_sel:[1,0,0] op_sel_hi:[1,1,1]
    v_pk_fma_f32 v[138:139], v[168:169], v[182:183], v[138:139] op_sel_hi:[1,0,1] neg_lo:[1,0,0] neg_hi:[1,0,0]
    v_pk_fma_f32 v[170:171], v[136:137], v[182:183], v[170:171] op_sel_hi:[1,0,1]
    v_pk_fma_f32 v[138:139], v[182:183], v[136:137], v[138:139] op_sel:[1,0,0] op_sel_hi:[1,1,1]
    v_pk_fma_f32 v[170:171], v[182:183], v[168:169], v[170:171] op_sel:[1,0,0] op_sel_hi:[1,1,1]
    v_cvt_pk_bf16_f32 v36, v132, v133
    v_cvt_pk_bf16_f32 v37, v134, v135
    v_cvt_pk_bf16_f32 v38, v136, v137
    v_cvt_pk_bf16_f32 v39, v138, v139
    s_mov_b64 exec, s[42:43]
    v_swap_b32 v36, v38
    v_swap_b32 v37, v39
    s_mov_b64 exec, -1
    buffer_store_dwordx4 v[36:39], v216, s[8:11], s57 offen offset:1024 sc1
    v_cvt_pk_bf16_f32 v40, -v164, -v165
    v_cvt_pk_bf16_f32 v41, -v166, -v167
    v_cvt_pk_bf16_f32 v42, -v168, -v169
    v_cvt_pk_bf16_f32 v43, -v170, -v171
    s_mov_b64 exec, s[42:43]
    v_swap_b32 v40, v42
    v_swap_b32 v41, v43
    s_mov_b64 exec, -1
    buffer_store_dwordx4 v[40:43], v216, s[8:11], s58 offen offset:1024 sc1
    v_pk_fma_f32 v[140:141], v[170:171], v[182:183], v[140:141] op_sel_hi:[1,0,1] neg_lo:[1,0,0] neg_hi:[1,0,0]
    v_pk_fma_f32 v[172:173], v[138:139], v[182:183], v[172:173] op_sel_hi:[1,0,1]
    v_pk_fma_f32 v[140:141], v[182:183], v[138:139], v[140:141] op_sel:[1,0,0] op_sel_hi:[1,1,1]
    v_pk_fma_f32 v[172:173], v[182:183], v[170:171], v[172:173] op_sel:[1,0,0] op_sel_hi:[1,1,1]
    v_pk_fma_f32 v[142:143], v[172:173], v[182:183], v[142:143] op_sel_hi:[1,0,1] neg_lo:[1,0,0] neg_hi:[1,0,0]
    v_pk_fma_f32 v[174:175], v[140:141], v[182:183], v[174:175] op_sel_hi:[1,0,1]
    v_pk_fma_f32 v[142:143], v[182:183], v[140:141], v[142:143] op_sel:[1,0,0] op_sel_hi:[1,1,1]
    v_pk_fma_f32 v[174:175], v[182:183], v[172:173], v[174:175] op_sel:[1,0,0] op_sel_hi:[1,1,1]
    v_pk_fma_f32 v[144:145], v[174:175], v[182:183], v[144:145] op_sel_hi:[1,0,1] neg_lo:[1,0,0] neg_hi:[1,0,0]
    v_pk_fma_f32 v[176:177], v[142:143], v[182:183], v[176:177] op_sel_hi:[1,0,1]
    v_pk_fma_f32 v[144:145], v[182:183], v[142:143], v[144:145] op_sel:[1,0,0] op_sel_hi:[1,1,1]
    v_pk_fma_f32 v[176:177], v[182:183], v[174:175], v[176:177] op_sel:[1,0,0] op_sel_hi:[1,1,1]
    v_pk_fma_f32 v[146:147], v[176:177], v[182:183], v[146:147] op_sel_hi:[1,0,1] neg_lo:[1,0,0] neg_hi:[1,0,0]
    v_pk_fma_f32 v[178:179], v[144:145], v[182:183], v[178:179] op_sel_hi:[1,0,1]
    v_pk_fma_f32 v[146:147], v[182:183], v[144:145], v[146:147] op_sel:[1,0,0] op_sel_hi:[1,1,1]
    v_pk_fma_f32 v[178:179], v[182:183], v[176:177], v[178:179] op_sel:[1,0,0] op_sel_hi:[1,1,1]
    v_cvt_pk_bf16_f32 v44, v140, v141
    v_cvt_pk_bf16_f32 v45, v142, v143
    v_cvt_pk_bf16_f32 v46, v144, v145
    v_cvt_pk_bf16_f32 v47, v146, v147
    s_mov_b64 exec, s[42:43]
    v_swap_b32 v44, v46
    v_swap_b32 v45, v47
    s_mov_b64 exec, -1
    buffer_store_dwordx4 v[44:47], v216, s[8:11], s57 offen offset:3072 sc1
    v_cvt_pk_bf16_f32 v48, -v172, -v173
    v_cvt_pk_bf16_f32 v49, -v174, -v175
    v_cvt_pk_bf16_f32 v50, -v176, -v177
    v_cvt_pk_bf16_f32 v51, -v178, -v179
    s_mov_b64 exec, s[42:43]
    v_swap_b32 v48, v50
    v_swap_b32 v49, v51
    s_mov_b64 exec, -1
    buffer_store_dwordx4 v[48:51], v216, s[8:11], s58 offen offset:3072 sc1
K2_begin:
    s_load_dwordx2 s[4:5], s[0:1], 128
    s_load_dwordx2 s[6:7], s[0:1], 0
    s_load_dwordx4 s[44:47], s[0:1], 40
    s_load_dwordx4 s[48:51], s[0:1], 96
    s_load_dwordx2 s[52:53], s[0:1], 112
    s_load_dwordx2 s[42:43], s[0:1], 64
    s_mov_b32 s32, s90
    s_and_b32 s3, s2, 7
    s_lshr_b32 s37, s2, 3
    s_lshr_b32 s33, s3, 1
    s_and_b32 s34, s3, 1
    s_lshl_b32 s34, s34, 2
    s_lshr_b32 s38, s37, 3
    s_add_u32 s34, s34, s38
    s_and_b32 s35, s37, 7
    s_lshl_b32 s36, s34, 3
    s_add_u32 s36, s36, s35
    s_waitcnt lgkmcnt(0)
    s_mov_b32 s8, s4
    s_mov_b32 s9, s5
    s_mov_b32 s10, 268435456
    s_mov_b32 s11, 131072
    s_mov_b32 s12, s48
    s_mov_b32 s13, s49
    s_mov_b32 s14, 7340032
    s_mov_b32 s15, 131072
    s_mov_b32 s16, s44
    s_mov_b32 s17, s45
    s_mov_b32 s18, 2097152
    s_mov_b32 s19, 131072
    s_mov_b32 s20, s46
    s_mov_b32 s21, s47
    s_mov_b32 s22, 2097152
    s_mov_b32 s23, 131072
    s_mov_b32 s24, s6
    s_mov_b32 s25, s7
    s_mov_b32 s26, 4194304
    s_mov_b32 s27, 131072
    s_mov_b32 s28, s52
    s_mov_b32 s29, s53
    s_mov_b32 s30, 8388608
    s_mov_b32 s31, 131072
    s_mov_b32 s40, s50
    s_mov_b32 s41, s51
    s_cmp_ge_u32 s32, 4
    s_cbranch_scc1 K2_loader
    v_lshlrev_b32 v241, 4, v1
    s_mov_b32 s54, 0
    s_mov_b32 s57, 32768
    v_mov_b32 v4, 0
    v_mov_b32 v5, 0
    v_mov_b32 v6, 0
    v_mov_b32 v7, 0
    v_mov_b32 v8, 0
    v_mov_b32 v9, 0
    v_mov_b32 v10, 0
    v_mov_b32 v11, 0
    v_mov_b32 v12, 0
    v_mov_b32 v13, 0
    v_mov_b32 v14, 0
    v_mov_b32 v15, 0
    v_mov_b32 v16, 0
    v_mov_b32 v17, 0
    v_mov_b32 v18, 0
    v_mov_b32 v19, 0
    v_mov_b32 v20, 0
    v_mov_b32 v21, 0
    v_mov_b32 v22, 0
    v_mov_b32 v23, 0
    v_mov_b32 v24, 0
    v_mov_b32 v25, 0
    v_mov_b32 v26, 0
    v_mov_b32 v27, 0
    v_mov_b32 v28, 0
    v_mov_b32 v29, 0
    v_mov_b32 v30, 0
    v_mov_b32 v31, 0
    v_mov_b32 v32, 0
    v_mov_b32 v33, 0
    v_mov_b32 v34, 0
    v_mov_b32 v35, 0
    v_mov_b32 v36, 0
    v_mov_b32 v37, 0
    v_mov_b32 v38, 0
    v_mov_b32 v39, 0
    v_mov_b32 v40, 0
    v_mov_b32 v41, 0
    v_mov_b32 v42, 0
    v_mov_b32 v43, 0
    v_mov_b32 v44, 0
    v_mov_b32 v45, 0
    v_mov_b32 v46, 0
    v_mov_b32 v47, 0
    v_mov_b32 v48, 0
    v_mov_b32 v49, 0
    v_mov_b32 v50, 0
    v_mov_b32 v51, 0
    v_mov_b32 v52, 0
    v_mov_b32 v53, 0
    v_mov_b32 v54, 0
    v_mov_b32 v55, 0
    v_mov_b32 v56, 0
    v_mov_b32 v57, 0
    v_mov_b32 v58, 0
    v_mov_b32 v59, 0
    v_mov_b32 v60, 0
    v_mov_b32 v61, 0
    v_mov_b32 v62, 0
    v_mov_b32 v63, 0
    v_mov_b32 v64, 0
    v_mov_b32 v65, 0
    v_mov_b32 v66, 0
    v_mov_b32 v67, 0
    v_mov_b32 v68, 0
    v_mov_b32 v69, 0
    v_mov_b32 v70, 0
    v_mov_b32 v71, 0
    v_mov_b32 v72, 0
    v_mov_b32 v73, 0
    v_mov_b32 v74, 0
    v_mov_b32 v75, 0
    v_mov_b32 v76, 0
    v_mov_b32 v77, 0
    v_mov_b32 v78, 0
    v_mov_b32 v79, 0
    v_mov_b32 v80, 0
    v_mov_b32 v81, 0
    v_mov_b32 v82, 0
    v_mov_b32 v83, 0
    v_mov_b32 v84, 0
    v_mov_b32 v85, 0
    v_mov_b32 v86, 0
    v_mov_b32 v87, 0
    v_mov_b32 v88, 0
    v_mov_b32 v89, 0
    v_mov_b32 v90, 0
    v_mov_b32 v91, 0
    v_mov_b32 v92, 0
    v_mov_b32 v93, 0
    v_mov_b32 v94, 0
    v_mov_b32 v95, 0
    v_mov_b32 v96, 0
    v_mov_b32 v97, 0
    v_mov_b32 v98, 0
    v_mov_b32 v99, 0
    v_mov_b32 v100, 0
    v_mov_b32 v101, 0
    v_mov_b32 v102, 0
    v_mov_b32 v103, 0
    v_mov_b32 v104, 0
    v_mov_b32 v105, 0
    v_mov_b32 v106, 0
    v_mov_b32 v107, 0
    v_mov_b32 v108, 0
    v_mov_b32 v109, 0
    v_mov_b32 v110, 0
    v_mov_b32 v111, 0
    v_mov_b32 v112, 0
    v_mov_b32 v113, 0
    v_mov_b32 v114, 0
    v_mov_b32 v115, 0
    v_mov_b32 v116, 0
    v_mov_b32 v117, 0
    v_mov_b32 v118, 0
    v_mov_b32 v119, 0
    v_mov_b32 v120, 0
    v_mov_b32 v121, 0
    v_mov_b32 v122, 0
    v_mov_b32 v123, 0
    v_mov_b32 v124, 0
    v_mov_b32 v125, 0
    v_mov_b32 v126, 0
    v_mov_b32 v127, 0
    v_mov_b32 v128, 0
    v_mov_b32 v129, 0
    v_mov_b32 v130, 0
    v_mov_b32 v131, 0
    s_nop 1
    s_cmp_eq_u32 s33, 0
    s_cbranch_scc1 K2_c0
    s_cmp_eq_u32 s33, 1
    s_cbranch_scc1 K2_c1
    s_cmp_eq_u32 s33, 2
    s_cbranch_scc1 K2_c2
    s_branch K2_c3
K2_c0:
    v_mov_b32 v238, 1
    v_mov_b32 v239, 0
    s_waitcnt vmcnt(0)
    s_mov_b64 exec, 1
    buffer_store_dword v238, v239, s[8:11], s91 offen offset:512 sc1
    s_mov_b64 exec, -1
    s_lshl_b32 s55, s32, 12
    s_add_u32 s55, s55, s54
    v_lshrrev_b32 v238, 5, v1
    v_lshlrev_b32 v239, 10, v238
    v_bfe_u32 v238, v1, 4, 1
    v_lshl_add_u32 v239, v238, 9, v239
    v_lshl_add_u32 v239, v238, 3, v239
    v_bfe_u32 v238, v1, 2, 2
    v_lshl_add_u32 v239, v238, 6, v239
    v_and_b32 v238, 3, v1
    v_lshl_add_u32 v239, v238, 4, v239
    v_add_u32 v228, s55, v239
    v_xor_b32 v239, 8, v239
    v_add_u32 v229, s55, v239
    v_and_b32 v238, 15, v1
    v_lshrrev_b32 v239, 1, v238
    v_lshrrev_b32 v240, 4, v1
    v_xor_b32 v239, v239, v240
    v_lshlrev_b32 v239, 4, v239
    v_lshl_add_u32 v239, v238, 7, v239
    s_lshr_b32 s55, s54, 1
    s_add_u32 s55, s55, 98304
    v_add_u32 v230, s55, v239
    v_xor_b32 v239, 64, v239
    v_add_u32 v231, s55, v239
    s_barrier
    ds_read_b64_tr_b16 v[132:133], v228 offset:0
    ds_read_b64_tr_b16 v[134:135], v228 offset:256
    ds_read_b64_tr_b16 v[136:137], v229 offset:0
    ds_read_b64_tr_b16 v[138:139], v229 offset:256
    ds_read_b64_tr_b16 v[140:141], v228 offset:2048
    ds_read_b64_tr_b16 v[142:143], v228 offset:2304
    ds_read_b64_tr_b16 v[144:145], v229 offset:2048
    ds_read_b64_tr_b16 v[146:147], v229 offset:2304
    ds_read_b128 v[148:151], v230 offset:0
    ds_read_b128 v[152:155], v230 offset:2048
    ds_read_b128 v[156:159], v230 offset:4096
    ds_read_b128 v[160:163], v230 offset:6144
    ds_read_b128 v[164:167], v230 offset:8192
    ds_read_b128 v[168:171], v230 offset:10240
    ds_read_b128 v[172:175], v230 offset:12288
    ds_read_b128 v[176:179], v230 offset:14336
    s_mov_b32 s59, 20
K1_loop_3:
    s_waitcnt lgkmcnt(0)
    v_mfma_f32_16x16x32_bf16 v[4:7], v[148:151], v[132:135], v[4:7]
    ds_read_b64_tr_b16 v[180:181], v228 offset:16384
    v_mfma_f32_16x16x32_bf16 v[36:39], v[148:151], v[136:139], v[36:39]
    ds_read_b64_tr_b16 v[182:183], v228 offset:16640
    v_mfma_f32_16x16x32_bf16 v[68:71], v[148:151], v[140:143], v[68:71]
    ds_read_b64_tr_b16 v[184:185], v229 offset:16384
    v_mfma_f32_16x16x32_bf16 v[100:103], v[148:151], v[144:147], v[100:103]
    ds_read_b64_tr_b16 v[186:187], v229 offset:16640
    v_mfma_f32_16x16x32_bf16 v[104:107], v[152:155], v[144:147], v[104:107]
    ds_read_b64_tr_b16 v[188:189], v228 offset:18432
    v_mfma_f32_16x16x32_bf16 v[72:75], v[152:155], v[140:143], v[72:75]
    ds_read_b64_tr_b16 v[190:191], v228 offset:18688
    v_mfma_f32_16x16x32_bf16 v[40:43], v[152:155], v[136:139], v[40:43]
    ds_read_b64_tr_b16 v[192:193], v229 offset:18432
    v_mfma_f32_16x16x32_bf16 v[8:11], v[152:155], v[132:135], v[8:11]
    ds_read_b64_tr_b16 v[194:195], v229 offset:18688
    v_mfma_f32_16x16x32_bf16 v[12:15], v[156:159], v[132:135], v[12:15]
    ds_read_b128 v[196:199], v231 offset:0
    v_mfma_f32_16x16x32_bf16 v[44:47], v[156:159], v[136:139], v[44:47]
    ds_read_b128 v[200:203], v231 offset:2048
    v_mfma_f32_16x16x32_bf16 v[76:79], v[156:159], v[140:143], v[76:79]
    ds_read_b128 v[204:207], v231 offset:4096
    v_mfma_f32_16x16x32_bf16 v[108:111], v[156:159], v[144:147], v[108:111]
    ds_read_b128 v[208:211], v231 offset:6144
    v_mfma_f32_16x16x32_bf16 v[112:115], v[160:163], v[144:147], v[112:115]
    ds_read_b128 v[212:215], v231 offset:8192
    v_mfma_f32_16x16x32_bf16 v[80:83], v[160:163], v[140:143], v[80:83]
    ds_read_b128 v[216:219], v231 offset:10240
    v_mfma_f32_16x16x32_bf16 v[48:51], v[160:163], v[136:139], v[48:51]
    ds_read_b128 v[220:223], v231 offset:12288
    v_mfma_f32_16x16x32_bf16 v[16:19], v[160:163], v[132:135], v[16:19]
    ds_read_b128 v[224:227], v231 offset:14336
    v_mfma_f32_16x16x32_bf16 v[20:23], v[164:167], v[132:135], v[20:23]
    s_add_u32 s54, s54, 32768
    s_cmp_eq_u32 s54, 98304
    s_cselect_b32 s56, 4294901760, s57
    s_cselect_b32 s54, 0, s54
    s_ashr_i32 s73, s56, 1
    v_mfma_f32_16x16x32_bf16 v[52:55], v[164:167], v[136:139], v[52:55]
    v_add_u32 v228, s56, v228
    v_mfma_f32_16x16x32_bf16 v[84:87], v[164:167], v[140:143], v[84:87]
    v_add_u32 v229, s56, v229
    v_mfma_f32_16x16x32_bf16 v[116:119], v[164:167], v[144:147], v[116:119]
    v_add_u32 v230, s73, v230
    v_mfma_f32_16x16x32_bf16 v[120:123], v[168:171], v[144:147], v[120:123]
    v_add_u32 v231, s73, v231
    v_mfma_f32_16x16x32_bf16 v[88:91], v[168:171], v[140:143], v[88:91]
    v_mfma_f32_16x16x32_bf16 v[56:59], v[168:171], v[136:139], v[56:59]
    v_mfma_f32_16x16x32_bf16 v[24:27], v[168:171], v[132:135], v[24:27]
    v_mfma_f32_16x16x32_bf16 v[28:31], v[172:175], v[132:135], v[28:31]
    v_mfma_f32_16x16x32_bf16 v[60:63], v[172:175], v[136:139], v[60:63]
    v_mfma_f32_16x16x32_bf16 v[92:95], v[172:175], v[140:143], v[92:95]
    v_mfma_f32_16x16x32_bf16 v[124:127], v[172:175], v[144:147], v[124:127]
    v_mfma_f32_16x16x32_bf16 v[128:131], v[176:179], v[144:147], v[128:131]
    v_mfma_f32_16x16x32_bf16 v[96:99], v[176:179], v[140:143], v[96:99]
    v_mfma_f32_16x16x32_bf16 v[64:67], v[176:179], v[136:139], v[64:67]
    v_mfma_f32_16x16x32_bf16 v[32:35], v[176:179], v[132:135], v[32:35]
    s_waitcnt lgkmcnt(0)
    s_barrier
    v_mfma_f32_16x16x32_bf16 v[4:7], v[196:199], v[180:183], v[4:7]
    ds_read_b64_tr_b16 v[132:133], v228 offset:0
    v_mfma_f32_16x16x32_bf16 v[36:39], v[196:199], v[184:187], v[36:39]
    ds_read_b64_tr_b16 v[134:135], v228 offset:256
    v_mfma_f32_16x16x32_bf16 v[68:71], v[196:199], v[188:191], v[68:71]
    ds_read_b64_tr_b16 v[136:137], v229 offset:0
    v_mfma_f32_16x16x32_bf16 v[100:103], v[196:199], v[192:195], v[100:103]
    ds_read_b64_tr_b16 v[138:139], v229 offset:256
    v_mfma_f32_16x16x32_bf16 v[104:107], v[200:203], v[192:195], v[104:107]
    ds_read_b64_tr_b16 v[140:141], v228 offset:2048
    v_mfma_f32_16x16x32_bf16 v[72:75], v[200:203], v[188:191], v[72:75]
    ds_read_b64_tr_b16 v[142:143], v228 offset:2304
    v_mfma_f32_16x16x32_bf16 v[40:43], v[200:203], v[184:187], v[40:43]
    ds_read_b64_tr_b16 v[144:145], v229 offset:2048
    v_mfma_f32_16x16x32_bf16 v[8:11], v[200:203], v[180:183], v[8:11]
    ds_read_b64_tr_b16 v[146:147], v229 offset:2304
    v_mfma_f32_16x16x32_bf16 v[12:15], v[204:207], v[180:183], v[12:15]
    ds_read_b128 v[148:151], v230 offset:0
    v_mfma_f32_16x16x32_bf16 v[44:47], v[204:207], v[184:187], v[44:47]
    ds_read_b128 v[152:155], v230 offset:2048
    v_mfma_f32_16x16x32_bf16 v[76:79], v[204:207], v[188:191], v[76:79]
    ds_read_b128 v[156:159], v230 offset:4096
    v_mfma_f32_16x16x32_bf16 v[108:111], v[204:207], v[192:195], v[108:111]
    ds_read_b128 v[160:163], v230 offset:6144
    v_mfma_f32_16x16x32_bf16 v[112:115], v[208:211], v[192:195], v[112:115]
    ds_read_b128 v[164:167], v230 offset:8192
    v_mfma_f32_16x16x32_bf16 v[80:83], v[208:211], v[188:191], v[80:83]
    ds_read_b128 v[168:171], v230 offset:10240
    v_mfma_f32_16x16x32_bf16 v[48:51], v[208:211], v[184:187], v[48:51]
    ds_read_b128 v[172:175], v230 offset:12288
    v_mfma_f32_16x16x32_bf16 v[16:19], v[208:211], v[180:183], v[16:19]
    ds_read_b128 v[176:179], v230 offset:14336
    v_mfma_f32_16x16x32_bf16 v[20:23], v[212:215], v[180:183], v[20:23]
    v_mfma_f32_16x16x32_bf16 v[52:55], v[212:215], v[184:187], v[52:55]
    v_mfma_f32_16x16x32_bf16 v[84:87], v[212:215], v[188:191], v[84:87]
    v_mfma_f32_16x16x32_bf16 v[116:119], v[212:215], v[192:195], v[116:119]
    v_mfma_f32_16x16x32_bf16 v[120:123], v[216:219], v[192:195], v[120:123]
    v_mfma_f32_16x16x32_bf16 v[88:91], v[216:219], v[188:191], v[88:91]
    v_mfma_f32_16x16x32_bf16 v[56:59], v[216:219], v[184:187], v[56:59]
    v_mfma_f32_16x16x32_bf16 v[24:27], v[216:219], v[180:183], v[24:27]
    v_mfma_f32_16x16x32_bf16 v[28:31], v[220:223], v[180:183], v[28:31]
    v_mfma_f32_16x16x32_bf16 v[60:63], v[220:223], v[184:187], v[60:63]
    v_mfma_f32_16x16x32_bf16 v[92:95], v[220:223], v[188:191], v[92:95]
    v_mfma_f32_16x16x32_bf16 v[124:127], v[220:223], v[192:195], v[124:127]
    v_mfma_f32_16x16x32_bf16 v[128:131], v[224:227], v[192:195], v[128:131]
    v_mfma_f32_16x16x32_bf16 v[96:99], v[224:227], v[188:191], v[96:99]
    v_mfma_f32_16x16x32_bf16 v[64:67], v[224:227], v[184:187], v[64:67]
    v_mfma_f32_16x16x32_bf16 v[32:35], v[224:227], v[180:183], v[32:35]
    s_sub_u32 s59, s59, 1
    s_cmp_lg_u32 s59, 0
    s_cbranch_scc1 K1_loop_3
    s_waitcnt lgkmcnt(0)
    v_mfma_f32_16x16x32_bf16 v[4:7], v[148:151], v[132:135], v[4:7]
    ds_read_b64_tr_b16 v[180:181], v228 offset:16384
    v_mfma_f32_16x16x32_bf16 v[36:39], v[148:151], v[136:139], v[36:39]
    ds_read_b64_tr_b16 v[182:183], v228 offset:16640
    v_mfma_f32_16x16x32_bf16 v[68:71], v[148:151], v[140:143], v[68:71]
    ds_read_b64_tr_b16 v[184:185], v229 offset:16384
    v_mfma_f32_16x16x32_bf16 v[100:103], v[148:151], v[144:147], v[100:103]
    ds_read_b64_tr_b16 v[186:187], v229 offset:16640
    v_mfma_f32_16x16x32_bf16 v[104:107], v[152:155], v[144:147], v[104:107]
    ds_read_b64_tr_b16 v[188:189], v228 offset:18432
    v_mfma_f32_16x16x32_bf16 v[72:75], v[152:155], v[140:143], v[72:75]
    ds_read_b64_tr_b16 v[190:191], v228 offset:18688
    v_mfma_f32_16x16x32_bf16 v[40:43], v[152:155], v[136:139], v[40:43]
    ds_read_b64_tr_b16 v[192:193], v229 offset:18432
    v_mfma_f32_16x16x32_bf16 v[8:11], v[152:155], v[132:135], v[8:11]
    ds_read_b64_tr_b16 v[194:195], v229 offset:18688
    v_mfma_f32_16x16x32_bf16 v[12:15], v[156:159], v[132:135], v[12:15]
    ds_read_b128 v[196:199], v231 offset:0
    v_mfma_f32_16x16x32_bf16 v[44:47], v[156:159], v[136:139], v[44:47]
    ds_read_b128 v[200:203], v231 offset:2048
    v_mfma_f32_16x16x32_bf16 v[76:79], v[156:159], v[140:143], v[76:79]
    ds_read_b128 v[204:207], v231 offset:4096
    v_mfma_f32_16x16x32_bf16 v[108:111], v[156:159], v[144:147], v[108:111]
    ds_read_b128 v[208:211], v231 offset:6144
    v_mfma_f32_16x16x32_bf16 v[112:115], v[160:163], v[144:147], v[112:115]
    ds_read_b128 v[212:215], v231 offset:8192
    v_mfma_f32_16x16x32_bf16 v[80:83], v[160:163], v[140:143], v[80:83]
    ds_read_b128 v[216:219], v231 offset:10240
    v_mfma_f32_16x16x32_bf16 v[48:51], v[160:163], v[136:139], v[48:51]
    ds_read_b128 v[220:223], v231 offset:12288
    v_mfma_f32_16x16x32_bf16 v[16:19], v[160:163], v[132:135], v[16:19]
    ds_read_b128 v[224:227], v231 offset:14336
    v_mfma_f32_16x16x32_bf16 v[20:23], v[164:167], v[132:135], v[20:23]
    s_cmp_lt_u32 s32, s33
    s_subb_u32 s69, s33, 0
    s_lshl_b32 s58, s36, 2
    s_add_u32 s58, s58, s32
    s_lshl_b32 s55, s58, 7
    s_add_u32 s55, s55, s69
    s_lshl_b32 s55, s55, 2
    s_add_u32 s55, s55, 49283072
    s_lshl_b32 s58, s58, 2
    s_add_u32 s58, s58, s69
    s_lshl_b32 s58, s58, 14
    s_add_u32 s58, s58, 27262976
    s_mov_b32 s59, 32768
    s_cmp_eq_u32 s32, s33
    s_cselect_b32 s58, 0x20000000, s58
    s_cselect_b32 s55, 0x20000000, s55
    s_cselect_b32 s69, s59, 114688
    v_add_u32 v251, s69, v241
    v_mfma_f32_16x16x32_bf16 v[52:55], v[164:167], v[136:139], v[52:55]
    v_mov_b32 v244, 1
    v_mov_b32 v239, 0
    v_mfma_f32_16x16x32_bf16 v[84:87], v[164:167], v[140:143], v[84:87]
    s_xor_b32 s71, s32, 4
    s_lshr_b32 s71, s71, 1
    s_and_b32 s72, s32, 1
    s_lshl_b32 s68, s34, 8
    s_lshl_b32 s69, s33, 6
    s_add_u32 s68, s68, s69
    s_lshl_b32 s69, s72, 2
    s_add_u32 s68, s68, s69
    v_and_b32 v252, 15, v1
    v_mfma_f32_16x16x32_bf16 v[116:119], v[164:167], v[144:147], v[116:119]
    v_lshrrev_b32 v248, 2, v252
    v_lshlrev_b32 v248, 4, v248
    v_mfma_f32_16x16x32_bf16 v[120:123], v[168:171], v[144:147], v[120:123]
    v_and_b32 v253, 1, v252
    v_lshl_add_u32 v248, v253, 3, v248
    v_mfma_f32_16x16x32_bf16 v[88:91], v[168:171], v[140:143], v[88:91]
    v_bfe_u32 v253, v252, 1, 1
    v_add_u32 v248, v248, v253
    v_mfma_f32_16x16x32_bf16 v[56:59], v[168:171], v[136:139], v[56:59]
    v_add_u32 v248, s68, v248
    s_lshl_b32 s68, s35, 7
    s_lshl_b32 s69, s71, 5
    s_add_u32 s68, s68, s69
    v_lshrrev_b32 v252, 4, v1
    v_mfma_f32_16x16x32_bf16 v[24:27], v[168:171], v[132:135], v[24:27]
    v_lshl_add_u32 v252, v252, 2, s68
    v_lshlrev_b32 v253, 4, v248
    v_mfma_f32_16x16x32_bf16 v[28:31], v[172:175], v[132:135], v[28:31]
    v_lshlrev_b32 v249, 12, v248
    v_lshl_add_u32 v249, v252, 2, v249
    v_mfma_f32_16x16x32_bf16 v[60:63], v[172:175], v[136:139], v[60:63]
    v_lshrrev_b32 v248, 1, v249
    v_lshlrev_b32 v252, 1, v252
    s_mov_b32 s60, 0
    s_mov_b32 s61, 4096
    s_mov_b32 s62, 8192
    s_mov_b32 s63, 0
    s_mov_b32 s68, 48234496
    v_mfma_f32_16x16x32_bf16 v[92:95], v[172:175], v[140:143], v[92:95]
    v_mfma_f32_16x16x32_bf16 v[124:127], v[172:175], v[144:147], v[124:127]
    v_mfma_f32_16x16x32_bf16 v[128:131], v[176:179], v[144:147], v[128:131]
    v_mfma_f32_16x16x32_bf16 v[96:99], v[176:179], v[140:143], v[96:99]
    v_mfma_f32_16x16x32_bf16 v[64:67], v[176:179], v[136:139], v[64:67]
    v_mfma_f32_16x16x32_bf16 v[32:35], v[176:179], v[132:135], v[32:35]
    s_waitcnt lgkmcnt(0)
    s_barrier
    s_branch K2_last1
K2_c1:
    s_lshl_b32 s55, s32, 12
    s_add_u32 s55, s55, s54
    v_add_u32 v228, s55, v241
    v_lshrrev_b32 v238, 2, v1
    v_lshlrev_b32 v239, 8, v238
    v_and_b32 v238, 7, v238
    v_lshl_add_u32 v239, v238, 5, v239
    v_and_b32 v238, 3, v1
    v_lshl_add_u32 v239, v238, 3, v239
    s_lshr_b32 s55, s54, 1
    s_add_u32 s55, s55, 98304
    v_xor_b32 v238, 0, v239
    v_add_u32 v230, s55, v238
    v_xor_b32 v238, 32, v239
    v_add_u32 v231, s55, v238
    v_xor_b32 v238, 64, v239
    v_add_u32 v232, s55, v238
    v_xor_b32 v238, 96, v239
    v_add_u32 v233, s55, v238
    v_xor_b32 v238, 128, v239
    v_add_u32 v234, s55, v238
    v_xor_b32 v238, 160, v239
    v_add_u32 v235, s55, v238
    v_xor_b32 v238, 192, v239
    v_add_u32 v236, s55, v238
    v_xor_b32 v238, 224, v239
    v_add_u32 v237, s55, v238
    s_barrier
    ds_read_b128 v[132:135], v228 offset:0
    ds_read_b128 v[136:139], v228 offset:1024
    ds_read_b128 v[140:143], v228 offset:2048
    ds_read_b128 v[144:147], v228 offset:3072
    ds_read_b64_tr_b16 v[148:149], v230 offset:0
    ds_read_b64_tr_b16 v[150:151], v230 offset:4096
    ds_read_b64_tr_b16 v[152:153], v231 offset:0
    ds_read_b64_tr_b16 v[154:155], v231 offset:4096
    ds_read_b64_tr_b16 v[156:157], v232 offset:0
    ds_read_b64_tr_b16 v[158:159], v232 offset:4096
    ds_read_b64_tr_b16 v[160:161], v233 offset:0
    ds_read_b64_tr_b16 v[162:163], v233 offset:4096
    ds_read_b64_tr_b16 v[164:165], v234 offset:0
    ds_read_b64_tr_b16 v[166:167], v234 offset:4096
    ds_read_b64_tr_b16 v[168:169], v235 offset:0
    ds_read_b64_tr_b16 v[170:171], v235 offset:4096
    ds_read_b64_tr_b16 v[172:173], v236 offset:0
    ds_read_b64_tr_b16 v[174:175], v236 offset:4096
    ds_read_b64_tr_b16 v[176:177], v237 offset:0
    ds_read_b64_tr_b16 v[178:179], v237 offset:4096
    s_waitcnt lgkmcnt(0)
    v_mfma_f32_16x16x32_bf16 v[4:7], v[148:151], v[132:135], v[4:7]
    ds_read_b128 v[180:183], v228 offset:16384
    v_mfma_f32_16x16x32_bf16 v[36:39], v[148:151], v[136:139], v[36:39]
    ds_read_b128 v[184:187], v228 offset:17408
    v_mfma_f32_16x16x32_bf16 v[68:71], v[148:151], v[140:143], v[68:71]
    ds_read_b128 v[188:191], v228 offset:18432
    v_mfma_f32_16x16x32_bf16 v[100:103], v[148:151], v[144:147], v[100:103]
    ds_read_b128 v[192:195], v228 offset:19456
    v_mfma_f32_16x16x32_bf16 v[104:107], v[152:155], v[144:147], v[104:107]
    ds_read_b64_tr_b16 v[196:197], v230 offset:8192
    v_mfma_f32_16x16x32_bf16 v[72:75], v[152:155], v[140:143], v[72:75]
    ds_read_b64_tr_b16 v[198:199], v230 offset:12288
    v_mfma_f32_16x16x32_bf16 v[40:43], v[152:155], v[136:139], v[40:43]
    ds_read_b64_tr_b16 v[200:201], v231 offset:8192
    v_mfma_f32_16x16x32_bf16 v[8:11], v[152:155], v[132:135], v[8:11]
    ds_read_b64_tr_b16 v[202:203], v231 offset:12288
    v_mfma_f32_16x16x32_bf16 v[12:15], v[156:159], v[132:135], v[12:15]
    ds_read_b64_tr_b16 v[204:205], v232 offset:8192
    v_mfma_f32_16x16x32_bf16 v[44:47], v[156:159], v[136:139], v[44:47]
    ds_read_b64_tr_b16 v[206:207], v232 offset:12288
    v_mfma_f32_16x16x32_bf16 v[76:79], v[156:159], v[140:143], v[76:79]
    ds_read_b64_tr_b16 v[208:209], v233 offset:8192
    v_mfma_f32_16x16x32_bf16 v[108:111], v[156:159], v[144:147], v[108:111]
    ds_read_b64_tr_b16 v[210:211], v233 offset:12288
    v_mfma_f32_16x16x32_bf16 v[112:115], v[160:163], v[144:147], v[112:115]
    ds_read_b64_tr_b16 v[212:213], v234 offset:8192
    v_mfma_f32_16x16x32_bf16 v[80:83], v[160:163], v[140:143], v[80:83]
    ds_read_b64_tr_b16 v[214:215], v234 offset:12288
    v_mfma_f32_16x16x32_bf16 v[48:51], v[160:163], v[136:139], v[48:51]
    ds_read_b64_tr_b16 v[216:217], v235 offset:8192
    v_mfma_f32_16x16x32_bf16 v[16:19], v[160:163], v[132:135], v[16:19]
    ds_read_b64_tr_b16 v[218:219], v235 offset:12288
    v_mfma_f32_16x16x32_bf16 v[20:23], v[164:167], v[132:135], v[20:23]
    ds_read_b64_tr_b16 v[220:221], v236 offset:8192
    v_mfma_f32_16x16x32_bf16 v[52:55], v[164:167], v[136:139], v[52:55]
    ds_read_b64_tr_b16 v[222:223], v236 offset:12288
    v_mfma_f32_16x16x32_bf16 v[84:87], v[164:167], v[140:143], v[84:87]
    ds_read_b64_tr_b16 v[224:225], v237 offset:8192
    v_mfma_f32_16x16x32_bf16 v[116:119], v[164:167], v[144:147], v[116:119]
    ds_read_b64_tr_b16 v[226:227], v237 offset:12288
    v_mfma_f32_16x16x32_bf16 v[120:123], v[168:171], v[144:147], v[120:123]
    s_add_u32 s54, s54, 32768
    s_cmp_eq_u32 s54, 98304
    s_cselect_b32 s56, 4294901760, s57
    s_cselect_b32 s54, 0, s54
    s_ashr_i32 s73, s56, 1
    v_mfma_f32_16x16x32_bf16 v[88:91], v[168:171], v[140:143], v[88:91]
    v_add_u32 v228, s56, v228
    v_mfma_f32_16x16x32_bf16 v[56:59], v[168:171], v[136:139], v[56:59]
    v_add_u32 v230, s73, v230
    v_mfma_f32_16x16x32_bf16 v[24:27], v[168:171], v[132:135], v[24:27]
    v_add_u32 v231, s73, v231
    v_mfma_f32_16x16x32_bf16 v[28:31], v[172:175], v[132:135], v[28:31]
    v_add_u32 v232, s73, v232
    v_mfma_f32_16x16x32_bf16 v[60:63], v[172:175], v[136:139], v[60:63]
    v_add_u32 v233, s73, v233
    v_mfma_f32_16x16x32_bf16 v[92:95], v[172:175], v[140:143], v[92:95]
    v_add_u32 v234, s73, v234
    v_mfma_f32_16x16x32_bf16 v[124:127], v[172:175], v[144:147], v[124:127]
    v_add_u32 v235, s73, v235
    v_mfma_f32_16x16x32_bf16 v[128:131], v[176:179], v[144:147], v[128:131]
    v_add_u32 v236, s73, v236
    v_mfma_f32_16x16x32_bf16 v[96:99], v[176:179], v[140:143], v[96:99]
    v_add_u32 v237, s73, v237
    v_mfma_f32_16x16x32_bf16 v[64:67], v[176:179], v[136:139], v[64:67]
    v_mfma_f32_16x16x32_bf16 v[32:35], v[176:179], v[132:135], v[32:35]
    v_mov_b32 v238, 1
    v_mov_b32 v239, 0
    s_waitcnt vmcnt(0)
    s_mov_b64 exec, 1
    buffer_store_dword v238, v239, s[8:11], s91 offen offset:512 sc1
    s_mov_b64 exec, -1
    s_waitcnt lgkmcnt(0)
    s_barrier
    v_mfma_f32_16x16x32_bf16 v[4:7], v[196:199], v[180:183], v[4:7]
    ds_read_b128 v[132:135], v228 offset:0
    v_mfma_f32_16x16x32_bf16 v[36:39], v[196:199], v[184:187], v[36:39]
    ds_read_b128 v[136:139], v228 offset:1024
    v_mfma_f32_16x16x32_bf16 v[68:71], v[196:199], v[188:191], v[68:71]
    ds_read_b128 v[140:143], v228 offset:2048
    v_mfma_f32_16x16x32_bf16 v[100:103], v[196:199], v[192:195], v[100:103]
    ds_read_b128 v[144:147], v228 offset:3072
    v_mfma_f32_16x16x32_bf16 v[104:107], v[200:203], v[192:195], v[104:107]
    ds_read_b64_tr_b16 v[148:149], v230 offset:0
    v_mfma_f32_16x16x32_bf16 v[72:75], v[200:203], v[188:191], v[72:75]
    ds_read_b64_tr_b16 v[150:151], v230 offset:4096
    v_mfma_f32_16x16x32_bf16 v[40:43], v[200:203], v[184:187], v[40:43]
    ds_read_b64_tr_b16 v[152:153], v231 offset:0
    v_mfma_f32_16x16x32_bf16 v[8:11], v[200:203], v[180:183], v[8:11]
    ds_read_b64_tr_b16 v[154:155], v231 offset:4096
    v_mfma_f32_16x16x32_bf16 v[12:15], v[204:207], v[180:183], v[12:15]
    ds_read_b64_tr_b16 v[156:157], v232 offset:0
    v_mfma_f32_16x16x32_bf16 v[44:47], v[204:207], v[184:187], v[44:47]
    ds_read_b64_tr_b16 v[158:159], v232 offset:4096
    v_mfma_f32_16x16x32_bf16 v[76:79], v[204:207], v[188:191], v[76:79]
    ds_read_b64_tr_b16 v[160:161], v233 offset:0
    v_mfma_f32_16x16x32_bf16 v[108:111], v[204:207], v[192:195], v[108:111]
    ds_read_b64_tr_b16 v[162:163], v233 offset:4096
    v_mfma_f32_16x16x32_bf16 v[112:115], v[208:211], v[192:195], v[112:115]
    ds_read_b64_tr_b16 v[164:165], v234 offset:0
    v_mfma_f32_16x16x32_bf16 v[80:83], v[208:211], v[188:191], v[80:83]
    ds_read_b64_tr_b16 v[166:167], v234 offset:4096
    v_mfma_f32_16x16x32_bf16 v[48:51], v[208:211], v[184:187], v[48:51]
    ds_read_b64_tr_b16 v[168:169], v235 offset:0
    v_mfma_f32_16x16x32_bf16 v[16:19], v[208:211], v[180:183], v[16:19]
    ds_read_b64_tr_b16 v[170:171], v235 offset:4096
    v_mfma_f32_16x16x32_bf16 v[20:23], v[212:215], v[180:183], v[20:23]
    ds_read_b64_tr_b16 v[172:173], v236 offset:0
    v_mfma_f32_16x16x32_bf16 v[52:55], v[212:215], v[184:187], v[52:55]
    ds_read_b64_tr_b16 v[174:175], v236 offset:4096
    v_mfma_f32_16x16x32_bf16 v[84:87], v[212:215], v[188:191], v[84:87]
    ds_read_b64_tr_b16 v[176:177], v237 offset:0
    v_mfma_f32_16x16x32_bf16 v[116:119], v[212:215], v[192:195], v[116:119]
    ds_read_b64_tr_b16 v[178:179], v237 offset:4096
    v_mfma_f32_16x16x32_bf16 v[120:123], v[216:219], v[192:195], v[120:123]
    v_mfma_f32_16x16x32_bf16 v[88:91], v[216:219], v[188:191], v[88:91]
    v_mfma_f32_16x16x32_bf16 v[56:59], v[216:219], v[184:187], v[56:59]
    v_mfma_f32_16x16x32_bf16 v[24:27], v[216:219], v[180:183], v[24:27]
    v_mfma_f32_16x16x32_bf16 v[28:31], v[220:223], v[180:183], v[28:31]
    v_mfma_f32_16x16x32_bf16 v[60:63], v[220:223], v[184:187], v[60:63]
    v_mfma_f32_16x16x32_bf16 v[92:95], v[220:223], v[188:191], v[92:95]
    v_mfma_f32_16x16x32_bf16 v[124:127], v[220:223], v[192:195], v[124:127]
    v_mfma_f32_16x16x32_bf16 v[128:131], v[224:227], v[192:195], v[128:131]
    v_mfma_f32_16x16x32_bf16 v[96:99], v[224:227], v[188:191], v[96:99]
    v_mfma_f32_16x16x32_bf16 v[64:67], v[224:227], v[184:187], v[64:67]
    v_mfma_f32_16x16x32_bf16 v[32:35], v[224:227], v[180:183], v[32:35]
    s_mov_b32 s59, 8
K1_loop_4:
    s_waitcnt lgkmcnt(0)
    v_mfma_f32_16x16x32_bf16 v[4:7], v[148:151], v[132:135], v[4:7]
    ds_read_b128 v[180:183], v228 offset:16384
    v_mfma_f32_16x16x32_bf16 v[36:39], v[148:151], v[136:139], v[36:39]
    ds_read_b128 v[184:187], v228 offset:17408
    v_mfma_f32_16x16x32_bf16 v[68:71], v[148:151], v[140:143], v[68:71]
    ds_read_b128 v[188:191], v228 offset:18432
    v_mfma_f32_16x16x32_bf16 v[100:103], v[148:151], v[144:147], v[100:103]
    ds_read_b128 v[192:195], v228 offset:19456
    v_mfma_f32_16x16x32_bf16 v[104:107], v[152:155], v[144:147], v[104:107]
    ds_read_b64_tr_b16 v[196:197], v230 offset:8192
    v_mfma_f32_16x16x32_bf16 v[72:75], v[152:155], v[140:143], v[72:75]
    ds_read_b64_tr_b16 v[198:199], v230 offset:12288
    v_mfma_f32_16x16x32_bf16 v[40:43], v[152:155], v[136:139], v[40:43]
    ds_read_b64_tr_b16 v[200:201], v231 offset:8192
    v_mfma_f32_16x16x32_bf16 v[8:11], v[152:155], v[132:135], v[8:11]
    ds_read_b64_tr_b16 v[202:203], v231 offset:12288
    v_mfma_f32_16x16x32_bf16 v[12:15], v[156:159], v[132:135], v[12:15]
    ds_read_b64_tr_b16 v[204:205], v232 offset:8192
    v_mfma_f32_16x16x32_bf16 v[44:47], v[156:159], v[136:139], v[44:47]
    ds_read_b64_tr_b16 v[206:207], v232 offset:12288
    v_mfma_f32_16x16x32_bf16 v[76:79], v[156:159], v[140:143], v[76:79]
    ds_read_b64_tr_b16 v[208:209], v233 offset:8192
    v_mfma_f32_16x16x32_bf16 v[108:111], v[156:159], v[144:147], v[108:111]
    ds_read_b64_tr_b16 v[210:211], v233 offset:12288
    v_mfma_f32_16x16x32_bf16 v[112:115], v[160:163], v[144:147], v[112:115]
    ds_read_b64_tr_b16 v[212:213], v234 offset:8192
    v_mfma_f32_16x16x32_bf16 v[80:83], v[160:163], v[140:143], v[80:83]
    ds_read_b64_tr_b16 v[214:215], v234 offset:12288
    v_mfma_f32_16x16x32_bf16 v[48:51], v[160:163], v[136:139], v[48:51]
    ds_read_b64_tr_b16 v[216:217], v235 offset:8192
    v_mfma_f32_16x16x32_bf16 v[16:19], v[160:163], v[132:135], v[16:19]
    ds_read_b64_tr_b16 v[218:219], v235 offset:12288
    v_mfma_f32_16x16x32_bf16 v[20:23], v[164:167], v[132:135], v[20:23]
    ds_read_b64_tr_b16 v[220:221], v236 offset:8192
    v_mfma_f32_16x16x32_bf16 v[52:55], v[164:167], v[136:139], v[52:55]
    ds_read_b64_tr_b16 v[222:223], v236 offset:12288
    v_mfma_f32_16x16x32_bf16 v[84:87], v[164:167], v[140:143], v[84:87]
    ds_read_b64_tr_b16 v[224:225], v237 offset:8192
    v_mfma_f32_16x16x32_bf16 v[116:119], v[164:167], v[144:147], v[116:119]
    ds_read_b64_tr_b16 v[226:227], v237 offset:12288
    v_mfma_f32_16x16x32_bf16 v[120:123], v[168:171], v[144:147], v[120:123]
    s_add_u32 s54, s54, 32768
    s_cmp_eq_u32 s54, 98304
    s_cselect_b32 s56, 4294901760, s57
    s_cselect_b32 s54, 0, s54
    s_ashr_i32 s73, s56, 1
    v_mfma_f32_16x16x32_bf16 v[88:91], v[168:171], v[140:143], v[88:91]
    v_add_u32 v228, s56, v228
    v_mfma_f32_16x16x32_bf16 v[56:59], v[168:171], v[136:139], v[56:59]
    v_add_u32 v230, s73, v230
    v_mfma_f32_16x16x32_bf16 v[24:27], v[168:171], v[132:135], v[24:27]
    v_add_u32 v231, s73, v231
    v_mfma_f32_16x16x32_bf16 v[28:31], v[172:175], v[132:135], v[28:31]
    v_add_u32 v232, s73, v232
    v_mfma_f32_16x16x32_bf16 v[60:63], v[172:175], v[136:139], v[60:63]
    v_add_u32 v233, s73, v233
    v_mfma_f32_16x16x32_bf16 v[92:95], v[172:175], v[140:143], v[92:95]
    v_add_u32 v234, s73, v234
    v_mfma_f32_16x16x32_bf16 v[124:127], v[172:175], v[144:147], v[124:127]
    v_add_u32 v235, s73, v235
    v_mfma_f32_16x16x32_bf16 v[128:131], v[176:179], v[144:147], v[128:131]
    v_add_u32 v236, s73, v236
    v_mfma_f32_16x16x32_bf16 v[96:99], v[176:179], v[140:143], v[96:99]
    v_add_u32 v237, s73, v237
    v_mfma_f32_16x16x32_bf16 v[64:67], v[176:179], v[136:139], v[64:67]
    v_mfma_f32_16x16x32_bf16 v[32:35], v[176:179], v[132:135], v[32:35]
    s_waitcnt lgkmcnt(0)
    s_barrier
    v_mfma_f32_16x16x32_bf16 v[4:7], v[196:199], v[180:183], v[4:7]
    ds_read_b128 v[132:135], v228 offset:0
    v_mfma_f32_16x16x32_bf16 v[36:39], v[196:199], v[184:187], v[36:39]
    ds_read_b128 v[136:139], v228 offset:1024
    v_mfma_f32_16x16x32_bf16 v[68:71], v[196:199], v[188:191], v[68:71]
    ds_read_b128 v[140:143], v228 offset:2048
    v_mfma_f32_16x16x32_bf16 v[100:103], v[196:199], v[192:195], v[100:103]
    ds_read_b128 v[144:147], v228 offset:3072
    v_mfma_f32_16x16x32_bf16 v[104:107], v[200:203], v[192:195], v[104:107]
    ds_read_b64_tr_b16 v[148:149], v230 offset:0
    v_mfma_f32_16x16x32_bf16 v[72:75], v[200:203], v[188:191], v[72:75]
    ds_read_b64_tr_b16 v[150:151], v230 offset:4096
    v_mfma_f32_16x16x32_bf16 v[40:43], v[200:203], v[184:187], v[40:43]
    ds_read_b64_tr_b16 v[152:153], v231 offset:0
    v_mfma_f32_16x16x32_bf16 v[8:11], v[200:203], v[180:183], v[8:11]
    ds_read_b64_tr_b16 v[154:155], v231 offset:4096
    v_mfma_f32_16x16x32_bf16 v[12:15], v[204:207], v[180:183], v[12:15]
    ds_read_b64_tr_b16 v[156:157], v232 offset:0
    v_mfma_f32_16x16x32_bf16 v[44:47], v[204:207], v[184:187], v[44:47]
    ds_read_b64_tr_b16 v[158:159], v232 offset:4096
    v_mfma_f32_16x16x32_bf16 v[76:79], v[204:207], v[188:191], v[76:79]
    ds_read_b64_tr_b16 v[160:161], v233 offset:0
    v_mfma_f32_16x16x32_bf16 v[108:111], v[204:207], v[192:195], v[108:111]
    ds_read_b64_tr_b16 v[162:163], v233 offset:4096
    v_mfma_f32_16x16x32_bf16 v[112:115], v[208:211], v[192:195], v[112:115]
    ds_read_b64_tr_b16 v[164:165], v234 offset:0
    v_mfma_f32_16x16x32_bf16 v[80:83], v[208:211], v[188:191], v[80:83]
    ds_read_b64_tr_b16 v[166:167], v234 offset:4096
    v_mfma_f32_16x16x32_bf16 v[48:51], v[208:211], v[184:187], v[48:51]
    ds_read_b64_tr_b16 v[168:169], v235 offset:0
    v_mfma_f32_16x16x32_bf16 v[16:19], v[208:211], v[180:183], v[16:19]
    ds_read_b64_tr_b16 v[170:171], v235 offset:4096
    v_mfma_f32_16x16x32_bf16 v[20:23], v[212:215], v[180:183], v[20:23]
    ds_read_b64_tr_b16 v[172:173], v236 offset:0
    v_mfma_f32_16x16x32_bf16 v[52:55], v[212:215], v[184:187], v[52:55]
    ds_read_b64_tr_b16 v[174:175], v236 offset:4096
    v_mfma_f32_16x16x32_bf16 v[84:87], v[212:215], v[188:191], v[84:87]
    ds_read_b64_tr_b16 v[176:177], v237 offset:0
    v_mfma_f32_16x16x32_bf16 v[116:119], v[212:215], v[192:195], v[116:119]
    ds_read_b64_tr_b16 v[178:179], v237 offset:4096
    v_mfma_f32_16x16x32_bf16 v[120:123], v[216:219], v[192:195], v[120:123]
    v_mfma_f32_16x16x32_bf16 v[88:91], v[216:219], v[188:191], v[88:91]
    v_mfma_f32_16x16x32_bf16 v[56:59], v[216:219], v[184:187], v[56:59]
    v_mfma_f32_16x16x32_bf16 v[24:27], v[216:219], v[180:183], v[24:27]
    v_mfma_f32_16x16x32_bf16 v[28:31], v[220:223], v[180:183], v[28:31]
    v_mfma_f32_16x16x32_bf16 v[60:63], v[220:223], v[184:187], v[60:63]
    v_mfma_f32_16x16x32_bf16 v[92:95], v[220:223], v[188:191], v[92:95]
    v_mfma_f32_16x16x32_bf16 v[124:127], v[220:223], v[192:195], v[124:127]
    v_mfma_f32_16x16x32_bf16 v[128:131], v[224:227], v[192:195], v[128:131]
    v_mfma_f32_16x16x32_bf16 v[96:99], v[224:227], v[188:191], v[96:99]
    v_mfma_f32_16x16x32_bf16 v[64:67], v[224:227], v[184:187], v[64:67]
    v_mfma_f32_16x16x32_bf16 v[32:35], v[224:227], v[180:183], v[32:35]
    s_sub_u32 s59, s59, 1
    s_cmp_lg_u32 s59, 0
    s_cbranch_scc1 K1_loop_4
    s_waitcnt lgkmcnt(0)
    v_mfma_f32_16x16x32_bf16 v[4:7], v[148:151], v[132:135], v[4:7]
    ds_read_b128 v[180:183], v228 offset:16384
    v_mfma_f32_16x16x32_bf16 v[36:39], v[148:151], v[136:139], v[36:39]
    ds_read_b128 v[184:187], v228 offset:17408
    v_mfma_f32_16x16x32_bf16 v[68:71], v[148:151], v[140:143], v[68:71]
    ds_read_b128 v[188:191], v228 offset:18432
    v_mfma_f32_16x16x32_bf16 v[100:103], v[148:151], v[144:147], v[100:103]
    ds_read_b128 v[192:195], v228 offset:19456
    v_mfma_f32_16x16x32_bf16 v[104:107], v[152:155], v[144:147], v[104:107]
    ds_read_b64_tr_b16 v[196:197], v230 offset:8192
    v_mfma_f32_16x16x32_bf16 v[72:75], v[152:155], v[140:143], v[72:75]
    ds_read_b64_tr_b16 v[198:199], v230 offset:12288
    v_mfma_f32_16x16x32_bf16 v[40:43], v[152:155], v[136:139], v[40:43]
    ds_read_b64_tr_b16 v[200:201], v231 offset:8192
    v_mfma_f32_16x16x32_bf16 v[8:11], v[152:155], v[132:135], v[8:11]
    ds_read_b64_tr_b16 v[202:203], v231 offset:12288
    v_mfma_f32_16x16x32_bf16 v[12:15], v[156:159], v[132:135], v[12:15]
    ds_read_b64_tr_b16 v[204:205], v232 offset:8192
    v_mfma_f32_16x16x32_bf16 v[44:47], v[156:159], v[136:139], v[44:47]
    ds_read_b64_tr_b16 v[206:207], v232 offset:12288
    v_mfma_f32_16x16x32_bf16 v[76:79], v[156:159], v[140:143], v[76:79]
    ds_read_b64_tr_b16 v[208:209], v233 offset:8192
    v_mfma_f32_16x16x32_bf16 v[108:111], v[156:159], v[144:147], v[108:111]
    ds_read_b64_tr_b16 v[210:211], v233 offset:12288
    v_mfma_f32_16x16x32_bf16 v[112:115], v[160:163], v[144:147], v[112:115]
    ds_read_b64_tr_b16 v[212:213], v234 offset:8192
    v_mfma_f32_16x16x32_bf16 v[80:83], v[160:163], v[140:143], v[80:83]
    ds_read_b64_tr_b16 v[214:215], v234 offset:12288
    v_mfma_f32_16x16x32_bf16 v[48:51], v[160:163], v[136:139], v[48:51]
    ds_read_b64_tr_b16 v[216:217], v235 offset:8192
    v_mfma_f32_16x16x32_bf16 v[16:19], v[160:163], v[132:135], v[16:19]
    ds_read_b64_tr_b16 v[218:219], v235 offset:12288
    v_mfma_f32_16x16x32_bf16 v[20:23], v[164:167], v[132:135], v[20:23]
    ds_read_b64_tr_b16 v[220:221], v236 offset:8192
    v_mfma_f32_16x16x32_bf16 v[52:55], v[164:167], v[136:139], v[52:55]
    ds_read_b64_tr_b16 v[222:223], v236 offset:12288
    v_mfma_f32_16x16x32_bf16 v[84:87], v[164:167], v[140:143], v[84:87]
    ds_read_b64_tr_b16 v[224:225], v237 offset:8192
    v_mfma_f32_16x16x32_bf16 v[116:119], v[164:167], v[144:147], v[116:119]
    ds_read_b64_tr_b16 v[226:227], v237 offset:12288
    v_mfma_f32_16x16x32_bf16 v[120:123], v[168:171], v[144:147], v[120:123]
    s_add_u32 s54, s54, 32768
    s_cmp_eq_u32 s54, 98304
    s_cselect_b32 s56, 4294901760, s57
    s_cselect_b32 s54, 0, s54
    s_ashr_i32 s73, s56, 1
    v_mfma_f32_16x16x32_bf16 v[88:91], v[168:171], v[140:143], v[88:91]
    v_mfma_f32_16x16x32_bf16 v[56:59], v[168:171], v[136:139], v[56:59]
    v_mfma_f32_16x16x32_bf16 v[24:27], v[168:171], v[132:135], v[24:27]
    v_mfma_f32_16x16x32_bf16 v[28:31], v[172:175], v[132:135], v[28:31]
    v_mfma_f32_16x16x32_bf16 v[60:63], v[172:175], v[136:139], v[60:63]
    v_mfma_f32_16x16x32_bf16 v[92:95], v[172:175], v[140:143], v[92:95]
    v_mfma_f32_16x16x32_bf16 v[124:127], v[172:175], v[144:147], v[124:127]
    v_mfma_f32_16x16x32_bf16 v[128:131], v[176:179], v[144:147], v[128:131]
    v_mfma_f32_16x16x32_bf16 v[96:99], v[176:179], v[140:143], v[96:99]
    v_mfma_f32_16x16x32_bf16 v[64:67], v[176:179], v[136:139], v[64:67]
    v_mfma_f32_16x16x32_bf16 v[32:35], v[176:179], v[132:135], v[32:35]
    s_lshl_b32 s55, s32, 12
    s_add_u32 s55, s55, s54
    v_lshrrev_b32 v238, 5, v1
    v_lshlrev_b32 v239, 10, v238
    v_bfe_u32 v238, v1, 4, 1
    v_lshl_add_u32 v239, v238, 9, v239
    v_lshl_add_u32 v239, v238, 3, v239
    v_bfe_u32 v238, v1, 2, 2
    v_lshl_add_u32 v239, v238, 6, v239
    v_and_b32 v238, 3, v1
    v_lshl_add_u32 v239, v238, 4, v239
    v_add_u32 v228, s55, v239
    v_xor_b32 v239, 8, v239
    v_add_u32 v229, s55, v239
    v_and_b32 v238, 15, v1
    v_lshrrev_b32 v239, 1, v238
    v_lshrrev_b32 v240, 4, v1
    v_xor_b32 v239, v239, v240
    v_lshlrev_b32 v239, 4, v239
    v_lshl_add_u32 v239, v238, 7, v239
    s_lshr_b32 s55, s54, 1
    s_add_u32 s55, s55, 98304
    v_add_u32 v230, s55, v239
    v_xor_b32 v239, 64, v239
    v_add_u32 v231, s55, v239
    s_waitcnt lgkmcnt(0)
    s_barrier
    v_mfma_f32_16x16x32_bf16 v[4:7], v[196:199], v[180:183], v[4:7]
    ds_read_b64_tr_b16 v[132:133], v228 offset:0
    v_mfma_f32_16x16x32_bf16 v[36:39], v[196:199], v[184:187], v[36:39]
    ds_read_b64_tr_b16 v[134:135], v228 offset:256
    v_mfma_f32_16x16x32_bf16 v[68:71], v[196:199], v[188:191], v[68:71]
    ds_read_b64_tr_b16 v[136:137], v229 offset:0
    v_mfma_f32_16x16x32_bf16 v[100:103], v[196:199], v[192:195], v[100:103]
    ds_read_b64_tr_b16 v[138:139], v229 offset:256
    v_mfma_f32_16x16x32_bf16 v[104:107], v[200:203], v[192:195], v[104:107]
    ds_read_b64_tr_b16 v[140:141], v228 offset:2048
    v_mfma_f32_16x16x32_bf16 v[72:75], v[200:203], v[188:191], v[72:75]
    ds_read_b64_tr_b16 v[142:143], v228 offset:2304
    v_mfma_f32_16x16x32_bf16 v[40:43], v[200:203], v[184:187], v[40:43]
    ds_read_b64_tr_b16 v[144:145], v229 offset:2048
    v_mfma_f32_16x16x32_bf16 v[8:11], v[200:203], v[180:183], v[8:11]
    ds_read_b64_tr_b16 v[146:147], v229 offset:2304
    v_mfma_f32_16x16x32_bf16 v[12:15], v[204:207], v[180:183], v[12:15]
    ds_read_b128 v[148:151], v230 offset:0
    v_mfma_f32_16x16x32_bf16 v[44:47], v[204:207], v[184:187], v[44:47]
    ds_read_b128 v[152:155], v230 offset:2048
    v_mfma_f32_16x16x32_bf16 v[76:79], v[204:207], v[188:191], v[76:79]
    ds_read_b128 v[156:159], v230 offset:4096
    v_mfma_f32_16x16x32_bf16 v[108:111], v[204:207], v[192:195], v[108:111]
    ds_read_b128 v[160:163], v230 offset:6144
    v_mfma_f32_16x16x32_bf16 v[112:115], v[208:211], v[192:195], v[112:115]
    ds_read_b128 v[164:167], v230 offset:8192
    v_mfma_f32_16x16x32_bf16 v[80:83], v[208:211], v[188:191], v[80:83]
    ds_read_b128 v[168:171], v230 offset:10240
    v_mfma_f32_16x16x32_bf16 v[48:51], v[208:211], v[184:187], v[48:51]
    ds_read_b128 v[172:175], v230 offset:12288
    v_mfma_f32_16x16x32_bf16 v[16:19], v[208:211], v[180:183], v[16:19]
    ds_read_b128 v[176:179], v230 offset:14336
    v_mfma_f32_16x16x32_bf16 v[20:23], v[212:215], v[180:183], v[20:23]
    v_mfma_f32_16x16x32_bf16 v[52:55], v[212:215], v[184:187], v[52:55]
    v_mfma_f32_16x16x32_bf16 v[84:87], v[212:215], v[188:191], v[84:87]
    v_mfma_f32_16x16x32_bf16 v[116:119], v[212:215], v[192:195], v[116:119]
    v_mfma_f32_16x16x32_bf16 v[120:123], v[216:219], v[192:195], v[120:123]
    v_mfma_f32_16x16x32_bf16 v[88:91], v[216:219], v[188:191], v[88:91]
    v_mfma_f32_16x16x32_bf16 v[56:59], v[216:219], v[184:187], v[56:59]
    v_mfma_f32_16x16x32_bf16 v[24:27], v[216:219], v[180:183], v[24:27]
    v_mfma_f32_16x16x32_bf16 v[28:31], v[220:223], v[180:183], v[28:31]
    v_mfma_f32_16x16x32_bf16 v[60:63], v[220:223], v[184:187], v[60:63]
    v_mfma_f32_16x16x32_bf16 v[92:95], v[220:223], v[188:191], v[92:95]
    v_mfma_f32_16x16x32_bf16 v[124:127], v[220:223], v[192:195], v[124:127]
    v_mfma_f32_16x16x32_bf16 v[128:131], v[224:227], v[192:195], v[128:131]
    v_mfma_f32_16x16x32_bf16 v[96:99], v[224:227], v[188:191], v[96:99]
    v_mfma_f32_16x16x32_bf16 v[64:67], v[224:227], v[184:187], v[64:67]
    v_mfma_f32_16x16x32_bf16 v[32:35], v[224:227], v[180:183], v[32:35]
    s_lshl_b32 s58, s36, 2
    s_add_u32 s58, s58, s32
    s_lshl_b32 s58, s58, 2
    s_add_u32 s58, s58, 3
    s_lshl_b32 s58, s58, 14
    s_add_u32 s58, s58, 27262976
    s_waitcnt lgkmcnt(0)
    v_cvt_pk_bf16_f32 v244, v4, v5
    v_cvt_pk_bf16_f32 v245, v6, v7
    v_mfma_f32_16x16x32_bf16 v[4:7], v[148:151], v[132:135], 0
    ds_read_b64_tr_b16 v[180:181], v228 offset:16384
    v_cvt_pk_bf16_f32 v246, v36, v37
    v_cvt_pk_bf16_f32 v247, v38, v39
    v_mfma_f32_16x16x32_bf16 v[36:39], v[148:151], v[136:139], 0
    ds_read_b64_tr_b16 v[182:183], v228 offset:16640
    buffer_store_dwordx4 v[244:247], v241, s[8:11], s58 offen offset:0 sc1
    v_cvt_pk_bf16_f32 v248, v68, v69
    v_cvt_pk_bf16_f32 v249, v70, v71
    v_mfma_f32_16x16x32_bf16 v[68:71], v[148:151], v[140:143], 0
    ds_read_b64_tr_b16 v[184:185], v229 offset:16384
    v_cvt_pk_bf16_f32 v250, v100, v101
    v_cvt_pk_bf16_f32 v251, v102, v103
    v_mfma_f32_16x16x32_bf16 v[100:103], v[148:151], v[144:147], 0
    ds_read_b64_tr_b16 v[186:187], v229 offset:16640
    buffer_store_dwordx4 v[248:251], v241, s[8:11], s58 offen offset:1024 sc1
    v_cvt_pk_bf16_f32 v252, v8, v9
    v_cvt_pk_bf16_f32 v253, v10, v11
    v_mfma_f32_16x16x32_bf16 v[8:11], v[152:155], v[132:135], 0
    ds_read_b64_tr_b16 v[188:189], v228 offset:18432
    v_cvt_pk_bf16_f32 v254, v40, v41
    v_cvt_pk_bf16_f32 v255, v42, v43
    v_mfma_f32_16x16x32_bf16 v[40:43], v[152:155], v[136:139], 0
    ds_read_b64_tr_b16 v[190:191], v228 offset:18688
    buffer_store_dwordx4 v[252:255], v241, s[8:11], s58 offen offset:2048 sc1
    v_cvt_pk_bf16_f32 v244, v72, v73
    v_cvt_pk_bf16_f32 v245, v74, v75
    v_mfma_f32_16x16x32_bf16 v[72:75], v[152:155], v[140:143], 0
    ds_read_b64_tr_b16 v[192:193], v229 offset:18432
    v_cvt_pk_bf16_f32 v246, v104, v105
    v_cvt_pk_bf16_f32 v247, v106, v107
    v_mfma_f32_16x16x32_bf16 v[104:107], v[152:155], v[144:147], 0
    ds_read_b64_tr_b16 v[194:195], v229 offset:18688
    buffer_store_dwordx4 v[244:247], v241, s[8:11], s58 offen offset:3072 sc1
    s_add_u32 s58, s58, 4096
    v_cvt_pk_bf16_f32 v248, v12, v13
    v_cvt_pk_bf16_f32 v249, v14, v15
    v_mfma_f32_16x16x32_bf16 v[12:15], v[156:159], v[132:135], 0
    ds_read_b128 v[196:199], v231 offset:0
    v_cvt_pk_bf16_f32 v250, v44, v45
    v_cvt_pk_bf16_f32 v251, v46, v47
    v_mfma_f32_16x16x32_bf16 v[44:47], v[156:159], v[136:139], 0
    ds_read_b128 v[200:203], v231 offset:2048
    buffer_store_dwordx4 v[248:251], v241, s[8:11], s58 offen offset:0 sc1
    v_cvt_pk_bf16_f32 v252, v76, v77
    v_cvt_pk_bf16_f32 v253, v78, v79
    v_mfma_f32_16x16x32_bf16 v[76:79], v[156:159], v[140:143], 0
    ds_read_b128 v[204:207], v231 offset:4096
    v_cvt_pk_bf16_f32 v254, v108, v109
    v_cvt_pk_bf16_f32 v255, v110, v111
    v_mfma_f32_16x16x32_bf16 v[108:111], v[156:159], v[144:147], 0
    ds_read_b128 v[208:211], v231 offset:6144
    buffer_store_dwordx4 v[252:255], v241, s[8:11], s58 offen offset:1024 sc1
    v_cvt_pk_bf16_f32 v244, v16, v17
    v_cvt_pk_bf16_f32 v245, v18, v19
    v_mfma_f32_16x16x32_bf16 v[16:19], v[160:163], v[132:135], 0
    ds_read_b128 v[212:215], v231 offset:8192
    v_cvt_pk_bf16_f32 v246, v48, v49
    v_cvt_pk_bf16_f32 v247, v50, v51
    v_mfma_f32_16x16x32_bf16 v[48:51], v[160:163], v[136:139], 0
    ds_read_b128 v[216:219], v231 offset:10240
    buffer_store_dwordx4 v[244:247], v241, s[8:11], s58 offen offset:2048 sc1
    v_cvt_pk_bf16_f32 v248, v80, v81
    v_cvt_pk_bf16_f32 v249, v82, v83
    v_mfma_f32_16x16x32_bf16 v[80:83], v[160:163], v[140:143], 0
    ds_read_b128 v[220:223], v231 offset:12288
    v_cvt_pk_bf16_f32 v250, v112, v113
    v_cvt_pk_bf16_f32 v251, v114, v115
    v_mfma_f32_16x16x32_bf16 v[112:115], v[160:163], v[144:147], 0
    ds_read_b128 v[224:227], v231 offset:14336
    buffer_store_dwordx4 v[248:251], v241, s[8:11], s58 offen offset:3072 sc1
    s_add_u32 s58, s58, 4096
    v_cvt_pk_bf16_f32 v252, v20, v21
    v_cvt_pk_bf16_f32 v253, v22, v23
    v_mfma_f32_16x16x32_bf16 v[20:23], v[164:167], v[132:135], 0
    s_add_u32 s54, s54, 32768
    s_cmp_eq_u32 s54, 98304
    s_cselect_b32 s56, 4294901760, s57
    s_cselect_b32 s54, 0, s54
    s_ashr_i32 s73, s56, 1
    v_cvt_pk_bf16_f32 v254, v52, v53
    v_cvt_pk_bf16_f32 v255, v54, v55
    v_mfma_f32_16x16x32_bf16 v[52:55], v[164:167], v[136:139], 0
    v_add_u32 v228, s56, v228
    buffer_store_dwordx4 v[252:255], v241, s[8:11], s58 offen offset:0 sc1
    v_cvt_pk_bf16_f32 v244, v84, v85
    v_cvt_pk_bf16_f32 v245, v86, v87
    v_mfma_f32_16x16x32_bf16 v[84:87], v[164:167], v[140:143], 0
    v_add_u32 v229, s56, v229
    v_cvt_pk_bf16_f32 v246, v116, v117
    v_cvt_pk_bf16_f32 v247, v118, v119
    v_mfma_f32_16x16x32_bf16 v[116:119], v[164:167], v[144:147], 0
    v_add_u32 v230, s73, v230
    buffer_store_dwordx4 v[244:247], v241, s[8:11], s58 offen offset:1024 sc1
    v_cvt_pk_bf16_f32 v248, v24, v25
    v_cvt_pk_bf16_f32 v249, v26, v27
    v_mfma_f32_16x16x32_bf16 v[24:27], v[168:171], v[132:135], 0
    v_add_u32 v231, s73, v231
    v_cvt_pk_bf16_f32 v250, v56, v57
    v_cvt_pk_bf16_f32 v251, v58, v59
    v_mfma_f32_16x16x32_bf16 v[56:59], v[168:171], v[136:139], 0
    buffer_store_dwordx4 v[248:251], v241, s[8:11], s58 offen offset:2048 sc1
    v_cvt_pk_bf16_f32 v252, v88, v89
    v_cvt_pk_bf16_f32 v253, v90, v91
    v_mfma_f32_16x16x32_bf16 v[88:91], v[168:171], v[140:143], 0
    v_cvt_pk_bf16_f32 v254, v120, v121
    v_cvt_pk_bf16_f32 v255, v122, v123
    v_mfma_f32_16x16x32_bf16 v[120:123], v[168:171], v[144:147], 0
    buffer_store_dwordx4 v[252:255], v241, s[8:11], s58 offen offset:3072 sc1
    s_add_u32 s58, s58, 4096
    v_cvt_pk_bf16_f32 v244, v28, v29
    v_cvt_pk_bf16_f32 v245, v30, v31
    v_mfma_f32_16x16x32_bf16 v[28:31], v[172:175], v[132:135], 0
    v_cvt_pk_bf16_f32 v246, v60, v61
    v_cvt_pk_bf16_f32 v247, v62, v63
    v_mfma_f32_16x16x32_bf16 v[60:63], v[172:175], v[136:139], 0
    buffer_store_dwordx4 v[244:247], v241, s[8:11], s58 offen offset:0 sc1
    v_cvt_pk_bf16_f32 v248, v92, v93
    v_cvt_pk_bf16_f32 v249, v94, v95
    v_mfma_f32_16x16x32_bf16 v[92:95], v[172:175], v[140:143], 0
    v_cvt_pk_bf16_f32 v250, v124, v125
    v_cvt_pk_bf16_f32 v251, v126, v127
    v_mfma_f32_16x16x32_bf16 v[124:127], v[172:175], v[144:147], 0
    buffer_store_dwordx4 v[248:251], v241, s[8:11], s58 offen offset:1024 sc1
    v_cvt_pk_bf16_f32 v252, v32, v33
    v_cvt_pk_bf16_f32 v253, v34, v35
    v_mfma_f32_16x16x32_bf16 v[32:35], v[176:179], v[132:135], 0
    v_cvt_pk_bf16_f32 v254, v64, v65
    v_cvt_pk_bf16_f32 v255, v66, v67
    v_mfma_f32_16x16x32_bf16 v[64:67], v[176:179], v[136:139], 0
    buffer_store_dwordx4 v[252:255], v241, s[8:11], s58 offen offset:2048 sc1
    v_cvt_pk_bf16_f32 v244, v96, v97
    v_cvt_pk_bf16_f32 v245, v98, v99
    v_mfma_f32_16x16x32_bf16 v[96:99], v[176:179], v[140:143], 0
    v_cvt_pk_bf16_f32 v246, v128, v129
    v_cvt_pk_bf16_f32 v247, v130, v131
    v_mfma_f32_16x16x32_bf16 v[128:131], v[176:179], v[144:147], 0
    buffer_store_dwordx4 v[244:247], v241, s[8:11], s58 offen offset:3072 sc1
    s_waitcnt lgkmcnt(0)
    s_barrier
    v_mfma_f32_16x16x32_bf16 v[4:7], v[196:199], v[180:183], v[4:7]
    ds_read_b64_tr_b16 v[132:133], v228 offset:0
    v_mfma_f32_16x16x32_bf16 v[36:39], v[196:199], v[184:187], v[36:39]
    ds_read_b64_tr_b16 v[134:135], v228 offset:256
    v_mfma_f32_16x16x32_bf16 v[68:71], v[196:199], v[188:191], v[68:71]
    ds_read_b64_tr_b16 v[136:137], v229 offset:0
    v_mfma_f32_16x16x32_bf16 v[100:103], v[196:199], v[192:195], v[100:103]
    ds_read_b64_tr_b16 v[138:139], v229 offset:256
    v_mfma_f32_16x16x32_bf16 v[104:107], v[200:203], v[192:195], v[104:107]
    ds_read_b64_tr_b16 v[140:141], v228 offset:2048
    v_mfma_f32_16x16x32_bf16 v[72:75], v[200:203], v[188:191], v[72:75]
    ds_read_b64_tr_b16 v[142:143], v228 offset:2304
    v_mfma_f32_16x16x32_bf16 v[40:43], v[200:203], v[184:187], v[40:43]
    ds_read_b64_tr_b16 v[144:145], v229 offset:2048
    v_mfma_f32_16x16x32_bf16 v[8:11], v[200:203], v[180:183], v[8:11]
    ds_read_b64_tr_b16 v[146:147], v229 offset:2304
    v_mfma_f32_16x16x32_bf16 v[12:15], v[204:207], v[180:183], v[12:15]
    ds_read_b128 v[148:151], v230 offset:0
    v_mfma_f32_16x16x32_bf16 v[44:47], v[204:207], v[184:187], v[44:47]
    ds_read_b128 v[152:155], v230 offset:2048
    v_mfma_f32_16x16x32_bf16 v[76:79], v[204:207], v[188:191], v[76:79]
    ds_read_b128 v[156:159], v230 offset:4096
    v_mfma_f32_16x16x32_bf16 v[108:111], v[204:207], v[192:195], v[108:111]
    ds_read_b128 v[160:163], v230 offset:6144
    v_mfma_f32_16x16x32_bf16 v[112:115], v[208:211], v[192:195], v[112:115]
    ds_read_b128 v[164:167], v230 offset:8192
    v_mfma_f32_16x16x32_bf16 v[80:83], v[208:211], v[188:191], v[80:83]
    ds_read_b128 v[168:171], v230 offset:10240
    v_mfma_f32_16x16x32_bf16 v[48:51], v[208:211], v[184:187], v[48:51]
    ds_read_b128 v[172:175], v230 offset:12288
    v_mfma_f32_16x16x32_bf16 v[16:19], v[208:211], v[180:183], v[16:19]
    ds_read_b128 v[176:179], v230 offset:14336
    v_mfma_f32_16x16x32_bf16 v[20:23], v[212:215], v[180:183], v[20:23]
    v_mfma_f32_16x16x32_bf16 v[52:55], v[212:215], v[184:187], v[52:55]
    v_mfma_f32_16x16x32_bf16 v[84:87], v[212:215], v[188:191], v[84:87]
    v_mfma_f32_16x16x32_bf16 v[116:119], v[212:215], v[192:195], v[116:119]
    v_mfma_f32_16x16x32_bf16 v[120:123], v[216:219], v[192:195], v[120:123]
    v_mfma_f32_16x16x32_bf16 v[88:91], v[216:219], v[188:191], v[88:91]
    v_mfma_f32_16x16x32_bf16 v[56:59], v[216:219], v[184:187], v[56:59]
    v_mfma_f32_16x16x32_bf16 v[24:27], v[216:219], v[180:183], v[24:27]
    v_mfma_f32_16x16x32_bf16 v[28:31], v[220:223], v[180:183], v[28:31]
    v_mfma_f32_16x16x32_bf16 v[60:63], v[220:223], v[184:187], v[60:63]
    v_mfma_f32_16x16x32_bf16 v[92:95], v[220:223], v[188:191], v[92:95]
    v_mfma_f32_16x16x32_bf16 v[124:127], v[220:223], v[192:195], v[124:127]
    v_mfma_f32_16x16x32_bf16 v[128:131], v[224:227], v[192:195], v[128:131]
    v_mfma_f32_16x16x32_bf16 v[96:99], v[224:227], v[188:191], v[96:99]
    v_mfma_f32_16x16x32_bf16 v[64:67], v[224:227], v[184:187], v[64:67]
    v_mfma_f32_16x16x32_bf16 v[32:35], v[224:227], v[180:183], v[32:35]
    s_waitcnt lgkmcnt(0)
    v_mfma_f32_16x16x32_bf16 v[4:7], v[148:151], v[132:135], v[4:7]
    ds_read_b64_tr_b16 v[180:181], v228 offset:16384
    v_mfma_f32_16x16x32_bf16 v[36:39], v[148:151], v[136:139], v[36:39]
    ds_read_b64_tr_b16 v[182:183], v228 offset:16640
    v_mfma_f32_16x16x32_bf16 v[68:71], v[148:151], v[140:143], v[68:71]
    ds_read_b64_tr_b16 v[184:185], v229 offset:16384
    v_mfma_f32_16x16x32_bf16 v[100:103], v[148:151], v[144:147], v[100:103]
    ds_read_b64_tr_b16 v[186:187], v229 offset:16640
    v_mfma_f32_16x16x32_bf16 v[104:107], v[152:155], v[144:147], v[104:107]
    ds_read_b64_tr_b16 v[188:189], v228 offset:18432
    v_mfma_f32_16x16x32_bf16 v[72:75], v[152:155], v[140:143], v[72:75]
    ds_read_b64_tr_b16 v[190:191], v228 offset:18688
    v_mfma_f32_16x16x32_bf16 v[40:43], v[152:155], v[136:139], v[40:43]
    ds_read_b64_tr_b16 v[192:193], v229 offset:18432
    v_mfma_f32_16x16x32_bf16 v[8:11], v[152:155], v[132:135], v[8:11]
    ds_read_b64_tr_b16 v[194:195], v229 offset:18688
    v_mfma_f32_16x16x32_bf16 v[12:15], v[156:159], v[132:135], v[12:15]
    ds_read_b128 v[196:199], v231 offset:0
    v_mfma_f32_16x16x32_bf16 v[44:47], v[156:159], v[136:139], v[44:47]
    ds_read_b128 v[200:203], v231 offset:2048
    v_mfma_f32_16x16x32_bf16 v[76:79], v[156:159], v[140:143], v[76:79]
    ds_read_b128 v[204:207], v231 offset:4096
    v_mfma_f32_16x16x32_bf16 v[108:111], v[156:159], v[144:147], v[108:111]
    ds_read_b128 v[208:211], v231 offset:6144
    v_mfma_f32_16x16x32_bf16 v[112:115], v[160:163], v[144:147], v[112:115]
    ds_read_b128 v[212:215], v231 offset:8192
    v_mfma_f32_16x16x32_bf16 v[80:83], v[160:163], v[140:143], v[80:83]
    ds_read_b128 v[216:219], v231 offset:10240
    v_mfma_f32_16x16x32_bf16 v[48:51], v[160:163], v[136:139], v[48:51]
    ds_read_b128 v[220:223], v231 offset:12288
    v_mfma_f32_16x16x32_bf16 v[16:19], v[160:163], v[132:135], v[16:19]
    ds_read_b128 v[224:227], v231 offset:14336
    v_mfma_f32_16x16x32_bf16 v[20:23], v[164:167], v[132:135], v[20:23]
    s_add_u32 s54, s54, 32768
    s_cmp_eq_u32 s54, 98304
    s_cselect_b32 s56, 4294901760, s57
    s_cselect_b32 s54, 0, s54
    s_ashr_i32 s73, s56, 1
    v_mfma_f32_16x16x32_bf16 v[52:55], v[164:167], v[136:139], v[52:55]
    v_add_u32 v228, s56, v228
    v_mfma_f32_16x16x32_bf16 v[84:87], v[164:167], v[140:143], v[84:87]
    v_add_u32 v229, s56, v229
    v_mfma_f32_16x16x32_bf16 v[116:119], v[164:167], v[144:147], v[116:119]
    v_add_u32 v230, s73, v230
    v_mfma_f32_16x16x32_bf16 v[120:123], v[168:171], v[144:147], v[120:123]
    v_add_u32 v231, s73, v231
    v_mfma_f32_16x16x32_bf16 v[88:91], v[168:171], v[140:143], v[88:91]
    v_mfma_f32_16x16x32_bf16 v[56:59], v[168:171], v[136:139], v[56:59]
    v_mfma_f32_16x16x32_bf16 v[24:27], v[168:171], v[132:135], v[24:27]
    v_mfma_f32_16x16x32_bf16 v[28:31], v[172:175], v[132:135], v[28:31]
    v_mfma_f32_16x16x32_bf16 v[60:63], v[172:175], v[136:139], v[60:63]
    v_mfma_f32_16x16x32_bf16 v[92:95], v[172:175], v[140:143], v[92:95]
    v_mfma_f32_16x16x32_bf16 v[124:127], v[172:175], v[144:147], v[124:127]
    v_mfma_f32_16x16x32_bf16 v[128:131], v[176:179], v[144:147], v[128:131]
    v_mfma_f32_16x16x32_bf16 v[96:99], v[176:179], v[140:143], v[96:99]
    v_mfma_f32_16x16x32_bf16 v[64:67], v[176:179], v[136:139], v[64:67]
    v_mfma_f32_16x16x32_bf16 v[32:35], v[176:179], v[132:135], v[32:35]
    s_waitcnt lgkmcnt(0)
    s_barrier
    v_mfma_f32_16x16x32_bf16 v[4:7], v[196:199], v[180:183], v[4:7]
    ds_read_b64_tr_b16 v[132:133], v228 offset:0
    v_mfma_f32_16x16x32_bf16 v[36:39], v[196:199], v[184:187], v[36:39]
    ds_read_b64_tr_b16 v[134:135], v228 offset:256
    v_mfma_f32_16x16x32_bf16 v[68:71], v[196:199], v[188:191], v[68:71]
    ds_read_b64_tr_b16 v[136:137], v229 offset:0
    v_mfma_f32_16x16x32_bf16 v[100:103], v[196:199], v[192:195], v[100:103]
    ds_read_b64_tr_b16 v[138:139], v229 offset:256
    v_mfma_f32_16x16x32_bf16 v[104:107], v[200:203], v[192:195], v[104:107]
    ds_read_b64_tr_b16 v[140:141], v228 offset:2048
    v_mfma_f32_16x16x32_bf16 v[72:75], v[200:203], v[188:191], v[72:75]
    ds_read_b64_tr_b16 v[142:143], v228 offset:2304
    v_mfma_f32_16x16x32_bf16 v[40:43], v[200:203], v[184:187], v[40:43]
    ds_read_b64_tr_b16 v[144:145], v229 offset:2048
    v_mfma_f32_16x16x32_bf16 v[8:11], v[200:203], v[180:183], v[8:11]
    ds_read_b64_tr_b16 v[146:147], v229 offset:2304
    v_mfma_f32_16x16x32_bf16 v[12:15], v[204:207], v[180:183], v[12:15]
    ds_read_b128 v[148:151], v230 offset:0
    v_mfma_f32_16x16x32_bf16 v[44:47], v[204:207], v[184:187], v[44:47]
    ds_read_b128 v[152:155], v230 offset:2048
    v_mfma_f32_16x16x32_bf16 v[76:79], v[204:207], v[188:191], v[76:79]
    ds_read_b128 v[156:159], v230 offset:4096
    v_mfma_f32_16x16x32_bf16 v[108:111], v[204:207], v[192:195], v[108:111]
    ds_read_b128 v[160:163], v230 offset:6144
    v_mfma_f32_16x16x32_bf16 v[112:115], v[208:211], v[192:195], v[112:115]
    ds_read_b128 v[164:167], v230 offset:8192
    v_mfma_f32_16x16x32_bf16 v[80:83], v[208:211], v[188:191], v[80:83]
    ds_read_b128 v[168:171], v230 offset:10240
    v_mfma_f32_16x16x32_bf16 v[48:51], v[208:211], v[184:187], v[48:51]
    ds_read_b128 v[172:175], v230 offset:12288
    v_mfma_f32_16x16x32_bf16 v[16:19], v[208:211], v[180:183], v[16:19]
    ds_read_b128 v[176:179], v230 offset:14336
    v_mfma_f32_16x16x32_bf16 v[20:23], v[212:215], v[180:183], v[20:23]
    v_mfma_f32_16x16x32_bf16 v[52:55], v[212:215], v[184:187], v[52:55]
    v_mfma_f32_16x16x32_bf16 v[84:87], v[212:215], v[188:191], v[84:87]
    v_mfma_f32_16x16x32_bf16 v[116:119], v[212:215], v[192:195], v[116:119]
    v_mfma_f32_16x16x32_bf16 v[120:123], v[216:219], v[192:195], v[120:123]
    v_mfma_f32_16x16x32_bf16 v[88:91], v[216:219], v[188:191], v[88:91]
    v_mfma_f32_16x16x32_bf16 v[56:59], v[216:219], v[184:187], v[56:59]
    v_mfma_f32_16x16x32_bf16 v[24:27], v[216:219], v[180:183], v[24:27]
    v_mfma_f32_16x16x32_bf16 v[28:31], v[220:223], v[180:183], v[28:31]
    v_mfma_f32_16x16x32_bf16 v[60:63], v[220:223], v[184:187], v[60:63]
    v_mfma_f32_16x16x32_bf16 v[92:95], v[220:223], v[188:191], v[92:95]
    v_mfma_f32_16x16x32_bf16 v[124:127], v[220:223], v[192:195], v[124:127]
    v_mfma_f32_16x16x32_bf16 v[128:131], v[224:227], v[192:195], v[128:131]
    v_mfma_f32_16x16x32_bf16 v[96:99], v[224:227], v[188:191], v[96:99]
    v_mfma_f32_16x16x32_bf16 v[64:67], v[224:227], v[184:187], v[64:67]
    v_mfma_f32_16x16x32_bf16 v[32:35], v[224:227], v[180:183], v[32:35]
    s_lshl_b32 s55, s36, 2
    s_add_u32 s55, s55, s32
    s_lshl_b32 s55, s55, 7
    s_add_u32 s55, s55, 3
    s_lshl_b32 s55, s55, 2
    s_add_u32 s55, s55, 49283072
    v_mov_b32 v244, 1
    v_mov_b32 v245, 1
    v_mov_b32 v246, 1
    v_mov_b32 v247, 1
    v_mov_b32 v239, 0
    v_lshlrev_b32 v239, 7, v1
    s_waitcnt vmcnt(0)
    s_mov_b64 exec, 15
    buffer_store_dword v244, v239, s[8:11], s55 offen sc1
    s_mov_b64 exec, -1
    s_mov_b32 s59, 8
K1_loop_5:
    s_waitcnt lgkmcnt(0)
    v_mfma_f32_16x16x32_bf16 v[4:7], v[148:151], v[132:135], v[4:7]
    ds_read_b64_tr_b16 v[180:181], v228 offset:16384
    v_mfma_f32_16x16x32_bf16 v[36:39], v[148:151], v[136:139], v[36:39]
    ds_read_b64_tr_b16 v[182:183], v228 offset:16640
    v_mfma_f32_16x16x32_bf16 v[68:71], v[148:151], v[140:143], v[68:71]
    ds_read_b64_tr_b16 v[184:185], v229 offset:16384
    v_mfma_f32_16x16x32_bf16 v[100:103], v[148:151], v[144:147], v[100:103]
    ds_read_b64_tr_b16 v[186:187], v229 offset:16640
    v_mfma_f32_16x16x32_bf16 v[104:107], v[152:155], v[144:147], v[104:107]
    ds_read_b64_tr_b16 v[188:189], v228 offset:18432
    v_mfma_f32_16x16x32_bf16 v[72:75], v[152:155], v[140:143], v[72:75]
    ds_read_b64_tr_b16 v[190:191], v228 offset:18688
    v_mfma_f32_16x16x32_bf16 v[40:43], v[152:155], v[136:139], v[40:43]
    ds_read_b64_tr_b16 v[192:193], v229 offset:18432
    v_mfma_f32_16x16x32_bf16 v[8:11], v[152:155], v[132:135], v[8:11]
    ds_read_b64_tr_b16 v[194:195], v229 offset:18688
    v_mfma_f32_16x16x32_bf16 v[12:15], v[156:159], v[132:135], v[12:15]
    ds_read_b128 v[196:199], v231 offset:0
    v_mfma_f32_16x16x32_bf16 v[44:47], v[156:159], v[136:139], v[44:47]
    ds_read_b128 v[200:203], v231 offset:2048
    v_mfma_f32_16x16x32_bf16 v[76:79], v[156:159], v[140:143], v[76:79]
    ds_read_b128 v[204:207], v231 offset:4096
    v_mfma_f32_16x16x32_bf16 v[108:111], v[156:159], v[144:147], v[108:111]
    ds_read_b128 v[208:211], v231 offset:6144
    v_mfma_f32_16x16x32_bf16 v[112:115], v[160:163], v[144:147], v[112:115]
    ds_read_b128 v[212:215], v231 offset:8192
    v_mfma_f32_16x16x32_bf16 v[80:83], v[160:163], v[140:143], v[80:83]
    ds_read_b128 v[216:219], v231 offset:10240
    v_mfma_f32_16x16x32_bf16 v[48:51], v[160:163], v[136:139], v[48:51]
    ds_read_b128 v[220:223], v231 offset:12288
    v_mfma_f32_16x16x32_bf16 v[16:19], v[160:163], v[132:135], v[16:19]
    ds_read_b128 v[224:227], v231 offset:14336
    v_mfma_f32_16x16x32_bf16 v[20:23], v[164:167], v[132:135], v[20:23]
    s_add_u32 s54, s54, 32768
    s_cmp_eq_u32 s54, 98304
    s_cselect_b32 s56, 4294901760, s57
    s_cselect_b32 s54, 0, s54
    s_ashr_i32 s73, s56, 1
    v_mfma_f32_16x16x32_bf16 v[52:55], v[164:167], v[136:139], v[52:55]
    v_add_u32 v228, s56, v228
    v_mfma_f32_16x16x32_bf16 v[84:87], v[164:167], v[140:143], v[84:87]
    v_add_u32 v229, s56, v229
    v_mfma_f32_16x16x32_bf16 v[116:119], v[164:167], v[144:147], v[116:119]
    v_add_u32 v230, s73, v230
    v_mfma_f32_16x16x32_bf16 v[120:123], v[168:171], v[144:147], v[120:123]
    v_add_u32 v231, s73, v231
    v_mfma_f32_16x16x32_bf16 v[88:91], v[168:171], v[140:143], v[88:91]
    v_mfma_f32_16x16x32_bf16 v[56:59], v[168:171], v[136:139], v[56:59]
    v_mfma_f32_16x16x32_bf16 v[24:27], v[168:171], v[132:135], v[24:27]
    v_mfma_f32_16x16x32_bf16 v[28:31], v[172:175], v[132:135], v[28:31]
    v_mfma_f32_16x16x32_bf16 v[60:63], v[172:175], v[136:139], v[60:63]
    v_mfma_f32_16x16x32_bf16 v[92:95], v[172:175], v[140:143], v[92:95]
    v_mfma_f32_16x16x32_bf16 v[124:127], v[172:175], v[144:147], v[124:127]
    v_mfma_f32_16x16x32_bf16 v[128:131], v[176:179], v[144:147], v[128:131]
    v_mfma_f32_16x16x32_bf16 v[96:99], v[176:179], v[140:143], v[96:99]
    v_mfma_f32_16x16x32_bf16 v[64:67], v[176:179], v[136:139], v[64:67]
    v_mfma_f32_16x16x32_bf16 v[32:35], v[176:179], v[132:135], v[32:35]
    s_waitcnt lgkmcnt(0)
    s_barrier
    v_mfma_f32_16x16x32_bf16 v[4:7], v[196:199], v[180:183], v[4:7]
    ds_read_b64_tr_b16 v[132:133], v228 offset:0
    v_mfma_f32_16x16x32_bf16 v[36:39], v[196:199], v[184:187], v[36:39]
    ds_read_b64_tr_b16 v[134:135], v228 offset:256
    v_mfma_f32_16x16x32_bf16 v[68:71], v[196:199], v[188:191], v[68:71]
    ds_read_b64_tr_b16 v[136:137], v229 offset:0
    v_mfma_f32_16x16x32_bf16 v[100:103], v[196:199], v[192:195], v[100:103]
    ds_read_b64_tr_b16 v[138:139], v229 offset:256
    v_mfma_f32_16x16x32_bf16 v[104:107], v[200:203], v[192:195], v[104:107]
    ds_read_b64_tr_b16 v[140:141], v228 offset:2048
    v_mfma_f32_16x16x32_bf16 v[72:75], v[200:203], v[188:191], v[72:75]
    ds_read_b64_tr_b16 v[142:143], v228 offset:2304
    v_mfma_f32_16x16x32_bf16 v[40:43], v[200:203], v[184:187], v[40:43]
    ds_read_b64_tr_b16 v[144:145], v229 offset:2048
    v_mfma_f32_16x16x32_bf16 v[8:11], v[200:203], v[180:183], v[8:11]
    ds_read_b64_tr_b16 v[146:147], v229 offset:2304
    v_mfma_f32_16x16x32_bf16 v[12:15], v[204:207], v[180:183], v[12:15]
    ds_read_b128 v[148:151], v230 offset:0
    v_mfma_f32_16x16x32_bf16 v[44:47], v[204:207], v[184:187], v[44:47]
    ds_read_b128 v[152:155], v230 offset:2048
    v_mfma_f32_16x16x32_bf16 v[76:79], v[204:207], v[188:191], v[76:79]
    ds_read_b128 v[156:159], v230 offset:4096
    v_mfma_f32_16x16x32_bf16 v[108:111], v[204:207], v[192:195], v[108:111]
    ds_read_b128 v[160:163], v230 offset:6144
    v_mfma_f32_16x16x32_bf16 v[112:115], v[208:211], v[192:195], v[112:115]
    ds_read_b128 v[164:167], v230 offset:8192
    v_mfma_f32_16x16x32_bf16 v[80:83], v[208:211], v[188:191], v[80:83]
    ds_read_b128 v[168:171], v230 offset:10240
    v_mfma_f32_16x16x32_bf16 v[48:51], v[208:211], v[184:187], v[48:51]
    ds_read_b128 v[172:175], v230 offset:12288
    v_mfma_f32_16x16x32_bf16 v[16:19], v[208:211], v[180:183], v[16:19]
    ds_read_b128 v[176:179], v230 offset:14336
    v_mfma_f32_16x16x32_bf16 v[20:23], v[212:215], v[180:183], v[20:23]
    v_mfma_f32_16x16x32_bf16 v[52:55], v[212:215], v[184:187], v[52:55]
    v_mfma_f32_16x16x32_bf16 v[84:87], v[212:215], v[188:191], v[84:87]
    v_mfma_f32_16x16x32_bf16 v[116:119], v[212:215], v[192:195], v[116:119]
    v_mfma_f32_16x16x32_bf16 v[120:123], v[216:219], v[192:195], v[120:123]
    v_mfma_f32_16x16x32_bf16 v[88:91], v[216:219], v[188:191], v[88:91]
    v_mfma_f32_16x16x32_bf16 v[56:59], v[216:219], v[184:187], v[56:59]
    v_mfma_f32_16x16x32_bf16 v[24:27], v[216:219], v[180:183], v[24:27]
    v_mfma_f32_16x16x32_bf16 v[28:31], v[220:223], v[180:183], v[28:31]
    v_mfma_f32_16x16x32_bf16 v[60:63], v[220:223], v[184:187], v[60:63]
    v_mfma_f32_16x16x32_bf16 v[92:95], v[220:223], v[188:191], v[92:95]
    v_mfma_f32_16x16x32_bf16 v[124:127], v[220:223], v[192:195], v[124:127]
    v_mfma_f32_16x16x32_bf16 v[128:131], v[224:227], v[192:195], v[128:131]
    v_mfma_f32_16x16x32_bf16 v[96:99], v[224:227], v[188:191], v[96:99]
    v_mfma_f32_16x16x32_bf16 v[64:67], v[224:227], v[184:187], v[64:67]
    v_mfma_f32_16x16x32_bf16 v[32:35], v[224:227], v[180:183], v[32:35]
    s_sub_u32 s59, s59, 1
    s_cmp_lg_u32 s59, 0
    s_cbranch_scc1 K1_loop_5
    s_waitcnt lgkmcnt(0)
    v_mfma_f32_16x16x32_bf16 v[4:7], v[148:151], v[132:135], v[4:7]
    ds_read_b64_tr_b16 v[180:181], v228 offset:16384
    v_mfma_f32_16x16x32_bf16 v[36:39], v[148:151], v[136:139], v[36:39]
    ds_read_b64_tr_b16 v[182:183], v228 offset:16640
    v_mfma_f32_16x16x32_bf16 v[68:71], v[148:151], v[140:143], v[68:71]
    ds_read_b64_tr_b16 v[184:185], v229 offset:16384
    v_mfma_f32_16x16x32_bf16 v[100:103], v[148:151], v[144:147], v[100:103]
    ds_read_b64_tr_b16 v[186:187], v229 offset:16640
    v_mfma_f32_16x16x32_bf16 v[104:107], v[152:155], v[144:147], v[104:107]
    ds_read_b64_tr_b16 v[188:189], v228 offset:18432
    v_mfma_f32_16x16x32_bf16 v[72:75], v[152:155], v[140:143], v[72:75]
    ds_read_b64_tr_b16 v[190:191], v228 offset:18688
    v_mfma_f32_16x16x32_bf16 v[40:43], v[152:155], v[136:139], v[40:43]
    ds_read_b64_tr_b16 v[192:193], v229 offset:18432
    v_mfma_f32_16x16x32_bf16 v[8:11], v[152:155], v[132:135], v[8:11]
    ds_read_b64_tr_b16 v[194:195], v229 offset:18688
    v_mfma_f32_16x16x32_bf16 v[12:15], v[156:159], v[132:135], v[12:15]
    ds_read_b128 v[196:199], v231 offset:0
    v_mfma_f32_16x16x32_bf16 v[44:47], v[156:159], v[136:139], v[44:47]
    ds_read_b128 v[200:203], v231 offset:2048
    v_mfma_f32_16x16x32_bf16 v[76:79], v[156:159], v[140:143], v[76:79]
    ds_read_b128 v[204:207], v231 offset:4096
    v_mfma_f32_16x16x32_bf16 v[108:111], v[156:159], v[144:147], v[108:111]
    ds_read_b128 v[208:211], v231 offset:6144
    v_mfma_f32_16x16x32_bf16 v[112:115], v[160:163], v[144:147], v[112:115]
    ds_read_b128 v[212:215], v231 offset:8192
    v_mfma_f32_16x16x32_bf16 v[80:83], v[160:163], v[140:143], v[80:83]
    ds_read_b128 v[216:219], v231 offset:10240
    v_mfma_f32_16x16x32_bf16 v[48:51], v[160:163], v[136:139], v[48:51]
    ds_read_b128 v[220:223], v231 offset:12288
    v_mfma_f32_16x16x32_bf16 v[16:19], v[160:163], v[132:135], v[16:19]
    ds_read_b128 v[224:227], v231 offset:14336
    v_mfma_f32_16x16x32_bf16 v[20:23], v[164:167], v[132:135], v[20:23]
    s_cmp_lt_u32 s32, s33
    s_subb_u32 s69, s33, 0
    s_lshl_b32 s58, s36, 2
    s_add_u32 s58, s58, s32
    s_lshl_b32 s55, s58, 7
    s_add_u32 s55, s55, s69
    s_lshl_b32 s55, s55, 2
    s_add_u32 s55, s55, 49283072
    s_lshl_b32 s58, s58, 2
    s_add_u32 s58, s58, s69
    s_lshl_b32 s58, s58, 14
    s_add_u32 s58, s58, 27262976
    s_mov_b32 s59, 32768
    s_cmp_eq_u32 s32, s33
    s_cselect_b32 s58, 0x20000000, s58
    s_cselect_b32 s55, 0x20000000, s55
    s_cselect_b32 s69, s59, 114688
    v_add_u32 v251, s69, v241
    v_mfma_f32_16x16x32_bf16 v[52:55], v[164:167], v[136:139], v[52:55]
    v_mov_b32 v244, 1
    v_mov_b32 v239, 0
    v_mfma_f32_16x16x32_bf16 v[84:87], v[164:167], v[140:143], v[84:87]
    s_xor_b32 s71, s32, 4
    s_lshr_b32 s71, s71, 1
    s_and_b32 s72, s32, 1
    s_lshl_b32 s68, s34, 8
    s_lshl_b32 s69, s33, 6
    s_add_u32 s68, s68, s69
    s_lshl_b32 s69, s72, 2
    s_add_u32 s68, s68, s69
    v_and_b32 v252, 15, v1
    v_mfma_f32_16x16x32_bf16 v[116:119], v[164:167], v[144:147], v[116:119]
    v_lshrrev_b32 v248, 2, v252
    v_lshlrev_b32 v248, 4, v248
    v_mfma_f32_16x16x32_bf16 v[120:123], v[168:171], v[144:147], v[120:123]
    v_and_b32 v253, 1, v252
    v_lshl_add_u32 v248, v253, 3, v248
    v_mfma_f32_16x16x32_bf16 v[88:91], v[168:171], v[140:143], v[88:91]
    v_bfe_u32 v253, v252, 1, 1
    v_add_u32 v248, v248, v253
    v_mfma_f32_16x16x32_bf16 v[56:59], v[168:171], v[136:139], v[56:59]
    v_add_u32 v248, s68, v248
    s_lshl_b32 s68, s35, 7
    s_lshl_b32 s69, s71, 5
    s_add_u32 s68, s68, s69
    v_lshrrev_b32 v252, 4, v1
    v_mfma_f32_16x16x32_bf16 v[24:27], v[168:171], v[132:135], v[24:27]
    v_lshl_add_u32 v252, v252, 2, s68
    v_lshlrev_b32 v253, 4, v248
    v_mfma_f32_16x16x32_bf16 v[28:31], v[172:175], v[132:135], v[28:31]
    v_lshlrev_b32 v249, 12, v248
    v_lshl_add_u32 v249, v252, 2, v249
    v_mfma_f32_16x16x32_bf16 v[60:63], v[172:175], v[136:139], v[60:63]
    v_lshrrev_b32 v248, 1, v249
    v_lshlrev_b32 v252, 1, v252
    s_mov_b32 s60, 0
    s_mov_b32 s61, 4096
    s_mov_b32 s62, 8192
    s_mov_b32 s63, 0
    s_mov_b32 s68, 48234496
    v_mfma_f32_16x16x32_bf16 v[92:95], v[172:175], v[140:143], v[92:95]
    v_mfma_f32_16x16x32_bf16 v[124:127], v[172:175], v[144:147], v[124:127]
    v_mfma_f32_16x16x32_bf16 v[128:131], v[176:179], v[144:147], v[128:131]
    v_mfma_f32_16x16x32_bf16 v[96:99], v[176:179], v[140:143], v[96:99]
    v_mfma_f32_16x16x32_bf16 v[64:67], v[176:179], v[136:139], v[64:67]
    v_mfma_f32_16x16x32_bf16 v[32:35], v[176:179], v[132:135], v[32:35]
    s_waitcnt lgkmcnt(0)
    s_barrier
    s_branch K2_last1
K2_c2:
    s_lshl_b32 s55, s32, 12
    s_add_u32 s55, s55, s54
    v_add_u32 v228, s55, v241
    v_lshrrev_b32 v238, 2, v1
    v_lshlrev_b32 v239, 8, v238
    v_and_b32 v238, 7, v238
    v_lshl_add_u32 v239, v238, 5, v239
    v_and_b32 v238, 3, v1
    v_lshl_add_u32 v239, v238, 3, v239
    s_lshr_b32 s55, s54, 1
    s_add_u32 s55, s55, 98304
    v_xor_b32 v238, 0, v239
    v_add_u32 v230, s55, v238
    v_xor_b32 v238, 32, v239
    v_add_u32 v231, s55, v238
    v_xor_b32 v238, 64, v239
    v_add_u32 v232, s55, v238
    v_xor_b32 v238, 96, v239
    v_add_u32 v233, s55, v238
    v_xor_b32 v238, 128, v239
    v_add_u32 v234, s55, v238
    v_xor_b32 v238, 160, v239
    v_add_u32 v235, s55, v238
    v_xor_b32 v238, 192, v239
    v_add_u32 v236, s55, v238
    v_xor_b32 v238, 224, v239
    v_add_u32 v237, s55, v238
    s_barrier
    ds_read_b128 v[132:135], v228 offset:0
    ds_read_b128 v[136:139], v228 offset:1024
    ds_read_b128 v[140:143], v228 offset:2048
    ds_read_b128 v[144:147], v228 offset:3072
    ds_read_b64_tr_b16 v[148:149], v230 offset:0
    ds_read_b64_tr_b16 v[150:151], v230 offset:4096
    ds_read_b64_tr_b16 v[152:153], v231 offset:0
    ds_read_b64_tr_b16 v[154:155], v231 offset:4096
    ds_read_b64_tr_b16 v[156:157], v232 offset:0
    ds_read_b64_tr_b16 v[158:159], v232 offset:4096
    ds_read_b64_tr_b16 v[160:161], v233 offset:0
    ds_read_b64_tr_b16 v[162:163], v233 offset:4096
    ds_read_b64_tr_b16 v[164:165], v234 offset:0
    ds_read_b64_tr_b16 v[166:167], v234 offset:4096
    ds_read_b64_tr_b16 v[168:169], v235 offset:0
    ds_read_b64_tr_b16 v[170:171], v235 offset:4096
    ds_read_b64_tr_b16 v[172:173], v236 offset:0
    ds_read_b64_tr_b16 v[174:175], v236 offset:4096
    ds_read_b64_tr_b16 v[176:177], v237 offset:0
    ds_read_b64_tr_b16 v[178:179], v237 offset:4096
    s_waitcnt lgkmcnt(0)
    v_mfma_f32_16x16x32_bf16 v[4:7], v[148:151], v[132:135], v[4:7]
    ds_read_b128 v[180:183], v228 offset:16384
    v_mfma_f32_16x16x32_bf16 v[36:39], v[148:151], v[136:139], v[36:39]
    ds_read_b128 v[184:187], v228 offset:17408
    v_mfma_f32_16x16x32_bf16 v[68:71], v[148:151], v[140:143], v[68:71]
    ds_read_b128 v[188:191], v228 offset:18432
    v_mfma_f32_16x16x32_bf16 v[100:103], v[148:151], v[144:147], v[100:103]
    ds_read_b128 v[192:195], v228 offset:19456
    v_mfma_f32_16x16x32_bf16 v[104:107], v[152:155], v[144:147], v[104:107]
    ds_read_b64_tr_b16 v[196:197], v230 offset:8192
    v_mfma_f32_16x16x32_bf16 v[72:75], v[152:155], v[140:143], v[72:75]
    ds_read_b64_tr_b16 v[198:199], v230 offset:12288
    v_mfma_f32_16x16x32_bf16 v[40:43], v[152:155], v[136:139], v[40:43]
    ds_read_b64_tr_b16 v[200:201], v231 offset:8192
    v_mfma_f32_16x16x32_bf16 v[8:11], v[152:155], v[132:135], v[8:11]
    ds_read_b64_tr_b16 v[202:203], v231 offset:12288
    v_mfma_f32_16x16x32_bf16 v[12:15], v[156:159], v[132:135], v[12:15]
    ds_read_b64_tr_b16 v[204:205], v232 offset:8192
    v_mfma_f32_16x16x32_bf16 v[44:47], v[156:159], v[136:139], v[44:47]
    ds_read_b64_tr_b16 v[206:207], v232 offset:12288
    v_mfma_f32_16x16x32_bf16 v[76:79], v[156:159], v[140:143], v[76:79]
    ds_read_b64_tr_b16 v[208:209], v233 offset:8192
    v_mfma_f32_16x16x32_bf16 v[108:111], v[156:159], v[144:147], v[108:111]
    ds_read_b64_tr_b16 v[210:211], v233 offset:12288
    v_mfma_f32_16x16x32_bf16 v[112:115], v[160:163], v[144:147], v[112:115]
    ds_read_b64_tr_b16 v[212:213], v234 offset:8192
    v_mfma_f32_16x16x32_bf16 v[80:83], v[160:163], v[140:143], v[80:83]
    ds_read_b64_tr_b16 v[214:215], v234 offset:12288
    v_mfma_f32_16x16x32_bf16 v[48:51], v[160:163], v[136:139], v[48:51]
    ds_read_b64_tr_b16 v[216:217], v235 offset:8192
    v_mfma_f32_16x16x32_bf16 v[16:19], v[160:163], v[132:135], v[16:19]
    ds_read_b64_tr_b16 v[218:219], v235 offset:12288
    v_mfma_f32_16x16x32_bf16 v[20:23], v[164:167], v[132:135], v[20:23]
    ds_read_b64_tr_b16 v[220:221], v236 offset:8192
    v_mfma_f32_16x16x32_bf16 v[52:55], v[164:167], v[136:139], v[52:55]
    ds_read_b64_tr_b16 v[222:223], v236 offset:12288
    v_mfma_f32_16x16x32_bf16 v[84:87], v[164:167], v[140:143], v[84:87]
    ds_read_b64_tr_b16 v[224:225], v237 offset:8192
    v_mfma_f32_16x16x32_bf16 v[116:119], v[164:167], v[144:147], v[116:119]
    ds_read_b64_tr_b16 v[226:227], v237 offset:12288
    v_mfma_f32_16x16x32_bf16 v[120:123], v[168:171], v[144:147], v[120:123]
    s_add_u32 s54, s54, 32768
    s_cmp_eq_u32 s54, 98304
    s_cselect_b32 s56, 4294901760, s57
    s_cselect_b32 s54, 0, s54
    s_ashr_i32 s73, s56, 1
    v_mfma_f32_16x16x32_bf16 v[88:91], v[168:171], v[140:143], v[88:91]
    v_add_u32 v228, s56, v228
    v_mfma_f32_16x16x32_bf16 v[56:59], v[168:171], v[136:139], v[56:59]
    v_add_u32 v230, s73, v230
    v_mfma_f32_16x16x32_bf16 v[24:27], v[168:171], v[132:135], v[24:27]
    v_add_u32 v231, s73, v231
    v_mfma_f32_16x16x32_bf16 v[28:31], v[172:175], v[132:135], v[28:31]
    v_add_u32 v232, s73, v232
    v_mfma_f32_16x16x32_bf16 v[60:63], v[172:175], v[136:139], v[60:63]
    v_add_u32 v233, s73, v233
    v_mfma_f32_16x16x32_bf16 v[92:95], v[172:175], v[140:143], v[92:95]
    v_add_u32 v234, s73, v234
    v_mfma_f32_16x16x32_bf16 v[124:127], v[172:175], v[144:147], v[124:127]
    v_add_u32 v235, s73, v235
    v_mfma_f32_16x16x32_bf16 v[128:131], v[176:179], v[144:147], v[128:131]
    v_add_u32 v236, s73, v236
    v_mfma_f32_16x16x32_bf16 v[96:99], v[176:179], v[140:143], v[96:99]
    v_add_u32 v237, s73, v237
    v_mfma_f32_16x16x32_bf16 v[64:67], v[176:179], v[136:139], v[64:67]
    v_mfma_f32_16x16x32_bf16 v[32:35], v[176:179], v[132:135], v[32:35]
    v_mov_b32 v238, 1
    v_mov_b32 v239, 0
    s_waitcnt vmcnt(0)
    s_mov_b64 exec, 1
    buffer_store_dword v238, v239, s[8:11], s91 offen offset:512 sc1
    s_mov_b64 exec, -1
    s_waitcnt lgkmcnt(0)
    s_barrier
    v_mfma_f32_16x16x32_bf16 v[4:7], v[196:199], v[180:183], v[4:7]
    ds_read_b128 v[132:135], v228 offset:0
    v_mfma_f32_16x16x32_bf16 v[36:39], v[196:199], v[184:187], v[36:39]
    ds_read_b128 v[136:139], v228 offset:1024
    v_mfma_f32_16x16x32_bf16 v[68:71], v[196:199], v[188:191], v[68:71]
    ds_read_b128 v[140:143], v228 offset:2048
    v_mfma_f32_16x16x32_bf16 v[100:103], v[196:199], v[192:195], v[100:103]
    ds_read_b128 v[144:147], v228 offset:3072
    v_mfma_f32_16x16x32_bf16 v[104:107], v[200:203], v[192:195], v[104:107]
    ds_read_b64_tr_b16 v[148:149], v230 offset:0
    v_mfma_f32_16x16x32_bf16 v[72:75], v[200:203], v[188:191], v[72:75]
    ds_read_b64_tr_b16 v[150:151], v230 offset:4096
    v_mfma_f32_16x16x32_bf16 v[40:43], v[200:203], v[184:187], v[40:43]
    ds_read_b64_tr_b16 v[152:153], v231 offset:0
    v_mfma_f32_16x16x32_bf16 v[8:11], v[200:203], v[180:183], v[8:11]
    ds_read_b64_tr_b16 v[154:155], v231 offset:4096
    v_mfma_f32_16x16x32_bf16 v[12:15], v[204:207], v[180:183], v[12:15]
    ds_read_b64_tr_b16 v[156:157], v232 offset:0
    v_mfma_f32_16x16x32_bf16 v[44:47], v[204:207], v[184:187], v[44:47]
    ds_read_b64_tr_b16 v[158:159], v232 offset:4096
    v_mfma_f32_16x16x32_bf16 v[76:79], v[204:207], v[188:191], v[76:79]
    ds_read_b64_tr_b16 v[160:161], v233 offset:0
    v_mfma_f32_16x16x32_bf16 v[108:111], v[204:207], v[192:195], v[108:111]
    ds_read_b64_tr_b16 v[162:163], v233 offset:4096
    v_mfma_f32_16x16x32_bf16 v[112:115], v[208:211], v[192:195], v[112:115]
    ds_read_b64_tr_b16 v[164:165], v234 offset:0
    v_mfma_f32_16x16x32_bf16 v[80:83], v[208:211], v[188:191], v[80:83]
    ds_read_b64_tr_b16 v[166:167], v234 offset:4096
    v_mfma_f32_16x16x32_bf16 v[48:51], v[208:211], v[184:187], v[48:51]
    ds_read_b64_tr_b16 v[168:169], v235 offset:0
    v_mfma_f32_16x16x32_bf16 v[16:19], v[208:211], v[180:183], v[16:19]
    ds_read_b64_tr_b16 v[170:171], v235 offset:4096
    v_mfma_f32_16x16x32_bf16 v[20:23], v[212:215], v[180:183], v[20:23]
    ds_read_b64_tr_b16 v[172:173], v236 offset:0
    v_mfma_f32_16x16x32_bf16 v[52:55], v[212:215], v[184:187], v[52:55]
    ds_read_b64_tr_b16 v[174:175], v236 offset:4096
    v_mfma_f32_16x16x32_bf16 v[84:87], v[212:215], v[188:191], v[84:87]
    ds_read_b64_tr_b16 v[176:177], v237 offset:0
    v_mfma_f32_16x16x32_bf16 v[116:119], v[212:215], v[192:195], v[116:119]
    ds_read_b64_tr_b16 v[178:179], v237 offset:4096
    v_mfma_f32_16x16x32_bf16 v[120:123], v[216:219], v[192:195], v[120:123]
    v_mfma_f32_16x16x32_bf16 v[88:91], v[216:219], v[188:191], v[88:91]
    v_mfma_f32_16x16x32_bf16 v[56:59], v[216:219], v[184:187], v[56:59]
    v_mfma_f32_16x16x32_bf16 v[24:27], v[216:219], v[180:183], v[24:27]
    v_mfma_f32_16x16x32_bf16 v[28:31], v[220:223], v[180:183], v[28:31]
    v_mfma_f32_16x16x32_bf16 v[60:63], v[220:223], v[184:187], v[60:63]
    v_mfma_f32_16x16x32_bf16 v[92:95], v[220:223], v[188:191], v[92:95]
    v_mfma_f32_16x16x32_bf16 v[124:127], v[220:223], v[192:195], v[124:127]
    v_mfma_f32_16x16x32_bf16 v[128:131], v[224:227], v[192:195], v[128:131]
    v_mfma_f32_16x16x32_bf16 v[96:99], v[224:227], v[188:191], v[96:99]
    v_mfma_f32_16x16x32_bf16 v[64:67], v[224:227], v[184:187], v[64:67]
    v_mfma_f32_16x16x32_bf16 v[32:35], v[224:227], v[180:183], v[32:35]
    s_mov_b32 s59, 21
K1_loop_6:
    s_waitcnt lgkmcnt(0)
    v_mfma_f32_16x16x32_bf16 v[4:7], v[148:151], v[132:135], v[4:7]
    ds_read_b128 v[180:183], v228 offset:16384
    v_mfma_f32_16x16x32_bf16 v[36:39], v[148:151], v[136:139], v[36:39]
    ds_read_b128 v[184:187], v228 offset:17408
    v_mfma_f32_16x16x32_bf16 v[68:71], v[148:151], v[140:143], v[68:71]
    ds_read_b128 v[188:191], v228 offset:18432
    v_mfma_f32_16x16x32_bf16 v[100:103], v[148:151], v[144:147], v[100:103]
    ds_read_b128 v[192:195], v228 offset:19456
    v_mfma_f32_16x16x32_bf16 v[104:107], v[152:155], v[144:147], v[104:107]
    ds_read_b64_tr_b16 v[196:197], v230 offset:8192
    v_mfma_f32_16x16x32_bf16 v[72:75], v[152:155], v[140:143], v[72:75]
    ds_read_b64_tr_b16 v[198:199], v230 offset:12288
    v_mfma_f32_16x16x32_bf16 v[40:43], v[152:155], v[136:139], v[40:43]
    ds_read_b64_tr_b16 v[200:201], v231 offset:8192
    v_mfma_f32_16x16x32_bf16 v[8:11], v[152:155], v[132:135], v[8:11]
    ds_read_b64_tr_b16 v[202:203], v231 offset:12288
    v_mfma_f32_16x16x32_bf16 v[12:15], v[156:159], v[132:135], v[12:15]
    ds_read_b64_tr_b16 v[204:205], v232 offset:8192
    v_mfma_f32_16x16x32_bf16 v[44:47], v[156:159], v[136:139], v[44:47]
    ds_read_b64_tr_b16 v[206:207], v232 offset:12288
    v_mfma_f32_16x16x32_bf16 v[76:79], v[156:159], v[140:143], v[76:79]
    ds_read_b64_tr_b16 v[208:209], v233 offset:8192
    v_mfma_f32_16x16x32_bf16 v[108:111], v[156:159], v[144:147], v[108:111]
    ds_read_b64_tr_b16 v[210:211], v233 offset:12288
    v_mfma_f32_16x16x32_bf16 v[112:115], v[160:163], v[144:147], v[112:115]
    ds_read_b64_tr_b16 v[212:213], v234 offset:8192
    v_mfma_f32_16x16x32_bf16 v[80:83], v[160:163], v[140:143], v[80:83]
    ds_read_b64_tr_b16 v[214:215], v234 offset:12288
    v_mfma_f32_16x16x32_bf16 v[48:51], v[160:163], v[136:139], v[48:51]
    ds_read_b64_tr_b16 v[216:217], v235 offset:8192
    v_mfma_f32_16x16x32_bf16 v[16:19], v[160:163], v[132:135], v[16:19]
    ds_read_b64_tr_b16 v[218:219], v235 offset:12288
    v_mfma_f32_16x16x32_bf16 v[20:23], v[164:167], v[132:135], v[20:23]
    ds_read_b64_tr_b16 v[220:221], v236 offset:8192
    v_mfma_f32_16x16x32_bf16 v[52:55], v[164:167], v[136:139], v[52:55]
    ds_read_b64_tr_b16 v[222:223], v236 offset:12288
    v_mfma_f32_16x16x32_bf16 v[84:87], v[164:167], v[140:143], v[84:87]
    ds_read_b64_tr_b16 v[224:225], v237 offset:8192
    v_mfma_f32_16x16x32_bf16 v[116:119], v[164:167], v[144:147], v[116:119]
    ds_read_b64_tr_b16 v[226:227], v237 offset:12288
    v_mfma_f32_16x16x32_bf16 v[120:123], v[168:171], v[144:147], v[120:123]
    s_add_u32 s54, s54, 32768
    s_cmp_eq_u32 s54, 98304
    s_cselect_b32 s56, 4294901760, s57
    s_cselect_b32 s54, 0, s54
    s_ashr_i32 s73, s56, 1
    v_mfma_f32_16x16x32_bf16 v[88:91], v[168:171], v[140:143], v[88:91]
    v_add_u32 v228, s56, v228
    v_mfma_f32_16x16x32_bf16 v[56:59], v[168:171], v[136:139], v[56:59]
    v_add_u32 v230, s73, v230
    v_mfma_f32_16x16x32_bf16 v[24:27], v[168:171], v[132:135], v[24:27]
    v_add_u32 v231, s73, v231
    v_mfma_f32_16x16x32_bf16 v[28:31], v[172:175], v[132:135], v[28:31]
    v_add_u32 v232, s73, v232
    v_mfma_f32_16x16x32_bf16 v[60:63], v[172:175], v[136:139], v[60:63]
    v_add_u32 v233, s73, v233
    v_mfma_f32_16x16x32_bf16 v[92:95], v[172:175], v[140:143], v[92:95]
    v_add_u32 v234, s73, v234
    v_mfma_f32_16x16x32_bf16 v[124:127], v[172:175], v[144:147], v[124:127]
    v_add_u32 v235, s73, v235
    v_mfma_f32_16x16x32_bf16 v[128:131], v[176:179], v[144:147], v[128:131]
    v_add_u32 v236, s73, v236
    v_mfma_f32_16x16x32_bf16 v[96:99], v[176:179], v[140:143], v[96:99]
    v_add_u32 v237, s73, v237
    v_mfma_f32_16x16x32_bf16 v[64:67], v[176:179], v[136:139], v[64:67]
    v_mfma_f32_16x16x32_bf16 v[32:35], v[176:179], v[132:135], v[32:35]
    s_waitcnt lgkmcnt(0)
    s_barrier
    v_mfma_f32_16x16x32_bf16 v[4:7], v[196:199], v[180:183], v[4:7]
    ds_read_b128 v[132:135], v228 offset:0
    v_mfma_f32_16x16x32_bf16 v[36:39], v[196:199], v[184:187], v[36:39]
    ds_read_b128 v[136:139], v228 offset:1024
    v_mfma_f32_16x16x32_bf16 v[68:71], v[196:199], v[188:191], v[68:71]
    ds_read_b128 v[140:143], v228 offset:2048
    v_mfma_f32_16x16x32_bf16 v[100:103], v[196:199], v[192:195], v[100:103]
    ds_read_b128 v[144:147], v228 offset:3072
    v_mfma_f32_16x16x32_bf16 v[104:107], v[200:203], v[192:195], v[104:107]
    ds_read_b64_tr_b16 v[148:149], v230 offset:0
    v_mfma_f32_16x16x32_bf16 v[72:75], v[200:203], v[188:191], v[72:75]
    ds_read_b64_tr_b16 v[150:151], v230 offset:4096
    v_mfma_f32_16x16x32_bf16 v[40:43], v[200:203], v[184:187], v[40:43]
    ds_read_b64_tr_b16 v[152:153], v231 offset:0
    v_mfma_f32_16x16x32_bf16 v[8:11], v[200:203], v[180:183], v[8:11]
    ds_read_b64_tr_b16 v[154:155], v231 offset:4096
    v_mfma_f32_16x16x32_bf16 v[12:15], v[204:207], v[180:183], v[12:15]
    ds_read_b64_tr_b16 v[156:157], v232 offset:0
    v_mfma_f32_16x16x32_bf16 v[44:47], v[204:207], v[184:187], v[44:47]
    ds_read_b64_tr_b16 v[158:159], v232 offset:4096
    v_mfma_f32_16x16x32_bf16 v[76:79], v[204:207], v[188:191], v[76:79]
    ds_read_b64_tr_b16 v[160:161], v233 offset:0
    v_mfma_f32_16x16x32_bf16 v[108:111], v[204:207], v[192:195], v[108:111]
    ds_read_b64_tr_b16 v[162:163], v233 offset:4096
    v_mfma_f32_16x16x32_bf16 v[112:115], v[208:211], v[192:195], v[112:115]
    ds_read_b64_tr_b16 v[164:165], v234 offset:0
    v_mfma_f32_16x16x32_bf16 v[80:83], v[208:211], v[188:191], v[80:83]
    ds_read_b64_tr_b16 v[166:167], v234 offset:4096
    v_mfma_f32_16x16x32_bf16 v[48:51], v[208:211], v[184:187], v[48:51]
    ds_read_b64_tr_b16 v[168:169], v235 offset:0
    v_mfma_f32_16x16x32_bf16 v[16:19], v[208:211], v[180:183], v[16:19]
    ds_read_b64_tr_b16 v[170:171], v235 offset:4096
    v_mfma_f32_16x16x32_bf16 v[20:23], v[212:215], v[180:183], v[20:23]
    ds_read_b64_tr_b16 v[172:173], v236 offset:0
    v_mfma_f32_16x16x32_bf16 v[52:55], v[212:215], v[184:187], v[52:55]
    ds_read_b64_tr_b16 v[174:175], v236 offset:4096
    v_mfma_f32_16x16x32_bf16 v[84:87], v[212:215], v[188:191], v[84:87]
    ds_read_b64_tr_b16 v[176:177], v237 offset:0
    v_mfma_f32_16x16x32_bf16 v[116:119], v[212:215], v[192:195], v[116:119]
    ds_read_b64_tr_b16 v[178:179], v237 offset:4096
    v_mfma_f32_16x16x32_bf16 v[120:123], v[216:219], v[192:195], v[120:123]
    v_mfma_f32_16x16x32_bf16 v[88:91], v[216:219], v[188:191], v[88:91]
    v_mfma_f32_16x16x32_bf16 v[56:59], v[216:219], v[184:187], v[56:59]
    v_mfma_f32_16x16x32_bf16 v[24:27], v[216:219], v[180:183], v[24:27]
    v_mfma_f32_16x16x32_bf16 v[28:31], v[220:223], v[180:183], v[28:31]
    v_mfma_f32_16x16x32_bf16 v[60:63], v[220:223], v[184:187], v[60:63]
    v_mfma_f32_16x16x32_bf16 v[92:95], v[220:223], v[188:191], v[92:95]
    v_mfma_f32_16x16x32_bf16 v[124:127], v[220:223], v[192:195], v[124:127]
    v_mfma_f32_16x16x32_bf16 v[128:131], v[224:227], v[192:195], v[128:131]
    v_mfma_f32_16x16x32_bf16 v[96:99], v[224:227], v[188:191], v[96:99]
    v_mfma_f32_16x16x32_bf16 v[64:67], v[224:227], v[184:187], v[64:67]
    v_mfma_f32_16x16x32_bf16 v[32:35], v[224:227], v[180:183], v[32:35]
    s_sub_u32 s59, s59, 1
    s_cmp_lg_u32 s59, 0
    s_cbranch_scc1 K1_loop_6
    s_waitcnt lgkmcnt(0)
    v_mfma_f32_16x16x32_bf16 v[4:7], v[148:151], v[132:135], v[4:7]
    ds_read_b128 v[180:183], v228 offset:16384
    v_mfma_f32_16x16x32_bf16 v[36:39], v[148:151], v[136:139], v[36:39]
    ds_read_b128 v[184:187], v228 offset:17408
    v_mfma_f32_16x16x32_bf16 v[68:71], v[148:151], v[140:143], v[68:71]
    ds_read_b128 v[188:191], v228 offset:18432
    v_mfma_f32_16x16x32_bf16 v[100:103], v[148:151], v[144:147], v[100:103]
    ds_read_b128 v[192:195], v228 offset:19456
    v_mfma_f32_16x16x32_bf16 v[104:107], v[152:155], v[144:147], v[104:107]
    ds_read_b64_tr_b16 v[196:197], v230 offset:8192
    v_mfma_f32_16x16x32_bf16 v[72:75], v[152:155], v[140:143], v[72:75]
    ds_read_b64_tr_b16 v[198:199], v230 offset:12288
    v_mfma_f32_16x16x32_bf16 v[40:43], v[152:155], v[136:139], v[40:43]
    ds_read_b64_tr_b16 v[200:201], v231 offset:8192
    v_mfma_f32_16x16x32_bf16 v[8:11], v[152:155], v[132:135], v[8:11]
    ds_read_b64_tr_b16 v[202:203], v231 offset:12288
    v_mfma_f32_16x16x32_bf16 v[12:15], v[156:159], v[132:135], v[12:15]
    ds_read_b64_tr_b16 v[204:205], v232 offset:8192
    v_mfma_f32_16x16x32_bf16 v[44:47], v[156:159], v[136:139], v[44:47]
    ds_read_b64_tr_b16 v[206:207], v232 offset:12288
    v_mfma_f32_16x16x32_bf16 v[76:79], v[156:159], v[140:143], v[76:79]
    ds_read_b64_tr_b16 v[208:209], v233 offset:8192
    v_mfma_f32_16x16x32_bf16 v[108:111], v[156:159], v[144:147], v[108:111]
    ds_read_b64_tr_b16 v[210:211], v233 offset:12288
    v_mfma_f32_16x16x32_bf16 v[112:115], v[160:163], v[144:147], v[112:115]
    ds_read_b64_tr_b16 v[212:213], v234 offset:8192
    v_mfma_f32_16x16x32_bf16 v[80:83], v[160:163], v[140:143], v[80:83]
    ds_read_b64_tr_b16 v[214:215], v234 offset:12288
    v_mfma_f32_16x16x32_bf16 v[48:51], v[160:163], v[136:139], v[48:51]
    ds_read_b64_tr_b16 v[216:217], v235 offset:8192
    v_mfma_f32_16x16x32_bf16 v[16:19], v[160:163], v[132:135], v[16:19]
    ds_read_b64_tr_b16 v[218:219], v235 offset:12288
    v_mfma_f32_16x16x32_bf16 v[20:23], v[164:167], v[132:135], v[20:23]
    ds_read_b64_tr_b16 v[220:221], v236 offset:8192
    v_mfma_f32_16x16x32_bf16 v[52:55], v[164:167], v[136:139], v[52:55]
    ds_read_b64_tr_b16 v[222:223], v236 offset:12288
    v_mfma_f32_16x16x32_bf16 v[84:87], v[164:167], v[140:143], v[84:87]
    ds_read_b64_tr_b16 v[224:225], v237 offset:8192
    v_mfma_f32_16x16x32_bf16 v[116:119], v[164:167], v[144:147], v[116:119]
    ds_read_b64_tr_b16 v[226:227], v237 offset:12288
    v_mfma_f32_16x16x32_bf16 v[120:123], v[168:171], v[144:147], v[120:123]
    s_cmp_lt_u32 s32, s33
    s_subb_u32 s69, s33, 0
    s_lshl_b32 s58, s36, 2
    s_add_u32 s58, s58, s32
    s_lshl_b32 s55, s58, 7
    s_add_u32 s55, s55, s69
    s_lshl_b32 s55, s55, 2
    s_add_u32 s55, s55, 49283072
    s_lshl_b32 s58, s58, 2
    s_add_u32 s58, s58, s69
    s_lshl_b32 s58, s58, 14
    s_add_u32 s58, s58, 27262976
    s_mov_b32 s59, 0
    s_cmp_eq_u32 s32, s33
    s_cselect_b32 s58, 0x20000000, s58
    s_cselect_b32 s55, 0x20000000, s55
    s_cselect_b32 s69, s59, 98304
    v_add_u32 v251, s69, v241
    v_mfma_f32_16x16x32_bf16 v[88:91], v[168:171], v[140:143], v[88:91]
    v_mov_b32 v244, 1
    v_mov_b32 v239, 0
    v_mfma_f32_16x16x32_bf16 v[56:59], v[168:171], v[136:139], v[56:59]
    s_xor_b32 s71, s32, 4
    s_lshr_b32 s71, s71, 1
    s_and_b32 s72, s32, 1
    s_lshl_b32 s68, s34, 8
    s_lshl_b32 s69, s33, 6
    s_add_u32 s68, s68, s69
    s_lshl_b32 s69, s72, 2
    s_add_u32 s68, s68, s69
    v_and_b32 v252, 15, v1
    v_mfma_f32_16x16x32_bf16 v[24:27], v[168:171], v[132:135], v[24:27]
    v_lshrrev_b32 v248, 2, v252
    v_lshlrev_b32 v248, 4, v248
    v_mfma_f32_16x16x32_bf16 v[28:31], v[172:175], v[132:135], v[28:31]
    v_and_b32 v253, 1, v252
    v_lshl_add_u32 v248, v253, 3, v248
    v_mfma_f32_16x16x32_bf16 v[60:63], v[172:175], v[136:139], v[60:63]
    v_bfe_u32 v253, v252, 1, 1
    v_add_u32 v248, v248, v253
    v_mfma_f32_16x16x32_bf16 v[92:95], v[172:175], v[140:143], v[92:95]
    v_add_u32 v248, s68, v248
    s_lshl_b32 s68, s35, 7
    s_lshl_b32 s69, s71, 5
    s_add_u32 s68, s68, s69
    v_lshrrev_b32 v252, 4, v1
    v_mfma_f32_16x16x32_bf16 v[124:127], v[172:175], v[144:147], v[124:127]
    v_lshl_add_u32 v252, v252, 2, s68
    v_lshlrev_b32 v253, 4, v248
    v_mfma_f32_16x16x32_bf16 v[128:131], v[176:179], v[144:147], v[128:131]
    v_lshlrev_b32 v249, 12, v248
    v_lshl_add_u32 v249, v252, 2, v249
    v_mfma_f32_16x16x32_bf16 v[96:99], v[176:179], v[140:143], v[96:99]
    v_lshrrev_b32 v248, 1, v249
    v_lshlrev_b32 v252, 1, v252
    s_mov_b32 s60, 0
    s_mov_b32 s61, 4096
    s_mov_b32 s62, 8192
    s_mov_b32 s63, 0
    s_mov_b32 s68, 48234496
    v_mfma_f32_16x16x32_bf16 v[64:67], v[176:179], v[136:139], v[64:67]
    v_mfma_f32_16x16x32_bf16 v[32:35], v[176:179], v[132:135], v[32:35]
    s_waitcnt lgkmcnt(0)
    s_barrier
    s_branch K2_last1
K2_c3:
    s_lshl_b32 s55, s32, 12
    s_add_u32 s55, s55, s54
    v_add_u32 v228, s55, v241
    v_lshrrev_b32 v238, 2, v1
    v_lshlrev_b32 v239, 8, v238
    v_and_b32 v238, 7, v238
    v_lshl_add_u32 v239, v238, 5, v239
    v_and_b32 v238, 3, v1
    v_lshl_add_u32 v239, v238, 3, v239
    s_lshr_b32 s55, s54, 1
    s_add_u32 s55, s55, 98304
    v_xor_b32 v238, 0, v239
    v_add_u32 v230, s55, v238
    v_xor_b32 v238, 32, v239
    v_add_u32 v231, s55, v238
    v_xor_b32 v238, 64, v239
    v_add_u32 v232, s55, v238
    v_xor_b32 v238, 96, v239
    v_add_u32 v233, s55, v238
    v_xor_b32 v238, 128, v239
    v_add_u32 v234, s55, v238
    v_xor_b32 v238, 160, v239
    v_add_u32 v235, s55, v238
    v_xor_b32 v238, 192, v239
    v_add_u32 v236, s55, v238
    v_xor_b32 v238, 224, v239
    v_add_u32 v237, s55, v238
    s_barrier
    ds_read_b128 v[132:135], v228 offset:0
    ds_read_b128 v[136:139], v228 offset:1024
    ds_read_b128 v[140:143], v228 offset:2048
    ds_read_b128 v[144:147], v228 offset:3072
    ds_read_b64_tr_b16 v[148:149], v230 offset:0
    ds_read_b64_tr_b16 v[150:151], v230 offset:4096
    ds_read_b64_tr_b16 v[152:153], v231 offset:0
    ds_read_b64_tr_b16 v[154:155], v231 offset:4096
    ds_read_b64_tr_b16 v[156:157], v232 offset:0
    ds_read_b64_tr_b16 v[158:159], v232 offset:4096
    ds_read_b64_tr_b16 v[160:161], v233 offset:0
    ds_read_b64_tr_b16 v[162:163], v233 offset:4096
    ds_read_b64_tr_b16 v[164:165], v234 offset:0
    ds_read_b64_tr_b16 v[166:167], v234 offset:4096
    ds_read_b64_tr_b16 v[168:169], v235 offset:0
    ds_read_b64_tr_b16 v[170:171], v235 offset:4096
    ds_read_b64_tr_b16 v[172:173], v236 offset:0
    ds_read_b64_tr_b16 v[174:175], v236 offset:4096
    ds_read_b64_tr_b16 v[176:177], v237 offset:0
    ds_read_b64_tr_b16 v[178:179], v237 offset:4096
    s_waitcnt lgkmcnt(0)
    v_mfma_f32_16x16x32_bf16 v[4:7], v[148:151], v[132:135], v[4:7]
    ds_read_b128 v[180:183], v228 offset:16384
    v_mfma_f32_16x16x32_bf16 v[36:39], v[148:151], v[136:139], v[36:39]
    ds_read_b128 v[184:187], v228 offset:17408
    v_mfma_f32_16x16x32_bf16 v[68:71], v[148:151], v[140:143], v[68:71]
    ds_read_b128 v[188:191], v228 offset:18432
    v_mfma_f32_16x16x32_bf16 v[100:103], v[148:151], v[144:147], v[100:103]
    ds_read_b128 v[192:195], v228 offset:19456
    v_mfma_f32_16x16x32_bf16 v[104:107], v[152:155], v[144:147], v[104:107]
    ds_read_b64_tr_b16 v[196:197], v230 offset:8192
    v_mfma_f32_16x16x32_bf16 v[72:75], v[152:155], v[140:143], v[72:75]
    ds_read_b64_tr_b16 v[198:199], v230 offset:12288
    v_mfma_f32_16x16x32_bf16 v[40:43], v[152:155], v[136:139], v[40:43]
    ds_read_b64_tr_b16 v[200:201], v231 offset:8192
    v_mfma_f32_16x16x32_bf16 v[8:11], v[152:155], v[132:135], v[8:11]
    ds_read_b64_tr_b16 v[202:203], v231 offset:12288
    v_mfma_f32_16x16x32_bf16 v[12:15], v[156:159], v[132:135], v[12:15]
    ds_read_b64_tr_b16 v[204:205], v232 offset:8192
    v_mfma_f32_16x16x32_bf16 v[44:47], v[156:159], v[136:139], v[44:47]
    ds_read_b64_tr_b16 v[206:207], v232 offset:12288
    v_mfma_f32_16x16x32_bf16 v[76:79], v[156:159], v[140:143], v[76:79]
    ds_read_b64_tr_b16 v[208:209], v233 offset:8192
    v_mfma_f32_16x16x32_bf16 v[108:111], v[156:159], v[144:147], v[108:111]
    ds_read_b64_tr_b16 v[210:211], v233 offset:12288
    v_mfma_f32_16x16x32_bf16 v[112:115], v[160:163], v[144:147], v[112:115]
    ds_read_b64_tr_b16 v[212:213], v234 offset:8192
    v_mfma_f32_16x16x32_bf16 v[80:83], v[160:163], v[140:143], v[80:83]
    ds_read_b64_tr_b16 v[214:215], v234 offset:12288
    v_mfma_f32_16x16x32_bf16 v[48:51], v[160:163], v[136:139], v[48:51]
    ds_read_b64_tr_b16 v[216:217], v235 offset:8192
    v_mfma_f32_16x16x32_bf16 v[16:19], v[160:163], v[132:135], v[16:19]
    ds_read_b64_tr_b16 v[218:219], v235 offset:12288
    v_mfma_f32_16x16x32_bf16 v[20:23], v[164:167], v[132:135], v[20:23]
    ds_read_b64_tr_b16 v[220:221], v236 offset:8192
    v_mfma_f32_16x16x32_bf16 v[52:55], v[164:167], v[136:139], v[52:55]
    ds_read_b64_tr_b16 v[222:223], v236 offset:12288
    v_mfma_f32_16x16x32_bf16 v[84:87], v[164:167], v[140:143], v[84:87]
    ds_read_b64_tr_b16 v[224:225], v237 offset:8192
    v_mfma_f32_16x16x32_bf16 v[116:119], v[164:167], v[144:147], v[116:119]
    ds_read_b64_tr_b16 v[226:227], v237 offset:12288
    v_mfma_f32_16x16x32_bf16 v[120:123], v[168:171], v[144:147], v[120:123]
    s_add_u32 s54, s54, 32768
    s_cmp_eq_u32 s54, 98304
    s_cselect_b32 s56, 4294901760, s57
    s_cselect_b32 s54, 0, s54
    s_ashr_i32 s73, s56, 1
    v_mfma_f32_16x16x32_bf16 v[88:91], v[168:171], v[140:143], v[88:91]
    v_add_u32 v228, s56, v228
    v_mfma_f32_16x16x32_bf16 v[56:59], v[168:171], v[136:139], v[56:59]
    v_add_u32 v230, s73, v230
    v_mfma_f32_16x16x32_bf16 v[24:27], v[168:171], v[132:135], v[24:27]
    v_add_u32 v231, s73, v231
    v_mfma_f32_16x16x32_bf16 v[28:31], v[172:175], v[132:135], v[28:31]
    v_add_u32 v232, s73, v232
    v_mfma_f32_16x16x32_bf16 v[60:63], v[172:175], v[136:139], v[60:63]
    v_add_u32 v233, s73, v233
    v_mfma_f32_16x16x32_bf16 v[92:95], v[172:175], v[140:143], v[92:95]
    v_add_u32 v234, s73, v234
    v_mfma_f32_16x16x32_bf16 v[124:127], v[172:175], v[144:147], v[124:127]
    v_add_u32 v235, s73, v235
    v_mfma_f32_16x16x32_bf16 v[128:131], v[176:179], v[144:147], v[128:131]
    v_add_u32 v236, s73, v236
    v_mfma_f32_16x16x32_bf16 v[96:99], v[176:179], v[140:143], v[96:99]
    v_add_u32 v237, s73, v237
    v_mfma_f32_16x16x32_bf16 v[64:67], v[176:179], v[136:139], v[64:67]
    v_mfma_f32_16x16x32_bf16 v[32:35], v[176:179], v[132:135], v[32:35]
    v_mov_b32 v238, 1
    v_mov_b32 v239, 0
    s_waitcnt vmcnt(0)
    s_mov_b64 exec, 1
    buffer_store_dword v238, v239, s[8:11], s91 offen offset:512 sc1
    s_mov_b64 exec, -1
    s_waitcnt lgkmcnt(0)
    s_barrier
    v_mfma_f32_16x16x32_bf16 v[4:7], v[196:199], v[180:183], v[4:7]
    ds_read_b128 v[132:135], v228 offset:0
    v_mfma_f32_16x16x32_bf16 v[36:39], v[196:199], v[184:187], v[36:39]
    ds_read_b128 v[136:139], v228 offset:1024
    v_mfma_f32_16x16x32_bf16 v[68:71], v[196:199], v[188:191], v[68:71]
    ds_read_b128 v[140:143], v228 offset:2048
    v_mfma_f32_16x16x32_bf16 v[100:103], v[196:199], v[192:195], v[100:103]
    ds_read_b128 v[144:147], v228 offset:3072
    v_mfma_f32_16x16x32_bf16 v[104:107], v[200:203], v[192:195], v[104:107]
    ds_read_b64_tr_b16 v[148:149], v230 offset:0
    v_mfma_f32_16x16x32_bf16 v[72:75], v[200:203], v[188:191], v[72:75]
    ds_read_b64_tr_b16 v[150:151], v230 offset:4096
    v_mfma_f32_16x16x32_bf16 v[40:43], v[200:203], v[184:187], v[40:43]
    ds_read_b64_tr_b16 v[152:153], v231 offset:0
    v_mfma_f32_16x16x32_bf16 v[8:11], v[200:203], v[180:183], v[8:11]
    ds_read_b64_tr_b16 v[154:155], v231 offset:4096
    v_mfma_f32_16x16x32_bf16 v[12:15], v[204:207], v[180:183], v[12:15]
    ds_read_b64_tr_b16 v[156:157], v232 offset:0
    v_mfma_f32_16x16x32_bf16 v[44:47], v[204:207], v[184:187], v[44:47]
    ds_read_b64_tr_b16 v[158:159], v232 offset:4096
    v_mfma_f32_16x16x32_bf16 v[76:79], v[204:207], v[188:191], v[76:79]
    ds_read_b64_tr_b16 v[160:161], v233 offset:0
    v_mfma_f32_16x16x32_bf16 v[108:111], v[204:207], v[192:195], v[108:111]
    ds_read_b64_tr_b16 v[162:163], v233 offset:4096
    v_mfma_f32_16x16x32_bf16 v[112:115], v[208:211], v[192:195], v[112:115]
    ds_read_b64_tr_b16 v[164:165], v234 offset:0
    v_mfma_f32_16x16x32_bf16 v[80:83], v[208:211], v[188:191], v[80:83]
    ds_read_b64_tr_b16 v[166:167], v234 offset:4096
    v_mfma_f32_16x16x32_bf16 v[48:51], v[208:211], v[184:187], v[48:51]
    ds_read_b64_tr_b16 v[168:169], v235 offset:0
    v_mfma_f32_16x16x32_bf16 v[16:19], v[208:211], v[180:183], v[16:19]
    ds_read_b64_tr_b16 v[170:171], v235 offset:4096
    v_mfma_f32_16x16x32_bf16 v[20:23], v[212:215], v[180:183], v[20:23]
    ds_read_b64_tr_b16 v[172:173], v236 offset:0
    v_mfma_f32_16x16x32_bf16 v[52:55], v[212:215], v[184:187], v[52:55]
    ds_read_b64_tr_b16 v[174:175], v236 offset:4096
    v_mfma_f32_16x16x32_bf16 v[84:87], v[212:215], v[188:191], v[84:87]
    ds_read_b64_tr_b16 v[176:177], v237 offset:0
    v_mfma_f32_16x16x32_bf16 v[116:119], v[212:215], v[192:195], v[116:119]
    ds_read_b64_tr_b16 v[178:179], v237 offset:4096
    v_mfma_f32_16x16x32_bf16 v[120:123], v[216:219], v[192:195], v[120:123]
    v_mfma_f32_16x16x32_bf16 v[88:91], v[216:219], v[188:191], v[88:91]
    v_mfma_f32_16x16x32_bf16 v[56:59], v[216:219], v[184:187], v[56:59]
    v_mfma_f32_16x16x32_bf16 v[24:27], v[216:219], v[180:183], v[24:27]
    v_mfma_f32_16x16x32_bf16 v[28:31], v[220:223], v[180:183], v[28:31]
    v_mfma_f32_16x16x32_bf16 v[60:63], v[220:223], v[184:187], v[60:63]
    v_mfma_f32_16x16x32_bf16 v[92:95], v[220:223], v[188:191], v[92:95]
    v_mfma_f32_16x16x32_bf16 v[124:127], v[220:223], v[192:195], v[124:127]
    v_mfma_f32_16x16x32_bf16 v[128:131], v[224:227], v[192:195], v[128:131]
    v_mfma_f32_16x16x32_bf16 v[96:99], v[224:227], v[188:191], v[96:99]
    v_mfma_f32_16x16x32_bf16 v[64:67], v[224:227], v[184:187], v[64:67]
    v_mfma_f32_16x16x32_bf16 v[32:35], v[224:227], v[180:183], v[32:35]
    s_mov_b32 s59, 13
K1_loop_7:
    s_waitcnt lgkmcnt(0)
    v_mfma_f32_16x16x32_bf16 v[4:7], v[148:151], v[132:135], v[4:7]
    ds_read_b128 v[180:183], v228 offset:16384
    v_mfma_f32_16x16x32_bf16 v[36:39], v[148:151], v[136:139], v[36:39]
    ds_read_b128 v[184:187], v228 offset:17408
    v_mfma_f32_16x16x32_bf16 v[68:71], v[148:151], v[140:143], v[68:71]
    ds_read_b128 v[188:191], v228 offset:18432
    v_mfma_f32_16x16x32_bf16 v[100:103], v[148:151], v[144:147], v[100:103]
    ds_read_b128 v[192:195], v228 offset:19456
    v_mfma_f32_16x16x32_bf16 v[104:107], v[152:155], v[144:147], v[104:107]
    ds_read_b64_tr_b16 v[196:197], v230 offset:8192
    v_mfma_f32_16x16x32_bf16 v[72:75], v[152:155], v[140:143], v[72:75]
    ds_read_b64_tr_b16 v[198:199], v230 offset:12288
    v_mfma_f32_16x16x32_bf16 v[40:43], v[152:155], v[136:139], v[40:43]
    ds_read_b64_tr_b16 v[200:201], v231 offset:8192
    v_mfma_f32_16x16x32_bf16 v[8:11], v[152:155], v[132:135], v[8:11]
    ds_read_b64_tr_b16 v[202:203], v231 offset:12288
    v_mfma_f32_16x16x32_bf16 v[12:15], v[156:159], v[132:135], v[12:15]
    ds_read_b64_tr_b16 v[204:205], v232 offset:8192
    v_mfma_f32_16x16x32_bf16 v[44:47], v[156:159], v[136:139], v[44:47]
    ds_read_b64_tr_b16 v[206:207], v232 offset:12288
    v_mfma_f32_16x16x32_bf16 v[76:79], v[156:159], v[140:143], v[76:79]
    ds_read_b64_tr_b16 v[208:209], v233 offset:8192
    v_mfma_f32_16x16x32_bf16 v[108:111], v[156:159], v[144:147], v[108:111]
    ds_read_b64_tr_b16 v[210:211], v233 offset:12288
    v_mfma_f32_16x16x32_bf16 v[112:115], v[160:163], v[144:147], v[112:115]
    ds_read_b64_tr_b16 v[212:213], v234 offset:8192
    v_mfma_f32_16x16x32_bf16 v[80:83], v[160:163], v[140:143], v[80:83]
    ds_read_b64_tr_b16 v[214:215], v234 offset:12288
    v_mfma_f32_16x16x32_bf16 v[48:51], v[160:163], v[136:139], v[48:51]
    ds_read_b64_tr_b16 v[216:217], v235 offset:8192
    v_mfma_f32_16x16x32_bf16 v[16:19], v[160:163], v[132:135], v[16:19]
    ds_read_b64_tr_b16 v[218:219], v235 offset:12288
    v_mfma_f32_16x16x32_bf16 v[20:23], v[164:167], v[132:135], v[20:23]
    ds_read_b64_tr_b16 v[220:221], v236 offset:8192
    v_mfma_f32_16x16x32_bf16 v[52:55], v[164:167], v[136:139], v[52:55]
    ds_read_b64_tr_b16 v[222:223], v236 offset:12288
    v_mfma_f32_16x16x32_bf16 v[84:87], v[164:167], v[140:143], v[84:87]
    ds_read_b64_tr_b16 v[224:225], v237 offset:8192
    v_mfma_f32_16x16x32_bf16 v[116:119], v[164:167], v[144:147], v[116:119]
    ds_read_b64_tr_b16 v[226:227], v237 offset:12288
    v_mfma_f32_16x16x32_bf16 v[120:123], v[168:171], v[144:147], v[120:123]
    s_add_u32 s54, s54, 32768
    s_cmp_eq_u32 s54, 98304
    s_cselect_b32 s56, 4294901760, s57
    s_cselect_b32 s54, 0, s54
    s_ashr_i32 s73, s56, 1
    v_mfma_f32_16x16x32_bf16 v[88:91], v[168:171], v[140:143], v[88:91]
    v_add_u32 v228, s56, v228
    v_mfma_f32_16x16x32_bf16 v[56:59], v[168:171], v[136:139], v[56:59]
    v_add_u32 v230, s73, v230
    v_mfma_f32_16x16x32_bf16 v[24:27], v[168:171], v[132:135], v[24:27]
    v_add_u32 v231, s73, v231
    v_mfma_f32_16x16x32_bf16 v[28:31], v[172:175], v[132:135], v[28:31]
    v_add_u32 v232, s73, v232
    v_mfma_f32_16x16x32_bf16 v[60:63], v[172:175], v[136:139], v[60:63]
    v_add_u32 v233, s73, v233
    v_mfma_f32_16x16x32_bf16 v[92:95], v[172:175], v[140:143], v[92:95]
    v_add_u32 v234, s73, v234
    v_mfma_f32_16x16x32_bf16 v[124:127], v[172:175], v[144:147], v[124:127]
    v_add_u32 v235, s73, v235
    v_mfma_f32_16x16x32_bf16 v[128:131], v[176:179], v[144:147], v[128:131]
    v_add_u32 v236, s73, v236
    v_mfma_f32_16x16x32_bf16 v[96:99], v[176:179], v[140:143], v[96:99]
    v_add_u32 v237, s73, v237
    v_mfma_f32_16x16x32_bf16 v[64:67], v[176:179], v[136:139], v[64:67]
    v_mfma_f32_16x16x32_bf16 v[32:35], v[176:179], v[132:135], v[32:35]
    s_waitcnt lgkmcnt(0)
    s_barrier
    v_mfma_f32_16x16x32_bf16 v[4:7], v[196:199], v[180:183], v[4:7]
    ds_read_b128 v[132:135], v228 offset:0
    v_mfma_f32_16x16x32_bf16 v[36:39], v[196:199], v[184:187], v[36:39]
    ds_read_b128 v[136:139], v228 offset:1024
    v_mfma_f32_16x16x32_bf16 v[68:71], v[196:199], v[188:191], v[68:71]
    ds_read_b128 v[140:143], v228 offset:2048
    v_mfma_f32_16x16x32_bf16 v[100:103], v[196:199], v[192:195], v[100:103]
    ds_read_b128 v[144:147], v228 offset:3072
    v_mfma_f32_16x16x32_bf16 v[104:107], v[200:203], v[192:195], v[104:107]
    ds_read_b64_tr_b16 v[148:149], v230 offset:0
    v_mfma_f32_16x16x32_bf16 v[72:75], v[200:203], v[188:191], v[72:75]
    ds_read_b64_tr_b16 v[150:151], v230 offset:4096
    v_mfma_f32_16x16x32_bf16 v[40:43], v[200:203], v[184:187], v[40:43]
    ds_read_b64_tr_b16 v[152:153], v231 offset:0
    v_mfma_f32_16x16x32_bf16 v[8:11], v[200:203], v[180:183], v[8:11]
    ds_read_b64_tr_b16 v[154:155], v231 offset:4096
    v_mfma_f32_16x16x32_bf16 v[12:15], v[204:207], v[180:183], v[12:15]
    ds_read_b64_tr_b16 v[156:157], v232 offset:0
    v_mfma_f32_16x16x32_bf16 v[44:47], v[204:207], v[184:187], v[44:47]
    ds_read_b64_tr_b16 v[158:159], v232 offset:4096
    v_mfma_f32_16x16x32_bf16 v[76:79], v[204:207], v[188:191], v[76:79]
    ds_read_b64_tr_b16 v[160:161], v233 offset:0
    v_mfma_f32_16x16x32_bf16 v[108:111], v[204:207], v[192:195], v[108:111]
    ds_read_b64_tr_b16 v[162:163], v233 offset:4096
    v_mfma_f32_16x16x32_bf16 v[112:115], v[208:211], v[192:195], v[112:115]
    ds_read_b64_tr_b16 v[164:165], v234 offset:0
    v_mfma_f32_16x16x32_bf16 v[80:83], v[208:211], v[188:191], v[80:83]
    ds_read_b64_tr_b16 v[166:167], v234 offset:4096
    v_mfma_f32_16x16x32_bf16 v[48:51], v[208:211], v[184:187], v[48:51]
    ds_read_b64_tr_b16 v[168:169], v235 offset:0
    v_mfma_f32_16x16x32_bf16 v[16:19], v[208:211], v[180:183], v[16:19]
    ds_read_b64_tr_b16 v[170:171], v235 offset:4096
    v_mfma_f32_16x16x32_bf16 v[20:23], v[212:215], v[180:183], v[20:23]
    ds_read_b64_tr_b16 v[172:173], v236 offset:0
    v_mfma_f32_16x16x32_bf16 v[52:55], v[212:215], v[184:187], v[52:55]
    ds_read_b64_tr_b16 v[174:175], v236 offset:4096
    v_mfma_f32_16x16x32_bf16 v[84:87], v[212:215], v[188:191], v[84:87]
    ds_read_b64_tr_b16 v[176:177], v237 offset:0
    v_mfma_f32_16x16x32_bf16 v[116:119], v[212:215], v[192:195], v[116:119]
    ds_read_b64_tr_b16 v[178:179], v237 offset:4096
    v_mfma_f32_16x16x32_bf16 v[120:123], v[216:219], v[192:195], v[120:123]
    v_mfma_f32_16x16x32_bf16 v[88:91], v[216:219], v[188:191], v[88:91]
    v_mfma_f32_16x16x32_bf16 v[56:59], v[216:219], v[184:187], v[56:59]
    v_mfma_f32_16x16x32_bf16 v[24:27], v[216:219], v[180:183], v[24:27]
    v_mfma_f32_16x16x32_bf16 v[28:31], v[220:223], v[180:183], v[28:31]
    v_mfma_f32_16x16x32_bf16 v[60:63], v[220:223], v[184:187], v[60:63]
    v_mfma_f32_16x16x32_bf16 v[92:95], v[220:223], v[188:191], v[92:95]
    v_mfma_f32_16x16x32_bf16 v[124:127], v[220:223], v[192:195], v[124:127]
    v_mfma_f32_16x16x32_bf16 v[128:131], v[224:227], v[192:195], v[128:131]
    v_mfma_f32_16x16x32_bf16 v[96:99], v[224:227], v[188:191], v[96:99]
    v_mfma_f32_16x16x32_bf16 v[64:67], v[224:227], v[184:187], v[64:67]
    v_mfma_f32_16x16x32_bf16 v[32:35], v[224:227], v[180:183], v[32:35]
    s_sub_u32 s59, s59, 1
    s_cmp_lg_u32 s59, 0
    s_cbranch_scc1 K1_loop_7
    s_waitcnt lgkmcnt(0)
    v_mfma_f32_16x16x32_bf16 v[4:7], v[148:151], v[132:135], v[4:7]
    ds_read_b128 v[180:183], v228 offset:16384
    v_mfma_f32_16x16x32_bf16 v[36:39], v[148:151], v[136:139], v[36:39]
    ds_read_b128 v[184:187], v228 offset:17408
    v_mfma_f32_16x16x32_bf16 v[68:71], v[148:151], v[140:143], v[68:71]
    ds_read_b128 v[188:191], v228 offset:18432
    v_mfma_f32_16x16x32_bf16 v[100:103], v[148:151], v[144:147], v[100:103]
    ds_read_b128 v[192:195], v228 offset:19456
    v_mfma_f32_16x16x32_bf16 v[104:107], v[152:155], v[144:147], v[104:107]
    ds_read_b64_tr_b16 v[196:197], v230 offset:8192
    v_mfma_f32_16x16x32_bf16 v[72:75], v[152:155], v[140:143], v[72:75]
    ds_read_b64_tr_b16 v[198:199], v230 offset:12288
    v_mfma_f32_16x16x32_bf16 v[40:43], v[152:155], v[136:139], v[40:43]
    ds_read_b64_tr_b16 v[200:201], v231 offset:8192
    v_mfma_f32_16x16x32_bf16 v[8:11], v[152:155], v[132:135], v[8:11]
    ds_read_b64_tr_b16 v[202:203], v231 offset:12288
    v_mfma_f32_16x16x32_bf16 v[12:15], v[156:159], v[132:135], v[12:15]
    ds_read_b64_tr_b16 v[204:205], v232 offset:8192
    v_mfma_f32_16x16x32_bf16 v[44:47], v[156:159], v[136:139], v[44:47]
    ds_read_b64_tr_b16 v[206:207], v232 offset:12288
    v_mfma_f32_16x16x32_bf16 v[76:79], v[156:159], v[140:143], v[76:79]
    ds_read_b64_tr_b16 v[208:209], v233 offset:8192
    v_mfma_f32_16x16x32_bf16 v[108:111], v[156:159], v[144:147], v[108:111]
    ds_read_b64_tr_b16 v[210:211], v233 offset:12288
    v_mfma_f32_16x16x32_bf16 v[112:115], v[160:163], v[144:147], v[112:115]
    ds_read_b64_tr_b16 v[212:213], v234 offset:8192
    v_mfma_f32_16x16x32_bf16 v[80:83], v[160:163], v[140:143], v[80:83]
    ds_read_b64_tr_b16 v[214:215], v234 offset:12288
    v_mfma_f32_16x16x32_bf16 v[48:51], v[160:163], v[136:139], v[48:51]
    ds_read_b64_tr_b16 v[216:217], v235 offset:8192
    v_mfma_f32_16x16x32_bf16 v[16:19], v[160:163], v[132:135], v[16:19]
    ds_read_b64_tr_b16 v[218:219], v235 offset:12288
    v_mfma_f32_16x16x32_bf16 v[20:23], v[164:167], v[132:135], v[20:23]
    ds_read_b64_tr_b16 v[220:221], v236 offset:8192
    v_mfma_f32_16x16x32_bf16 v[52:55], v[164:167], v[136:139], v[52:55]
    ds_read_b64_tr_b16 v[222:223], v236 offset:12288
    v_mfma_f32_16x16x32_bf16 v[84:87], v[164:167], v[140:143], v[84:87]
    ds_read_b64_tr_b16 v[224:225], v237 offset:8192
    v_mfma_f32_16x16x32_bf16 v[116:119], v[164:167], v[144:147], v[116:119]
    ds_read_b64_tr_b16 v[226:227], v237 offset:12288
    v_mfma_f32_16x16x32_bf16 v[120:123], v[168:171], v[144:147], v[120:123]
    s_add_u32 s54, s54, 32768
    s_cmp_eq_u32 s54, 98304
    s_cselect_b32 s56, 4294901760, s57
    s_cselect_b32 s54, 0, s54
    s_ashr_i32 s73, s56, 1
    v_mfma_f32_16x16x32_bf16 v[88:91], v[168:171], v[140:143], v[88:91]
    v_add_u32 v228, s56, v228
    v_mfma_f32_16x16x32_bf16 v[56:59], v[168:171], v[136:139], v[56:59]
    v_add_u32 v230, s73, v230
    v_mfma_f32_16x16x32_bf16 v[24:27], v[168:171], v[132:135], v[24:27]
    v_add_u32 v231, s73, v231
    v_mfma_f32_16x16x32_bf16 v[28:31], v[172:175], v[132:135], v[28:31]
    v_add_u32 v232, s73, v232
    v_mfma_f32_16x16x32_bf16 v[60:63], v[172:175], v[136:139], v[60:63]
    v_add_u32 v233, s73, v233
    v_mfma_f32_16x16x32_bf16 v[92:95], v[172:175], v[140:143], v[92:95]
    v_add_u32 v234, s73, v234
    v_mfma_f32_16x16x32_bf16 v[124:127], v[172:175], v[144:147], v[124:127]
    v_add_u32 v235, s73, v235
    v_mfma_f32_16x16x32_bf16 v[128:131], v[176:179], v[144:147], v[128:131]
    v_add_u32 v236, s73, v236
    v_mfma_f32_16x16x32_bf16 v[96:99], v[176:179], v[140:143], v[96:99]
    v_add_u32 v237, s73, v237
    v_mfma_f32_16x16x32_bf16 v[64:67], v[176:179], v[136:139], v[64:67]
    v_mfma_f32_16x16x32_bf16 v[32:35], v[176:179], v[132:135], v[32:35]
    s_waitcnt lgkmcnt(0)
    s_barrier
    v_mfma_f32_16x16x32_bf16 v[4:7], v[196:199], v[180:183], v[4:7]
    ds_read_b64 v[132:133], v228 offset:0
    v_mfma_f32_16x16x32_bf16 v[36:39], v[196:199], v[184:187], v[36:39]
    ds_read_b64 v[134:135], v228 offset:1024
    v_mfma_f32_16x16x32_bf16 v[68:71], v[196:199], v[188:191], v[68:71]
    ds_read_b64 v[136:137], v228 offset:8
    v_mfma_f32_16x16x32_bf16 v[100:103], v[196:199], v[192:195], v[100:103]
    ds_read_b64 v[138:139], v228 offset:1032
    v_mfma_f32_16x16x32_bf16 v[104:107], v[200:203], v[192:195], v[104:107]
    ds_read_b64 v[140:141], v228 offset:2048
    v_mfma_f32_16x16x32_bf16 v[72:75], v[200:203], v[188:191], v[72:75]
    ds_read_b64 v[142:143], v228 offset:3072
    v_mfma_f32_16x16x32_bf16 v[40:43], v[200:203], v[184:187], v[40:43]
    ds_read_b64 v[144:145], v228 offset:2056
    v_mfma_f32_16x16x32_bf16 v[8:11], v[200:203], v[180:183], v[8:11]
    ds_read_b64 v[146:147], v228 offset:3080
    v_mfma_f32_16x16x32_bf16 v[12:15], v[204:207], v[180:183], v[12:15]
    ds_read_b64_tr_b16 v[148:149], v230 offset:0
    v_mfma_f32_16x16x32_bf16 v[44:47], v[204:207], v[184:187], v[44:47]
    ds_read_b64_tr_b16 v[150:151], v230 offset:4096
    v_mfma_f32_16x16x32_bf16 v[76:79], v[204:207], v[188:191], v[76:79]
    ds_read_b64_tr_b16 v[152:153], v231 offset:0
    v_mfma_f32_16x16x32_bf16 v[108:111], v[204:207], v[192:195], v[108:111]
    ds_read_b64_tr_b16 v[154:155], v231 offset:4096
    v_mfma_f32_16x16x32_bf16 v[112:115], v[208:211], v[192:195], v[112:115]
    ds_read_b64_tr_b16 v[156:157], v232 offset:0
    v_mfma_f32_16x16x32_bf16 v[80:83], v[208:211], v[188:191], v[80:83]
    ds_read_b64_tr_b16 v[158:159], v232 offset:4096
    v_mfma_f32_16x16x32_bf16 v[48:51], v[208:211], v[184:187], v[48:51]
    ds_read_b64_tr_b16 v[160:161], v233 offset:0
    v_mfma_f32_16x16x32_bf16 v[16:19], v[208:211], v[180:183], v[16:19]
    ds_read_b64_tr_b16 v[162:163], v233 offset:4096
    v_mfma_f32_16x16x32_bf16 v[20:23], v[212:215], v[180:183], v[20:23]
    ds_read_b64_tr_b16 v[164:165], v234 offset:0
    v_mfma_f32_16x16x32_bf16 v[52:55], v[212:215], v[184:187], v[52:55]
    ds_read_b64_tr_b16 v[166:167], v234 offset:4096
    v_mfma_f32_16x16x32_bf16 v[84:87], v[212:215], v[188:191], v[84:87]
    ds_read_b64_tr_b16 v[168:169], v235 offset:0
    v_mfma_f32_16x16x32_bf16 v[116:119], v[212:215], v[192:195], v[116:119]
    ds_read_b64_tr_b16 v[170:171], v235 offset:4096
    v_mfma_f32_16x16x32_bf16 v[120:123], v[216:219], v[192:195], v[120:123]
    ds_read_b64_tr_b16 v[172:173], v236 offset:0
    v_mfma_f32_16x16x32_bf16 v[88:91], v[216:219], v[188:191], v[88:91]
    ds_read_b64_tr_b16 v[174:175], v236 offset:4096
    v_mfma_f32_16x16x32_bf16 v[56:59], v[216:219], v[184:187], v[56:59]
    ds_read_b64_tr_b16 v[176:177], v237 offset:0
    v_mfma_f32_16x16x32_bf16 v[24:27], v[216:219], v[180:183], v[24:27]
    ds_read_b64_tr_b16 v[178:179], v237 offset:4096
    v_mfma_f32_16x16x32_bf16 v[28:31], v[220:223], v[180:183], v[28:31]
    v_mfma_f32_16x16x32_bf16 v[60:63], v[220:223], v[184:187], v[60:63]
    v_mfma_f32_16x16x32_bf16 v[92:95], v[220:223], v[188:191], v[92:95]
    v_mfma_f32_16x16x32_bf16 v[124:127], v[220:223], v[192:195], v[124:127]
    v_mfma_f32_16x16x32_bf16 v[128:131], v[224:227], v[192:195], v[128:131]
    v_mfma_f32_16x16x32_bf16 v[96:99], v[224:227], v[188:191], v[96:99]
    v_mfma_f32_16x16x32_bf16 v[64:67], v[224:227], v[184:187], v[64:67]
    v_mfma_f32_16x16x32_bf16 v[32:35], v[224:227], v[180:183], v[32:35]
    s_mov_b32 s59, 7
K1_loop_8:
    s_waitcnt lgkmcnt(0)
    v_mfma_f32_16x16x32_bf16 v[4:7], v[148:151], v[132:135], v[4:7]
    ds_read_b64 v[180:181], v228 offset:16384
    v_mfma_f32_16x16x32_bf16 v[36:39], v[148:151], v[136:139], v[36:39]
    ds_read_b64 v[182:183], v228 offset:17408
    v_mfma_f32_16x16x32_bf16 v[68:71], v[148:151], v[140:143], v[68:71]
    ds_read_b64 v[184:185], v228 offset:16392
    v_mfma_f32_16x16x32_bf16 v[100:103], v[148:151], v[144:147], v[100:103]
    ds_read_b64 v[186:187], v228 offset:17416
    v_mfma_f32_16x16x32_bf16 v[104:107], v[152:155], v[144:147], v[104:107]
    ds_read_b64 v[188:189], v228 offset:18432
    v_mfma_f32_16x16x32_bf16 v[72:75], v[152:155], v[140:143], v[72:75]
    ds_read_b64 v[190:191], v228 offset:19456
    v_mfma_f32_16x16x32_bf16 v[40:43], v[152:155], v[136:139], v[40:43]
    ds_read_b64 v[192:193], v228 offset:18440
    v_mfma_f32_16x16x32_bf16 v[8:11], v[152:155], v[132:135], v[8:11]
    ds_read_b64 v[194:195], v228 offset:19464
    v_mfma_f32_16x16x32_bf16 v[12:15], v[156:159], v[132:135], v[12:15]
    ds_read_b64_tr_b16 v[196:197], v230 offset:8192
    v_mfma_f32_16x16x32_bf16 v[44:47], v[156:159], v[136:139], v[44:47]
    ds_read_b64_tr_b16 v[198:199], v230 offset:12288
    v_mfma_f32_16x16x32_bf16 v[76:79], v[156:159], v[140:143], v[76:79]
    ds_read_b64_tr_b16 v[200:201], v231 offset:8192
    v_mfma_f32_16x16x32_bf16 v[108:111], v[156:159], v[144:147], v[108:111]
    ds_read_b64_tr_b16 v[202:203], v231 offset:12288
    v_mfma_f32_16x16x32_bf16 v[112:115], v[160:163], v[144:147], v[112:115]
    ds_read_b64_tr_b16 v[204:205], v232 offset:8192
    v_mfma_f32_16x16x32_bf16 v[80:83], v[160:163], v[140:143], v[80:83]
    ds_read_b64_tr_b16 v[206:207], v232 offset:12288
    v_mfma_f32_16x16x32_bf16 v[48:51], v[160:163], v[136:139], v[48:51]
    ds_read_b64_tr_b16 v[208:209], v233 offset:8192
    v_mfma_f32_16x16x32_bf16 v[16:19], v[160:163], v[132:135], v[16:19]
    ds_read_b64_tr_b16 v[210:211], v233 offset:12288
    v_mfma_f32_16x16x32_bf16 v[20:23], v[164:167], v[132:135], v[20:23]
    ds_read_b64_tr_b16 v[212:213], v234 offset:8192
    v_mfma_f32_16x16x32_bf16 v[52:55], v[164:167], v[136:139], v[52:55]
    ds_read_b64_tr_b16 v[214:215], v234 offset:12288
    v_mfma_f32_16x16x32_bf16 v[84:87], v[164:167], v[140:143], v[84:87]
    ds_read_b64_tr_b16 v[216:217], v235 offset:8192
    v_mfma_f32_16x16x32_bf16 v[116:119], v[164:167], v[144:147], v[116:119]
    ds_read_b64_tr_b16 v[218:219], v235 offset:12288
    v_mfma_f32_16x16x32_bf16 v[120:123], v[168:171], v[144:147], v[120:123]
    ds_read_b64_tr_b16 v[220:221], v236 offset:8192
    v_mfma_f32_16x16x32_bf16 v[88:91], v[168:171], v[140:143], v[88:91]
    ds_read_b64_tr_b16 v[222:223], v236 offset:12288
    v_mfma_f32_16x16x32_bf16 v[56:59], v[168:171], v[136:139], v[56:59]
    ds_read_b64_tr_b16 v[224:225], v237 offset:8192
    v_mfma_f32_16x16x32_bf16 v[24:27], v[168:171], v[132:135], v[24:27]
    ds_read_b64_tr_b16 v[226:227], v237 offset:12288
    v_mfma_f32_16x16x32_bf16 v[28:31], v[172:175], v[132:135], v[28:31]
    s_add_u32 s54, s54, 32768
    s_cmp_eq_u32 s54, 98304
    s_cselect_b32 s56, 4294901760, s57
    s_cselect_b32 s54, 0, s54
    s_ashr_i32 s73, s56, 1
    v_mfma_f32_16x16x32_bf16 v[60:63], v[172:175], v[136:139], v[60:63]
    v_add_u32 v228, s56, v228
    v_mfma_f32_16x16x32_bf16 v[92:95], v[172:175], v[140:143], v[92:95]
    v_add_u32 v230, s73, v230
    v_mfma_f32_16x16x32_bf16 v[124:127], v[172:175], v[144:147], v[124:127]
    v_add_u32 v231, s73, v231
    v_mfma_f32_16x16x32_bf16 v[128:131], v[176:179], v[144:147], v[128:131]
    v_add_u32 v232, s73, v232
    v_mfma_f32_16x16x32_bf16 v[96:99], v[176:179], v[140:143], v[96:99]
    v_add_u32 v233, s73, v233
    v_mfma_f32_16x16x32_bf16 v[64:67], v[176:179], v[136:139], v[64:67]
    v_add_u32 v234, s73, v234
    v_mfma_f32_16x16x32_bf16 v[32:35], v[176:179], v[132:135], v[32:35]
    v_add_u32 v235, s73, v235
    v_add_u32 v236, s73, v236
    v_add_u32 v237, s73, v237
    s_waitcnt lgkmcnt(0)
    s_barrier
    v_mfma_f32_16x16x32_bf16 v[4:7], v[196:199], v[180:183], v[4:7]
    ds_read_b64 v[132:133], v228 offset:0
    v_mfma_f32_16x16x32_bf16 v[36:39], v[196:199], v[184:187], v[36:39]
    ds_read_b64 v[134:135], v228 offset:1024
    v_mfma_f32_16x16x32_bf16 v[68:71], v[196:199], v[188:191], v[68:71]
    ds_read_b64 v[136:137], v228 offset:8
    v_mfma_f32_16x16x32_bf16 v[100:103], v[196:199], v[192:195], v[100:103]
    ds_read_b64 v[138:139], v228 offset:1032
    v_mfma_f32_16x16x32_bf16 v[104:107], v[200:203], v[192:195], v[104:107]
    ds_read_b64 v[140:141], v228 offset:2048
    v_mfma_f32_16x16x32_bf16 v[72:75], v[200:203], v[188:191], v[72:75]
    ds_read_b64 v[142:143], v228 offset:3072
    v_mfma_f32_16x16x32_bf16 v[40:43], v[200:203], v[184:187], v[40:43]
    ds_read_b64 v[144:145], v228 offset:2056
    v_mfma_f32_16x16x32_bf16 v[8:11], v[200:203], v[180:183], v[8:11]
    ds_read_b64 v[146:147], v228 offset:3080
    v_mfma_f32_16x16x32_bf16 v[12:15], v[204:207], v[180:183], v[12:15]
    ds_read_b64_tr_b16 v[148:149], v230 offset:0
    v_mfma_f32_16x16x32_bf16 v[44:47], v[204:207], v[184:187], v[44:47]
    ds_read_b64_tr_b16 v[150:151], v230 offset:4096
    v_mfma_f32_16x16x32_bf16 v[76:79], v[204:207], v[188:191], v[76:79]
    ds_read_b64_tr_b16 v[152:153], v231 offset:0
    v_mfma_f32_16x16x32_bf16 v[108:111], v[204:207], v[192:195], v[108:111]
    ds_read_b64_tr_b16 v[154:155], v231 offset:4096
    v_mfma_f32_16x16x32_bf16 v[112:115], v[208:211], v[192:195], v[112:115]
    ds_read_b64_tr_b16 v[156:157], v232 offset:0
    v_mfma_f32_16x16x32_bf16 v[80:83], v[208:211], v[188:191], v[80:83]
    ds_read_b64_tr_b16 v[158:159], v232 offset:4096
    v_mfma_f32_16x16x32_bf16 v[48:51], v[208:211], v[184:187], v[48:51]
    ds_read_b64_tr_b16 v[160:161], v233 offset:0
    v_mfma_f32_16x16x32_bf16 v[16:19], v[208:211], v[180:183], v[16:19]
    ds_read_b64_tr_b16 v[162:163], v233 offset:4096
    v_mfma_f32_16x16x32_bf16 v[20:23], v[212:215], v[180:183], v[20:23]
    ds_read_b64_tr_b16 v[164:165], v234 offset:0
    v_mfma_f32_16x16x32_bf16 v[52:55], v[212:215], v[184:187], v[52:55]
    ds_read_b64_tr_b16 v[166:167], v234 offset:4096
    v_mfma_f32_16x16x32_bf16 v[84:87], v[212:215], v[188:191], v[84:87]
    ds_read_b64_tr_b16 v[168:169], v235 offset:0
    v_mfma_f32_16x16x32_bf16 v[116:119], v[212:215], v[192:195], v[116:119]
    ds_read_b64_tr_b16 v[170:171], v235 offset:4096
    v_mfma_f32_16x16x32_bf16 v[120:123], v[216:219], v[192:195], v[120:123]
    ds_read_b64_tr_b16 v[172:173], v236 offset:0
    v_mfma_f32_16x16x32_bf16 v[88:91], v[216:219], v[188:191], v[88:91]
    ds_read_b64_tr_b16 v[174:175], v236 offset:4096
    v_mfma_f32_16x16x32_bf16 v[56:59], v[216:219], v[184:187], v[56:59]
    ds_read_b64_tr_b16 v[176:177], v237 offset:0
    v_mfma_f32_16x16x32_bf16 v[24:27], v[216:219], v[180:183], v[24:27]
    ds_read_b64_tr_b16 v[178:179], v237 offset:4096
    v_mfma_f32_16x16x32_bf16 v[28:31], v[220:223], v[180:183], v[28:31]
    v_mfma_f32_16x16x32_bf16 v[60:63], v[220:223], v[184:187], v[60:63]
    v_mfma_f32_16x16x32_bf16 v[92:95], v[220:223], v[188:191], v[92:95]
    v_mfma_f32_16x16x32_bf16 v[124:127], v[220:223], v[192:195], v[124:127]
    v_mfma_f32_16x16x32_bf16 v[128:131], v[224:227], v[192:195], v[128:131]
    v_mfma_f32_16x16x32_bf16 v[96:99], v[224:227], v[188:191], v[96:99]
    v_mfma_f32_16x16x32_bf16 v[64:67], v[224:227], v[184:187], v[64:67]
    v_mfma_f32_16x16x32_bf16 v[32:35], v[224:227], v[180:183], v[32:35]
    s_sub_u32 s59, s59, 1
    s_cmp_lg_u32 s59, 0
    s_cbranch_scc1 K1_loop_8
    s_waitcnt lgkmcnt(0)
    v_mfma_f32_16x16x32_bf16 v[4:7], v[148:151], v[132:135], v[4:7]
    ds_read_b64 v[180:181], v228 offset:16384
    v_mfma_f32_16x16x32_bf16 v[36:39], v[148:151], v[136:139], v[36:39]
    ds_read_b64 v[182:183], v228 offset:17408
    v_mfma_f32_16x16x32_bf16 v[68:71], v[148:151], v[140:143], v[68:71]
    ds_read_b64 v[184:185], v228 offset:16392
    v_mfma_f32_16x16x32_bf16 v[100:103], v[148:151], v[144:147], v[100:103]
    ds_read_b64 v[186:187], v228 offset:17416
    v_mfma_f32_16x16x32_bf16 v[104:107], v[152:155], v[144:147], v[104:107]
    ds_read_b64 v[188:189], v228 offset:18432
    v_mfma_f32_16x16x32_bf16 v[72:75], v[152:155], v[140:143], v[72:75]
    ds_read_b64 v[190:191], v228 offset:19456
    v_mfma_f32_16x16x32_bf16 v[40:43], v[152:155], v[136:139], v[40:43]
    ds_read_b64 v[192:193], v228 offset:18440
    v_mfma_f32_16x16x32_bf16 v[8:11], v[152:155], v[132:135], v[8:11]
    ds_read_b64 v[194:195], v228 offset:19464
    v_mfma_f32_16x16x32_bf16 v[12:15], v[156:159], v[132:135], v[12:15]
    ds_read_b64_tr_b16 v[196:197], v230 offset:8192
    v_mfma_f32_16x16x32_bf16 v[44:47], v[156:159], v[136:139], v[44:47]
    ds_read_b64_tr_b16 v[198:199], v230 offset:12288
    v_mfma_f32_16x16x32_bf16 v[76:79], v[156:159], v[140:143], v[76:79]
    ds_read_b64_tr_b16 v[200:201], v231 offset:8192
    v_mfma_f32_16x16x32_bf16 v[108:111], v[156:159], v[144:147], v[108:111]
    ds_read_b64_tr_b16 v[202:203], v231 offset:12288
    v_mfma_f32_16x16x32_bf16 v[112:115], v[160:163], v[144:147], v[112:115]
    ds_read_b64_tr_b16 v[204:205], v232 offset:8192
    v_mfma_f32_16x16x32_bf16 v[80:83], v[160:163], v[140:143], v[80:83]
    ds_read_b64_tr_b16 v[206:207], v232 offset:12288
    v_mfma_f32_16x16x32_bf16 v[48:51], v[160:163], v[136:139], v[48:51]
    ds_read_b64_tr_b16 v[208:209], v233 offset:8192
    v_mfma_f32_16x16x32_bf16 v[16:19], v[160:163], v[132:135], v[16:19]
    ds_read_b64_tr_b16 v[210:211], v233 offset:12288
    v_mfma_f32_16x16x32_bf16 v[20:23], v[164:167], v[132:135], v[20:23]
    ds_read_b64_tr_b16 v[212:213], v234 offset:8192
    v_mfma_f32_16x16x32_bf16 v[52:55], v[164:167], v[136:139], v[52:55]
    ds_read_b64_tr_b16 v[214:215], v234 offset:12288
    v_mfma_f32_16x16x32_bf16 v[84:87], v[164:167], v[140:143], v[84:87]
    ds_read_b64_tr_b16 v[216:217], v235 offset:8192
    v_mfma_f32_16x16x32_bf16 v[116:119], v[164:167], v[144:147], v[116:119]
    ds_read_b64_tr_b16 v[218:219], v235 offset:12288
    v_mfma_f32_16x16x32_bf16 v[120:123], v[168:171], v[144:147], v[120:123]
    ds_read_b64_tr_b16 v[220:221], v236 offset:8192
    v_mfma_f32_16x16x32_bf16 v[88:91], v[168:171], v[140:143], v[88:91]
    ds_read_b64_tr_b16 v[222:223], v236 offset:12288
    v_mfma_f32_16x16x32_bf16 v[56:59], v[168:171], v[136:139], v[56:59]
    ds_read_b64_tr_b16 v[224:225], v237 offset:8192
    v_mfma_f32_16x16x32_bf16 v[24:27], v[168:171], v[132:135], v[24:27]
    ds_read_b64_tr_b16 v[226:227], v237 offset:12288
    v_mfma_f32_16x16x32_bf16 v[28:31], v[172:175], v[132:135], v[28:31]
    s_cmp_lt_u32 s32, s33
    s_subb_u32 s69, s33, 0
    s_lshl_b32 s58, s36, 2
    s_add_u32 s58, s58, s32
    s_lshl_b32 s55, s58, 7
    s_add_u32 s55, s55, s69
    s_lshl_b32 s55, s55, 2
    s_add_u32 s55, s55, 49283072
    s_lshl_b32 s58, s58, 2
    s_add_u32 s58, s58, s69
    s_lshl_b32 s58, s58, 14
    s_add_u32 s58, s58, 27262976
    s_mov_b32 s59, 0
    s_cmp_eq_u32 s32, s33
    s_cselect_b32 s58, 0x20000000, s58
    s_cselect_b32 s55, 0x20000000, s55
    s_cselect_b32 s69, s59, 98304
    v_add_u32 v251, s69, v241
    v_mfma_f32_16x16x32_bf16 v[60:63], v[172:175], v[136:139], v[60:63]
    v_mov_b32 v244, 1
    v_mov_b32 v239, 0
    v_mfma_f32_16x16x32_bf16 v[92:95], v[172:175], v[140:143], v[92:95]
    s_xor_b32 s71, s32, 4
    s_lshr_b32 s71, s71, 1
    s_and_b32 s72, s32, 1
    s_lshl_b32 s68, s34, 8
    s_lshl_b32 s69, s33, 6
    s_add_u32 s68, s68, s69
    s_lshl_b32 s69, s72, 2
    s_add_u32 s68, s68, s69
    v_and_b32 v252, 15, v1
    v_mfma_f32_16x16x32_bf16 v[124:127], v[172:175], v[144:147], v[124:127]
    v_lshrrev_b32 v248, 2, v252
    v_lshlrev_b32 v248, 4, v248
    v_mfma_f32_16x16x32_bf16 v[128:131], v[176:179], v[144:147], v[128:131]
    v_and_b32 v253, 1, v252
    v_lshl_add_u32 v248, v253, 3, v248
    v_mfma_f32_16x16x32_bf16 v[96:99], v[176:179], v[140:143], v[96:99]
    v_bfe_u32 v253, v252, 1, 1
    v_add_u32 v248, v248, v253
    v_mfma_f32_16x16x32_bf16 v[64:67], v[176:179], v[136:139], v[64:67]
    v_add_u32 v248, s68, v248
    s_lshl_b32 s68, s35, 7
    s_lshl_b32 s69, s71, 5
    s_add_u32 s68, s68, s69
    v_lshrrev_b32 v252, 4, v1
    v_mfma_f32_16x16x32_bf16 v[32:35], v[176:179], v[132:135], v[32:35]
    v_lshl_add_u32 v252, v252, 2, s68
    v_lshlrev_b32 v253, 4, v248
    v_lshlrev_b32 v249, 12, v248
    v_lshl_add_u32 v249, v252, 2, v249
    v_lshrrev_b32 v248, 1, v249
    v_lshlrev_b32 v252, 1, v252
    s_mov_b32 s60, 0
    s_mov_b32 s61, 4096
    s_mov_b32 s62, 8192
    s_mov_b32 s63, 0
    s_mov_b32 s68, 48234496
    s_waitcnt lgkmcnt(0)
    s_barrier
    s_branch K2_last1
K2_last1:
    v_mfma_f32_16x16x32_bf16 v[4:7], v[196:199], v[180:183], v[4:7]
    buffer_load_dwordx2 v[148:149], v253, s[8:11], s68 offen
    v_mfma_f32_16x16x32_bf16 v[36:39], v[196:199], v[184:187], v[36:39]
    buffer_load_dwordx2 v[150:151], v253, s[8:11], s68 offen offset:32
    v_mfma_f32_16x16x32_bf16 v[68:71], v[196:199], v[188:191], v[68:71]
    buffer_load_dwordx2 v[132:133], v248, s[24:27], s60 offen offset:0
    v_mfma_f32_16x16x32_bf16 v[100:103], v[196:199], v[192:195], v[100:103]
    buffer_load_dwordx2 v[134:135], v248, s[24:27], s61 offen offset:0
    v_mfma_f32_16x16x32_bf16 v[104:107], v[200:203], v[192:195], v[104:107]
    buffer_load_dwordx2 v[136:137], v248, s[24:27], s60 offen offset:32
    v_mfma_f32_16x16x32_bf16 v[72:75], v[200:203], v[188:191], v[72:75]
    buffer_load_dwordx2 v[138:139], v248, s[24:27], s61 offen offset:32
    v_mfma_f32_16x16x32_bf16 v[40:43], v[200:203], v[184:187], v[40:43]
    global_load_dwordx2 v[140:141], v252, s[42:43] offset:0
    v_mfma_f32_16x16x32_bf16 v[8:11], v[200:203], v[180:183], v[8:11]
    global_load_dwordx2 v[144:145], v252, s[40:41] offset:0
    v_mfma_f32_16x16x32_bf16 v[12:15], v[204:207], v[180:183], v[12:15]
    global_load_dwordx2 v[142:143], v252, s[42:43] offset:32
    global_load_dwordx2 v[146:147], v252, s[40:41] offset:32
    v_mfma_f32_16x16x32_bf16 v[44:47], v[204:207], v[184:187], v[44:47]
    v_mfma_f32_16x16x32_bf16 v[76:79], v[204:207], v[188:191], v[76:79]
    v_mfma_f32_16x16x32_bf16 v[108:111], v[204:207], v[192:195], v[108:111]
    v_mfma_f32_16x16x32_bf16 v[112:115], v[208:211], v[192:195], v[112:115]
    v_mfma_f32_16x16x32_bf16 v[80:83], v[208:211], v[188:191], v[80:83]
    v_cvt_pk_bf16_f32 v228, v4, v5
    v_cvt_pk_bf16_f32 v229, v6, v7
    v_cvt_pk_bf16_f32 v230, v36, v37
    v_cvt_pk_bf16_f32 v231, v38, v39
    buffer_store_dwordx4 v[228:231], v241, s[8:11], s58 offen offset:0 sc1
    ds_write_b128 v251, v[228:231] offset:0
    v_mfma_f32_16x16x32_bf16 v[48:51], v[208:211], v[184:187], v[48:51]
    v_mfma_f32_16x16x32_bf16 v[16:19], v[208:211], v[180:183], v[16:19]
    v_cvt_pk_bf16_f32 v232, v68, v69
    v_cvt_pk_bf16_f32 v233, v70, v71
    v_cvt_pk_bf16_f32 v234, v100, v101
    v_cvt_pk_bf16_f32 v235, v102, v103
    buffer_store_dwordx4 v[232:235], v241, s[8:11], s58 offen offset:1024 sc1
    ds_write_b128 v251, v[232:235] offset:1024
    v_mfma_f32_16x16x32_bf16 v[20:23], v[212:215], v[180:183], v[20:23]
    v_mfma_f32_16x16x32_bf16 v[52:55], v[212:215], v[184:187], v[52:55]
    v_cvt_pk_bf16_f32 v228, v8, v9
    v_cvt_pk_bf16_f32 v229, v10, v11
    v_cvt_pk_bf16_f32 v230, v40, v41
    v_cvt_pk_bf16_f32 v231, v42, v43
    buffer_store_dwordx4 v[228:231], v241, s[8:11], s58 offen offset:2048 sc1
    ds_write_b128 v251, v[228:231] offset:2048
    v_mfma_f32_16x16x32_bf16 v[84:87], v[212:215], v[188:191], v[84:87]
    v_mfma_f32_16x16x32_bf16 v[116:119], v[212:215], v[192:195], v[116:119]
    v_cvt_pk_bf16_f32 v232, v72, v73
    v_cvt_pk_bf16_f32 v233, v74, v75
    v_cvt_pk_bf16_f32 v234, v104, v105
    v_cvt_pk_bf16_f32 v235, v106, v107
    buffer_store_dwordx4 v[232:235], v241, s[8:11], s58 offen offset:3072 sc1
    ds_write_b128 v251, v[232:235] offset:3072
    s_add_u32 s58, s58, 4096
    v_mfma_f32_16x16x32_bf16 v[120:123], v[216:219], v[192:195], v[120:123]
    v_mfma_f32_16x16x32_bf16 v[88:91], v[216:219], v[188:191], v[88:91]
    v_cvt_pk_bf16_f32 v228, v12, v13
    v_cvt_pk_bf16_f32 v229, v14, v15
    v_cvt_pk_bf16_f32 v230, v44, v45
    v_cvt_pk_bf16_f32 v231, v46, v47
    buffer_store_dwordx4 v[228:231], v241, s[8:11], s58 offen offset:0 sc1
    ds_write_b128 v251, v[228:231] offset:4096
    v_mfma_f32_16x16x32_bf16 v[56:59], v[216:219], v[184:187], v[56:59]
    v_mfma_f32_16x16x32_bf16 v[24:27], v[216:219], v[180:183], v[24:27]
    v_cvt_pk_bf16_f32 v232, v76, v77
    v_cvt_pk_bf16_f32 v233, v78, v79
    v_cvt_pk_bf16_f32 v234, v108, v109
    v_cvt_pk_bf16_f32 v235, v110, v111
    buffer_store_dwordx4 v[232:235], v241, s[8:11], s58 offen offset:1024 sc1
    ds_write_b128 v251, v[232:235] offset:5120
    v_mfma_f32_16x16x32_bf16 v[28:31], v[220:223], v[180:183], v[28:31]
    v_mfma_f32_16x16x32_bf16 v[60:63], v[220:223], v[184:187], v[60:63]
    v_cvt_pk_bf16_f32 v228, v16, v17
    v_cvt_pk_bf16_f32 v229, v18, v19
    v_cvt_pk_bf16_f32 v230, v48, v49
    v_cvt_pk_bf16_f32 v231, v50, v51
    buffer_store_dwordx4 v[228:231], v241, s[8:11], s58 offen offset:2048 sc1
    ds_write_b128 v251, v[228:231] offset:6144
    v_mfma_f32_16x16x32_bf16 v[92:95], v[220:223], v[188:191], v[92:95]
    v_mfma_f32_16x16x32_bf16 v[124:127], v[220:223], v[192:195], v[124:127]
    v_cvt_pk_bf16_f32 v232, v80, v81
    v_cvt_pk_bf16_f32 v233, v82, v83
    v_cvt_pk_bf16_f32 v234, v112, v113
    v_cvt_pk_bf16_f32 v235, v114, v115
    buffer_store_dwordx4 v[232:235], v241, s[8:11], s58 offen offset:3072 sc1
    ds_write_b128 v251, v[232:235] offset:7168
    s_add_u32 s58, s58, 4096
    v_mfma_f32_16x16x32_bf16 v[128:131], v[224:227], v[192:195], v[128:131]
    v_mfma_f32_16x16x32_bf16 v[96:99], v[224:227], v[188:191], v[96:99]
    v_cvt_pk_bf16_f32 v228, v20, v21
    v_cvt_pk_bf16_f32 v229, v22, v23
    v_cvt_pk_bf16_f32 v230, v52, v53
    v_cvt_pk_bf16_f32 v231, v54, v55
    buffer_store_dwordx4 v[228:231], v241, s[8:11], s58 offen offset:0 sc1
    ds_write_b128 v251, v[228:231] offset:8192
    v_mfma_f32_16x16x32_bf16 v[64:67], v[224:227], v[184:187], v[64:67]
    v_mfma_f32_16x16x32_bf16 v[32:35], v[224:227], v[180:183], v[32:35]
    v_cvt_pk_bf16_f32 v232, v84, v85
    v_cvt_pk_bf16_f32 v233, v86, v87
    v_cvt_pk_bf16_f32 v234, v116, v117
    v_cvt_pk_bf16_f32 v235, v118, v119
    buffer_store_dwordx4 v[232:235], v241, s[8:11], s58 offen offset:1024 sc1
    ds_write_b128 v251, v[232:235] offset:9216
    v_cvt_pk_bf16_f32 v228, v24, v25
    v_cvt_pk_bf16_f32 v229, v26, v27
    v_cvt_pk_bf16_f32 v230, v56, v57
    v_cvt_pk_bf16_f32 v231, v58, v59
    buffer_store_dwordx4 v[228:231], v241, s[8:11], s58 offen offset:2048 sc1
    ds_write_b128 v251, v[228:231] offset:10240
    v_cvt_pk_bf16_f32 v232, v88, v89
    v_cvt_pk_bf16_f32 v233, v90, v91
    v_cvt_pk_bf16_f32 v234, v120, v121
    v_cvt_pk_bf16_f32 v235, v122, v123
    buffer_store_dwordx4 v[232:235], v241, s[8:11], s58 offen offset:3072 sc1
    ds_write_b128 v251, v[232:235] offset:11264
    s_add_u32 s58, s58, 4096
    v_cvt_pk_bf16_f32 v228, v28, v29
    v_cvt_pk_bf16_f32 v229, v30, v31
    v_cvt_pk_bf16_f32 v230, v60, v61
    v_cvt_pk_bf16_f32 v231, v62, v63
    buffer_store_dwordx4 v[228:231], v241, s[8:11], s58 offen offset:0 sc1
    ds_write_b128 v251, v[228:231] offset:12288
    v_cvt_pk_bf16_f32 v232, v92, v93
    v_cvt_pk_bf16_f32 v233, v94, v95
    v_cvt_pk_bf16_f32 v234, v124, v125
    v_cvt_pk_bf16_f32 v235, v126, v127
    buffer_store_dwordx4 v[232:235], v241, s[8:11], s58 offen offset:1024 sc1
    ds_write_b128 v251, v[232:235] offset:13312
    v_cvt_pk_bf16_f32 v228, v32, v33
    v_cvt_pk_bf16_f32 v229, v34, v35
    v_cvt_pk_bf16_f32 v230, v64, v65
    v_cvt_pk_bf16_f32 v231, v66, v67
    buffer_store_dwordx4 v[228:231], v241, s[8:11], s58 offen offset:2048 sc1
    ds_write_b128 v251, v[228:231] offset:14336
    v_cvt_pk_bf16_f32 v232, v96, v97
    v_cvt_pk_bf16_f32 v233, v98, v99
    v_cvt_pk_bf16_f32 v234, v128, v129
    v_cvt_pk_bf16_f32 v235, v130, v131
    buffer_store_dwordx4 v[232:235], v241, s[8:11], s58 offen offset:3072 sc1
    ds_write_b128 v251, v[232:235] offset:15360
    s_waitcnt lgkmcnt(0)
    s_barrier
    s_lshl_b32 s68, s71, 2
    s_add_u32 s68, s68, s72
    s_lshl_b32 s69, s36, 2
    s_add_u32 s69, s69, s33
    s_lshl_b32 s69, s69, 6
    s_add_u32 s69, s69, s68
    s_lshl_b32 s69, s69, 10
    s_add_u32 s64, s69, 27262976
    s_add_u32 s65, s64, 16384
    s_add_u32 s66, s64, 32768
    s_add_u32 s67, s64, 49152
    s_lshl_b32 s68, s68, 10
    s_add_u32 s68, s68, s59
    v_add_u32 v250, s68, v241
    s_mov_b32 s57, 0xffff0000
    s_waitcnt vmcnt(12)
    s_mov_b64 exec, 1
    buffer_store_dword v244, v239, s[8:11], s55 offen offset:0 sc1
    s_mov_b64 exec, -1
    v_lshlrev_b32 v152, 16, v140
    v_and_b32 v153, s57, v140
    v_lshlrev_b32 v154, 16, v141
    v_and_b32 v155, s57, v141
    v_lshlrev_b32 v180, 16, v132
    v_and_b32 v181, s57, v132
    v_pk_add_f32 v[156:157], v[180:181], v[148:149] op_sel_hi:[1,0] neg_lo:[0,1] neg_hi:[0,1]
    v_pk_mul_f32 v[156:157], v[148:149], v[156:157] op_sel:[1,0] op_sel_hi:[1,1]
    v_cvt_pk_bf16_f32 v156, v156, v157
    v_and_b32 v157, s57, v156
    v_lshlrev_b32 v156, 16, v156
    v_pk_mul_f32 v[156:157], v[156:157], v[152:153]
    v_cvt_pk_bf16_f32 v156, v156, v157
    v_lshlrev_b32 v196, 16, v156
    v_and_b32 v197, s57, v156
    v_lshlrev_b32 v212, 16, v144
    v_and_b32 v213, s57, v144
    v_lshlrev_b32 v182, 16, v133
    v_and_b32 v183, s57, v133
    v_pk_add_f32 v[156:157], v[182:183], v[148:149] op_sel_hi:[1,0] neg_lo:[0,1] neg_hi:[0,1]
    v_pk_mul_f32 v[156:157], v[148:149], v[156:157] op_sel:[1,0] op_sel_hi:[1,1]
    v_cvt_pk_bf16_f32 v156, v156, v157
    v_and_b32 v157, s57, v156
    v_lshlrev_b32 v156, 16, v156
    v_pk_mul_f32 v[156:157], v[156:157], v[154:155]
    v_cvt_pk_bf16_f32 v156, v156, v157
    v_lshlrev_b32 v198, 16, v156
    v_and_b32 v199, s57, v156
    v_lshlrev_b32 v214, 16, v145
    v_and_b32 v215, s57, v145
    v_lshlrev_b32 v184, 16, v134
    v_and_b32 v185, s57, v134
    v_pk_add_f32 v[156:157], v[184:185], v[150:151] op_sel_hi:[1,0] neg_lo:[0,1] neg_hi:[0,1]
    v_pk_mul_f32 v[156:157], v[150:151], v[156:157] op_sel:[1,0] op_sel_hi:[1,1]
    v_cvt_pk_bf16_f32 v156, v156, v157
    v_and_b32 v157, s57, v156
    v_lshlrev_b32 v156, 16, v156
    v_pk_mul_f32 v[156:157], v[156:157], v[152:153]
    v_cvt_pk_bf16_f32 v156, v156, v157
    v_lshlrev_b32 v200, 16, v156
    v_and_b32 v201, s57, v156
    v_lshlrev_b32 v216, 16, v144
    v_and_b32 v217, s57, v144
    v_lshlrev_b32 v186, 16, v135
    v_and_b32 v187, s57, v135
    v_pk_add_f32 v[156:157], v[186:187], v[150:151] op_sel_hi:[1,0] neg_lo:[0,1] neg_hi:[0,1]
    v_pk_mul_f32 v[156:157], v[150:151], v[156:157] op_sel:[1,0] op_sel_hi:[1,1]
    v_cvt_pk_bf16_f32 v156, v156, v157
    v_and_b32 v157, s57, v156
    v_lshlrev_b32 v156, 16, v156
    v_pk_mul_f32 v[156:157], v[156:157], v[154:155]
    v_cvt_pk_bf16_f32 v156, v156, v157
    v_lshlrev_b32 v202, 16, v156
    v_and_b32 v203, s57, v156
    v_lshlrev_b32 v218, 16, v145
    v_and_b32 v219, s57, v145
    s_waitcnt vmcnt(9)
    s_mov_b64 exec, 1
    buffer_store_dword v244, v239, s[8:11], s55 offen offset:128 sc1
    s_mov_b64 exec, -1
    v_lshlrev_b32 v152, 16, v142
    v_and_b32 v153, s57, v142
    v_lshlrev_b32 v154, 16, v143
    v_and_b32 v155, s57, v143
    v_lshlrev_b32 v188, 16, v136
    v_and_b32 v189, s57, v136
    v_pk_add_f32 v[156:157], v[188:189], v[148:149] op_sel_hi:[1,0] neg_lo:[0,1] neg_hi:[0,1]
    v_pk_mul_f32 v[156:157], v[148:149], v[156:157] op_sel:[1,0] op_sel_hi:[1,1]
    v_cvt_pk_bf16_f32 v156, v156, v157
    v_and_b32 v157, s57, v156
    v_lshlrev_b32 v156, 16, v156
    v_pk_mul_f32 v[156:157], v[156:157], v[152:153]
    v_cvt_pk_bf16_f32 v156, v156, v157
    v_lshlrev_b32 v204, 16, v156
    v_and_b32 v205, s57, v156
    v_lshlrev_b32 v220, 16, v146
    v_and_b32 v221, s57, v146
    v_lshlrev_b32 v190, 16, v137
    v_and_b32 v191, s57, v137
    v_pk_add_f32 v[156:157], v[190:191], v[148:149] op_sel_hi:[1,0] neg_lo:[0,1] neg_hi:[0,1]
    v_pk_mul_f32 v[156:157], v[148:149], v[156:157] op_sel:[1,0] op_sel_hi:[1,1]
    v_cvt_pk_bf16_f32 v156, v156, v157
    v_and_b32 v157, s57, v156
    v_lshlrev_b32 v156, 16, v156
    v_pk_mul_f32 v[156:157], v[156:157], v[154:155]
    v_cvt_pk_bf16_f32 v156, v156, v157
    v_lshlrev_b32 v206, 16, v156
    v_and_b32 v207, s57, v156
    v_lshlrev_b32 v222, 16, v147
    v_and_b32 v223, s57, v147
    v_lshlrev_b32 v192, 16, v138
    v_and_b32 v193, s57, v138
    v_pk_add_f32 v[156:157], v[192:193], v[150:151] op_sel_hi:[1,0] neg_lo:[0,1] neg_hi:[0,1]
    v_pk_mul_f32 v[156:157], v[150:151], v[156:157] op_sel:[1,0] op_sel_hi:[1,1]
    v_cvt_pk_bf16_f32 v156, v156, v157
    v_and_b32 v157, s57, v156
    v_lshlrev_b32 v156, 16, v156
    v_pk_mul_f32 v[156:157], v[156:157], v[152:153]
    v_cvt_pk_bf16_f32 v156, v156, v157
    v_lshlrev_b32 v208, 16, v156
    v_and_b32 v209, s57, v156
    v_lshlrev_b32 v224, 16, v146
    v_and_b32 v225, s57, v146
    v_lshlrev_b32 v194, 16, v139
    v_and_b32 v195, s57, v139
    v_pk_add_f32 v[156:157], v[194:195], v[150:151] op_sel_hi:[1,0] neg_lo:[0,1] neg_hi:[0,1]
    v_pk_mul_f32 v[156:157], v[150:151], v[156:157] op_sel:[1,0] op_sel_hi:[1,1]
    v_cvt_pk_bf16_f32 v156, v156, v157
    v_and_b32 v157, s57, v156
    v_lshlrev_b32 v156, 16, v156
    v_pk_mul_f32 v[156:157], v[156:157], v[154:155]
    v_cvt_pk_bf16_f32 v156, v156, v157
    v_lshlrev_b32 v210, 16, v156
    v_and_b32 v211, s57, v156
    v_lshlrev_b32 v226, 16, v147
    v_and_b32 v227, s57, v147
    s_waitcnt vmcnt(6)
    s_mov_b64 exec, 1
    buffer_store_dword v244, v239, s[8:11], s55 offen offset:256 sc1
    s_mov_b64 exec, -1
    s_waitcnt vmcnt(3)
    s_mov_b64 exec, 1
    buffer_store_dword v244, v239, s[8:11], s55 offen offset:384 sc1
    s_mov_b64 exec, -1
    s_branch K2_own
K2_loader:
    s_sub_u32 s60, s32, 4
    s_lshl_b32 s61, s60, 13
    v_lshlrev_b32 v2, 4, v1
    v_add_u32 v2, s61, v2
    s_lshl_b32 s62, s60, 12
    s_add_u32 s62, s62, 98304
    s_lshr_b32 s63, s60, 1
    s_and_b32 s64, s60, 1
    s_mul_i32 s65, s64, 196608
    s_mul_i32 s66, s34, 1572864
    s_add_u32 s66, s66, 4194304
    s_lshl_b32 s67, s34, 18
    s_add_u32 s67, s67, 16777216
    s_lshl_b32 s68, s34, 20
    s_add_u32 s68, s68, 18874368
    s_mov_b64 s[74:75], 0
    s_mov_b64 s[76:77], 0
    s_mov_b64 s[88:89], 0
    s_mov_b32 s69, 0
    s_lshl_b32 s73, s34, 11
    s_add_u32 s73, s73, 48431104
    v_lshlrev_b32 v18, 3, v1
    s_getpc_b64 s[84:85]
K2_pc:
    s_add_u32 s86, s84, K2_poll1-K2_pc
    s_addc_u32 s87, s85, 0
    s_add_u32 s92, s84, K2_poll2-K2_pc
    s_addc_u32 s93, s85, 0
    s_add_u32 s84, s84, K2_poll0-K2_pc
    s_addc_u32 s85, s85, 0
    s_branch K2_polldone
K2_poll0:
    s_ff1_i32_b64 s80, s[78:79]
    s_and_b32 s80, s80, 48
    s_lshl_b64 exec, 0xffff, s80
    buffer_load_dwordx2 v[16:17], v18, s[8:11], s73 offen offset:0 sc1
    s_waitcnt vmcnt(0)
    v_and_b32 v16, v16, v17
    v_cmp_eq_u32 vcc, 1, v16
    s_mov_b64 exec, -1
    s_add_u32 s69, s69, 1
    s_cmp_gt_u32 s69, 0x40000
    s_nop 1
    s_cselect_b64 s[80:81], -1, vcc
    s_or_b64 s[74:75], s[74:75], s[80:81]
    s_andn2_b64 s[80:81], s[78:79], s[74:75]
    s_cbranch_scc0 K2_pollret0
    s_sleep 16
    s_branch K2_poll0
K2_pollret0:
    s_setpc_b64 s[82:83]
K2_poll1:
    s_ff1_i32_b64 s80, s[78:79]
    s_and_b32 s80, s80, 48
    s_lshl_b64 exec, 0xffff, s80
    buffer_load_dwordx2 v[16:17], v18, s[8:11], s73 offen offset:512 sc1
    s_waitcnt vmcnt(0)
    v_and_b32 v16, v16, v17
    v_cmp_eq_u32 vcc, 1, v16
    s_mov_b64 exec, -1
    s_add_u32 s69, s69, 1
    s_cmp_gt_u32 s69, 0x40000
    s_nop 1
    s_cselect_b64 s[80:81], -1, vcc
    s_or_b64 s[76:77], s[76:77], s[80:81]
    s_andn2_b64 s[80:81], s[78:79], s[76:77]
    s_cbranch_scc0 K2_pollret1
    s_sleep 4
    s_branch K2_poll1
K2_pollret1:
    s_setpc_b64 s[82:83]
K2_poll2:
    s_ff1_i32_b64 s80, s[78:79]
    s_and_b32 s80, s80, 48
    s_lshl_b64 exec, 0xffff, s80
    buffer_load_dwordx2 v[16:17], v18, s[8:11], s73 offen offset:1024 sc1
    s_waitcnt vmcnt(0)
    v_and_b32 v16, v16, v17
    v_cmp_eq_u32 vcc, 1, v16
    s_mov_b64 exec, -1
    s_add_u32 s69, s69, 1
    s_cmp_gt_u32 s69, 0x40000
    s_nop 1
    s_cselect_b64 s[80:81], -1, vcc
    s_or_b64 s[88:89], s[88:89], s[80:81]
    s_andn2_b64 s[80:81], s[78:79], s[88:89]
    s_cbranch_scc0 K2_pollret2
    s_sleep 16
    s_branch K2_poll2
K2_pollret2:
    s_setpc_b64 s[82:83]
K2_polldone:
    s_cmp_eq_u32 s33, 0
    s_cbranch_scc1 K2_l0
    s_cmp_eq_u32 s33, 1
    s_cbranch_scc1 K2_l1
    s_cmp_eq_u32 s33, 2
    s_cbranch_scc1 K2_l2
    s_branch K2_l3
K2_l0:
    s_barrier
    s_lshl_b32 s69, s35, 7
    s_lshl_b32 s55, s60, 5
    s_add_u32 s69, s69, s55
    v_lshrrev_b32 v12, 3, v1
    v_lshrrev_b32 v13, 1, v12
    v_and_b32 v14, 7, v1
    v_xor_b32 v13, v13, v14
    v_add_u32 v12, s69, v12
    v_lshlrev_b32 v12, 11, v12
    v_lshl_add_u32 v8, v13, 4, v12
    v_xor_b32 v13, 64, v8
    v_add_u32 v9, 15360, v13
    v_add_u32 v10, 30720, v8
    v_add_u32 v11, 30720, v9
    s_add_u32 m0, s62, 0
    s_mov_b32 s55, 1024
    buffer_load_dwordx4 v8, s[16:19], s55 offen offset:0  lds
    buffer_load_dwordx4 v9, s[16:19], s55 offen offset:1024  lds
    buffer_load_dwordx4 v10, s[16:19], s55 offen offset:2048  lds
    buffer_load_dwordx4 v11, s[16:19], s55 offen offset:3072  lds
    s_add_u32 m0, s62, 16384
    s_mov_b32 s55, 1024
    buffer_load_dwordx4 v8, s[20:23], s55 offen offset:0  lds
    buffer_load_dwordx4 v9, s[20:23], s55 offen offset:1024  lds
    buffer_load_dwordx4 v10, s[20:23], s55 offen offset:2048  lds
    buffer_load_dwordx4 v11, s[20:23], s55 offen offset:3072  lds
    s_add_u32 m0, s62, 32768
    s_mov_b32 s55, 1152
    buffer_load_dwordx4 v8, s[16:19], s55 offen offset:0  lds
    buffer_load_dwordx4 v9, s[16:19], s55 offen offset:1024  lds
    buffer_load_dwordx4 v10, s[16:19], s55 offen offset:2048  lds
    buffer_load_dwordx4 v11, s[16:19], s55 offen offset:3072  lds
    s_sleep 36
    s_mov_b32 s55, 32
    s_cmp_eq_u32 s63, 1
    s_cmov_b32 s55, 34
    s_add_u32 s55, s55, s64
    s_lshl_b64 s[78:79], 1, s55
    s_andn2_b64 s[80:81], s[78:79], s[76:77]
    s_cbranch_scc0 K1_ok_9
    s_swappc_b64 s[82:83], s[86:87]
K1_ok_9:
    s_add_u32 m0, s61, 0
    s_add_u32 s55, s68, 524288
    buffer_load_dwordx4 v2, s[8:11], s55 offen offset:0  lds
    buffer_load_dwordx4 v2, s[8:11], s55 offen offset:1024  lds
    buffer_load_dwordx4 v2, s[8:11], s55 offen offset:2048  lds
    buffer_load_dwordx4 v2, s[8:11], s55 offen offset:3072  lds
    s_add_u32 m0, s61, 4096
    s_add_u32 s55, s68, 528384
    buffer_load_dwordx4 v2, s[8:11], s55 offen offset:0  lds
    buffer_load_dwordx4 v2, s[8:11], s55 offen offset:1024  lds
    buffer_load_dwordx4 v2, s[8:11], s55 offen offset:2048  lds
    buffer_load_dwordx4 v2, s[8:11], s55 offen offset:3072  lds
    s_mov_b32 s55, 32
    s_cmp_eq_u32 s63, 1
    s_cmov_b32 s55, 34
    s_add_u32 s55, s55, s64
    s_lshl_b64 s[78:79], 1, s55
    s_andn2_b64 s[80:81], s[78:79], s[76:77]
    s_cbranch_scc0 K1_ok_10
    s_swappc_b64 s[82:83], s[86:87]
K1_ok_10:
    s_add_u32 m0, s61, 32768
    s_add_u32 s55, s68, 557056
    buffer_load_dwordx4 v2, s[8:11], s55 offen offset:0  lds
    buffer_load_dwordx4 v2, s[8:11], s55 offen offset:1024  lds
    buffer_load_dwordx4 v2, s[8:11], s55 offen offset:2048  lds
    buffer_load_dwordx4 v2, s[8:11], s55 offen offset:3072  lds
    s_add_u32 m0, s61, 36864
    s_add_u32 s55, s68, 561152
    buffer_load_dwordx4 v2, s[8:11], s55 offen offset:0  lds
    buffer_load_dwordx4 v2, s[8:11], s55 offen offset:1024  lds
    buffer_load_dwordx4 v2, s[8:11], s55 offen offset:2048  lds
    buffer_load_dwordx4 v2, s[8:11], s55 offen offset:3072  lds
    s_waitcnt vmcnt(8)
    s_barrier
    s_mov_b32 s55, 36
    s_cmp_eq_u32 s63, 1
    s_cmov_b32 s55, 38
    s_add_u32 s55, s55, s64
    s_lshl_b64 s[78:79], 1, s55
    s_andn2_b64 s[80:81], s[78:79], s[76:77]
    s_cbranch_scc0 K1_ok_11
    s_swappc_b64 s[82:83], s[86:87]
K1_ok_11:
    s_add_u32 m0, s61, 65536
    s_add_u32 s55, s68, 589824
    buffer_load_dwordx4 v2, s[8:11], s55 offen offset:0  lds
    buffer_load_dwordx4 v2, s[8:11], s55 offen offset:1024  lds
    buffer_load_dwordx4 v2, s[8:11], s55 offen offset:2048  lds
    buffer_load_dwordx4 v2, s[8:11], s55 offen offset:3072  lds
    s_add_u32 m0, s61, 69632
    s_add_u32 s55, s68, 593920
    buffer_load_dwordx4 v2, s[8:11], s55 offen offset:0  lds
    buffer_load_dwordx4 v2, s[8:11], s55 offen offset:1024  lds
    buffer_load_dwordx4 v2, s[8:11], s55 offen offset:2048  lds
    buffer_load_dwordx4 v2, s[8:11], s55 offen offset:3072  lds
    s_waitcnt vmcnt(8)
    s_barrier
    s_mov_b32 s55, 36
    s_cmp_eq_u32 s63, 1
    s_cmov_b32 s55, 38
    s_add_u32 s55, s55, s64
    s_lshl_b64 s[78:79], 1, s55
    s_andn2_b64 s[80:81], s[78:79], s[76:77]
    s_cbranch_scc0 K1_ok_12
    s_swappc_b64 s[82:83], s[86:87]
K1_ok_12:
    s_add_u32 m0, s61, 0
    s_add_u32 s55, s68, 622592
    buffer_load_dwordx4 v2, s[8:11], s55 offen offset:0  lds
    buffer_load_dwordx4 v2, s[8:11], s55 offen offset:1024  lds
    buffer_load_dwordx4 v2, s[8:11], s55 offen offset:2048  lds
    buffer_load_dwordx4 v2, s[8:11], s55 offen offset:3072  lds
    s_add_u32 m0, s61, 4096
    s_add_u32 s55, s68, 626688
    buffer_load_dwordx4 v2, s[8:11], s55 offen offset:0  lds
    buffer_load_dwordx4 v2, s[8:11], s55 offen offset:1024  lds
    buffer_load_dwordx4 v2, s[8:11], s55 offen offset:2048  lds
    buffer_load_dwordx4 v2, s[8:11], s55 offen offset:3072  lds
    s_add_u32 m0, s62, 0
    s_mov_b32 s55, 1152
    buffer_load_dwordx4 v8, s[20:23], s55 offen offset:0  lds
    buffer_load_dwordx4 v9, s[20:23], s55 offen offset:1024  lds
    buffer_load_dwordx4 v10, s[20:23], s55 offen offset:2048  lds
    buffer_load_dwordx4 v11, s[20:23], s55 offen offset:3072  lds
    s_waitcnt vmcnt(12)
    s_barrier
    s_mov_b32 s55, 40
    s_cmp_eq_u32 s63, 1
    s_cmov_b32 s55, 42
    s_add_u32 s55, s55, s64
    s_lshl_b64 s[78:79], 1, s55
    s_andn2_b64 s[80:81], s[78:79], s[76:77]
    s_cbranch_scc0 K1_ok_13
    s_swappc_b64 s[82:83], s[86:87]
K1_ok_13:
    s_add_u32 m0, s61, 32768
    s_add_u32 s55, s68, 655360
    buffer_load_dwordx4 v2, s[8:11], s55 offen offset:0  lds
    buffer_load_dwordx4 v2, s[8:11], s55 offen offset:1024  lds
    buffer_load_dwordx4 v2, s[8:11], s55 offen offset:2048  lds
    buffer_load_dwordx4 v2, s[8:11], s55 offen offset:3072  lds
    s_add_u32 m0, s61, 36864
    s_add_u32 s55, s68, 659456
    buffer_load_dwordx4 v2, s[8:11], s55 offen offset:0  lds
    buffer_load_dwordx4 v2, s[8:11], s55 offen offset:1024  lds
    buffer_load_dwordx4 v2, s[8:11], s55 offen offset:2048  lds
    buffer_load_dwordx4 v2, s[8:11], s55 offen offset:3072  lds
    s_add_u32 m0, s62, 16384
    s_mov_b32 s55, 1280
    buffer_load_dwordx4 v8, s[16:19], s55 offen offset:0  lds
    buffer_load_dwordx4 v9, s[16:19], s55 offen offset:1024  lds
    buffer_load_dwordx4 v10, s[16:19], s55 offen offset:2048  lds
    buffer_load_dwordx4 v11, s[16:19], s55 offen offset:3072  lds
    s_waitcnt vmcnt(12)
    s_barrier
    s_mov_b32 s55, 0
    s_cmp_eq_u32 s63, 1
    s_cmov_b32 s55, 2
    s_add_u32 s55, s55, s64
    s_lshl_b64 s[78:79], 1, s55
    s_andn2_b64 s[80:81], s[78:79], s[76:77]
    s_cbranch_scc0 K1_ok_14
    s_swappc_b64 s[82:83], s[86:87]
K1_ok_14:
    s_add_u32 m0, s61, 65536
    s_add_u32 s55, s68, 0
    buffer_load_dwordx4 v2, s[8:11], s55 offen offset:0  lds
    buffer_load_dwordx4 v2, s[8:11], s55 offen offset:1024  lds
    buffer_load_dwordx4 v2, s[8:11], s55 offen offset:2048  lds
    buffer_load_dwordx4 v2, s[8:11], s55 offen offset:3072  lds
    s_add_u32 m0, s61, 69632
    s_add_u32 s55, s68, 4096
    buffer_load_dwordx4 v2, s[8:11], s55 offen offset:0  lds
    buffer_load_dwordx4 v2, s[8:11], s55 offen offset:1024  lds
    buffer_load_dwordx4 v2, s[8:11], s55 offen offset:2048  lds
    buffer_load_dwordx4 v2, s[8:11], s55 offen offset:3072  lds
    s_add_u32 m0, s62, 32768
    s_mov_b32 s55, 0
    buffer_load_dwordx4 v8, s[16:19], s55 offen offset:0  lds
    buffer_load_dwordx4 v9, s[16:19], s55 offen offset:1024  lds
    buffer_load_dwordx4 v10, s[16:19], s55 offen offset:2048  lds
    buffer_load_dwordx4 v11, s[16:19], s55 offen offset:3072  lds
    s_waitcnt vmcnt(12)
    s_barrier
    s_mov_b32 s55, 0
    s_cmp_eq_u32 s63, 1
    s_cmov_b32 s55, 2
    s_add_u32 s55, s55, s64
    s_lshl_b64 s[78:79], 1, s55
    s_andn2_b64 s[80:81], s[78:79], s[76:77]
    s_cbranch_scc0 K1_ok_15
    s_swappc_b64 s[82:83], s[86:87]
K1_ok_15:
    s_add_u32 m0, s61, 0
    s_add_u32 s55, s68, 32768
    buffer_load_dwordx4 v2, s[8:11], s55 offen offset:0  lds
    buffer_load_dwordx4 v2, s[8:11], s55 offen offset:1024  lds
    buffer_load_dwordx4 v2, s[8:11], s55 offen offset:2048  lds
    buffer_load_dwordx4 v2, s[8:11], s55 offen offset:3072  lds
    s_add_u32 m0, s61, 4096
    s_add_u32 s55, s68, 36864
    buffer_load_dwordx4 v2, s[8:11], s55 offen offset:0  lds
    buffer_load_dwordx4 v2, s[8:11], s55 offen offset:1024  lds
    buffer_load_dwordx4 v2, s[8:11], s55 offen offset:2048  lds
    buffer_load_dwordx4 v2, s[8:11], s55 offen offset:3072  lds
    s_add_u32 m0, s62, 0
    s_mov_b32 s55, 0
    buffer_load_dwordx4 v8, s[20:23], s55 offen offset:0  lds
    buffer_load_dwordx4 v9, s[20:23], s55 offen offset:1024  lds
    buffer_load_dwordx4 v10, s[20:23], s55 offen offset:2048  lds
    buffer_load_dwordx4 v11, s[20:23], s55 offen offset:3072  lds
    s_waitcnt vmcnt(12)
    s_barrier
    s_mov_b32 s55, 4
    s_cmp_eq_u32 s63, 1
    s_cmov_b32 s55, 6
    s_add_u32 s55, s55, s64
    s_lshl_b64 s[78:79], 1, s55
    s_andn2_b64 s[80:81], s[78:79], s[76:77]
    s_cbranch_scc0 K1_ok_16
    s_swappc_b64 s[82:83], s[86:87]
K1_ok_16:
    s_add_u32 m0, s61, 32768
    s_add_u32 s55, s68, 65536
    buffer_load_dwordx4 v2, s[8:11], s55 offen offset:0  lds
    buffer_load_dwordx4 v2, s[8:11], s55 offen offset:1024  lds
    buffer_load_dwordx4 v2, s[8:11], s55 offen offset:2048  lds
    buffer_load_dwordx4 v2, s[8:11], s55 offen offset:3072  lds
    s_add_u32 m0, s61, 36864
    s_add_u32 s55, s68, 69632
    buffer_load_dwordx4 v2, s[8:11], s55 offen offset:0  lds
    buffer_load_dwordx4 v2, s[8:11], s55 offen offset:1024  lds
    buffer_load_dwordx4 v2, s[8:11], s55 offen offset:2048  lds
    buffer_load_dwordx4 v2, s[8:11], s55 offen offset:3072  lds
    s_add_u32 m0, s62, 16384
    s_mov_b32 s55, 128
    buffer_load_dwordx4 v8, s[16:19], s55 offen offset:0  lds
    buffer_load_dwordx4 v9, s[16:19], s55 offen offset:1024  lds
    buffer_load_dwordx4 v10, s[16:19], s55 offen offset:2048  lds
    buffer_load_dwordx4 v11, s[16:19], s55 offen offset:3072  lds
    s_waitcnt vmcnt(12)
    s_barrier
    s_mov_b32 s55, 4
    s_cmp_eq_u32 s63, 1
    s_cmov_b32 s55, 6
    s_add_u32 s55, s55, s64
    s_lshl_b64 s[78:79], 1, s55
    s_andn2_b64 s[80:81], s[78:79], s[76:77]
    s_cbranch_scc0 K1_ok_17
    s_swappc_b64 s[82:83], s[86:87]
K1_ok_17:
    s_add_u32 m0, s61, 65536
    s_add_u32 s55, s68, 98304
    buffer_load_dwordx4 v2, s[8:11], s55 offen offset:0  lds
    buffer_load_dwordx4 v2, s[8:11], s55 offen offset:1024  lds
    buffer_load_dwordx4 v2, s[8:11], s55 offen offset:2048  lds
    buffer_load_dwordx4 v2, s[8:11], s55 offen offset:3072  lds
    s_add_u32 m0, s61, 69632
    s_add_u32 s55, s68, 102400
    buffer_load_dwordx4 v2, s[8:11], s55 offen offset:0  lds
    buffer_load_dwordx4 v2, s[8:11], s55 offen offset:1024  lds
    buffer_load_dwordx4 v2, s[8:11], s55 offen offset:2048  lds
    buffer_load_dwordx4 v2, s[8:11], s55 offen offset:3072  lds
    s_add_u32 m0, s62, 32768
    s_mov_b32 s55, 128
    buffer_load_dwordx4 v8, s[20:23], s55 offen offset:0  lds
    buffer_load_dwordx4 v9, s[20:23], s55 offen offset:1024  lds
    buffer_load_dwordx4 v10, s[20:23], s55 offen offset:2048  lds
    buffer_load_dwordx4 v11, s[20:23], s55 offen offset:3072  lds
    s_waitcnt vmcnt(12)
    s_barrier
    s_mov_b32 s55, 8
    s_cmp_eq_u32 s63, 1
    s_cmov_b32 s55, 10
    s_add_u32 s55, s55, s64
    s_lshl_b64 s[78:79], 1, s55
    s_andn2_b64 s[80:81], s[78:79], s[76:77]
    s_cbranch_scc0 K1_ok_18
    s_swappc_b64 s[82:83], s[86:87]
K1_ok_18:
    s_add_u32 m0, s61, 0
    s_add_u32 s55, s68, 131072
    buffer_load_dwordx4 v2, s[8:11], s55 offen offset:0  lds
    buffer_load_dwordx4 v2, s[8:11], s55 offen offset:1024  lds
    buffer_load_dwordx4 v2, s[8:11], s55 offen offset:2048  lds
    buffer_load_dwordx4 v2, s[8:11], s55 offen offset:3072  lds
    s_add_u32 m0, s61, 4096
    s_add_u32 s55, s68, 135168
    buffer_load_dwordx4 v2, s[8:11], s55 offen offset:0  lds
    buffer_load_dwordx4 v2, s[8:11], s55 offen offset:1024  lds
    buffer_load_dwordx4 v2, s[8:11], s55 offen offset:2048  lds
    buffer_load_dwordx4 v2, s[8:11], s55 offen offset:3072  lds
    s_add_u32 m0, s62, 0
    s_mov_b32 s55, 256
    buffer_load_dwordx4 v8, s[16:19], s55 offen offset:0  lds
    buffer_load_dwordx4 v9, s[16:19], s55 offen offset:1024  lds
    buffer_load_dwordx4 v10, s[16:19], s55 offen offset:2048  lds
    buffer_load_dwordx4 v11, s[16:19], s55 offen offset:3072  lds
    s_waitcnt vmcnt(12)
    s_barrier
    s_mov_b32 s55, 8
    s_cmp_eq_u32 s63, 1
    s_cmov_b32 s55, 10
    s_add_u32 s55, s55, s64
    s_lshl_b64 s[78:79], 1, s55
    s_andn2_b64 s[80:81], s[78:79], s[76:77]
    s_cbranch_scc0 K1_ok_19
    s_swappc_b64 s[82:83], s[86:87]
K1_ok_19:
    s_add_u32 m0, s61, 32768
    s_add_u32 s55, s68, 163840
    buffer_load_dwordx4 v2, s[8:11], s55 offen offset:0  lds
    buffer_load_dwordx4 v2, s[8:11], s55 offen offset:1024  lds
    buffer_load_dwordx4 v2, s[8:11], s55 offen offset:2048  lds
    buffer_load_dwordx4 v2, s[8:11], s55 offen offset:3072  lds
    s_add_u32 m0, s61, 36864
    s_add_u32 s55, s68, 167936
    buffer_load_dwordx4 v2, s[8:11], s55 offen offset:0  lds
    buffer_load_dwordx4 v2, s[8:11], s55 offen offset:1024  lds
    buffer_load_dwordx4 v2, s[8:11], s55 offen offset:2048  lds
    buffer_load_dwordx4 v2, s[8:11], s55 offen offset:3072  lds
    s_add_u32 m0, s62, 16384
    s_mov_b32 s55, 256
    buffer_load_dwordx4 v8, s[20:23], s55 offen offset:0  lds
    buffer_load_dwordx4 v9, s[20:23], s55 offen offset:1024  lds
    buffer_load_dwordx4 v10, s[20:23], s55 offen offset:2048  lds
    buffer_load_dwordx4 v11, s[20:23], s55 offen offset:3072  lds
    s_waitcnt vmcnt(12)
    s_barrier
    s_mov_b32 s55, 12
    s_cmp_eq_u32 s63, 1
    s_cmov_b32 s55, 14
    s_add_u32 s55, s55, s64
    s_lshl_b64 s[78:79], 1, s55
    s_andn2_b64 s[80:81], s[78:79], s[76:77]
    s_cbranch_scc0 K1_ok_20
    s_swappc_b64 s[82:83], s[86:87]
K1_ok_20:
    s_add_u32 m0, s61, 65536
    s_add_u32 s55, s68, 196608
    buffer_load_dwordx4 v2, s[8:11], s55 offen offset:0  lds
    buffer_load_dwordx4 v2, s[8:11], s55 offen offset:1024  lds
    buffer_load_dwordx4 v2, s[8:11], s55 offen offset:2048  lds
    buffer_load_dwordx4 v2, s[8:11], s55 offen offset:3072  lds
    s_add_u32 m0, s61, 69632
    s_add_u32 s55, s68, 200704
    buffer_load_dwordx4 v2, s[8:11], s55 offen offset:0  lds
    buffer_load_dwordx4 v2, s[8:11], s55 offen offset:1024  lds
    buffer_load_dwordx4 v2, s[8:11], s55 offen offset:2048  lds
    buffer_load_dwordx4 v2, s[8:11], s55 offen offset:3072  lds
    s_add_u32 m0, s62, 32768
    s_mov_b32 s55, 384
    buffer_load_dwordx4 v8, s[16:19], s55 offen offset:0  lds
    buffer_load_dwordx4 v9, s[16:19], s55 offen offset:1024  lds
    buffer_load_dwordx4 v10, s[16:19], s55 offen offset:2048  lds
    buffer_load_dwordx4 v11, s[16:19], s55 offen offset:3072  lds
    s_waitcnt vmcnt(12)
    s_barrier
    s_mov_b32 s55, 12
    s_cmp_eq_u32 s63, 1
    s_cmov_b32 s55, 14
    s_add_u32 s55, s55, s64
    s_lshl_b64 s[78:79], 1, s55
    s_andn2_b64 s[80:81], s[78:79], s[76:77]
    s_cbranch_scc0 K1_ok_21
    s_swappc_b64 s[82:83], s[86:87]
K1_ok_21:
    s_add_u32 m0, s61, 0
    s_add_u32 s55, s68, 229376
    buffer_load_dwordx4 v2, s[8:11], s55 offen offset:0  lds
    buffer_load_dwordx4 v2, s[8:11], s55 offen offset:1024  lds
    buffer_load_dwordx4 v2, s[8:11], s55 offen offset:2048  lds
    buffer_load_dwordx4 v2, s[8:11], s55 offen offset:3072  lds
    s_add_u32 m0, s61, 4096
    s_add_u32 s55, s68, 233472
    buffer_load_dwordx4 v2, s[8:11], s55 offen offset:0  lds
    buffer_load_dwordx4 v2, s[8:11], s55 offen offset:1024  lds
    buffer_load_dwordx4 v2, s[8:11], s55 offen offset:2048  lds
    buffer_load_dwordx4 v2, s[8:11], s55 offen offset:3072  lds
    s_add_u32 m0, s62, 0
    s_mov_b32 s55, 384
    buffer_load_dwordx4 v8, s[20:23], s55 offen offset:0  lds
    buffer_load_dwordx4 v9, s[20:23], s55 offen offset:1024  lds
    buffer_load_dwordx4 v10, s[20:23], s55 offen offset:2048  lds
    buffer_load_dwordx4 v11, s[20:23], s55 offen offset:3072  lds
    s_waitcnt vmcnt(12)
    s_barrier
    s_mov_b32 s55, 16
    s_cmp_eq_u32 s63, 1
    s_cmov_b32 s55, 18
    s_add_u32 s55, s55, s64
    s_lshl_b64 s[78:79], 1, s55
    s_andn2_b64 s[80:81], s[78:79], s[76:77]
    s_cbranch_scc0 K1_ok_22
    s_swappc_b64 s[82:83], s[86:87]
K1_ok_22:
    s_add_u32 m0, s61, 32768
    s_add_u32 s55, s68, 262144
    buffer_load_dwordx4 v2, s[8:11], s55 offen offset:0  lds
    buffer_load_dwordx4 v2, s[8:11], s55 offen offset:1024  lds
    buffer_load_dwordx4 v2, s[8:11], s55 offen offset:2048  lds
    buffer_load_dwordx4 v2, s[8:11], s55 offen offset:3072  lds
    s_add_u32 m0, s61, 36864
    s_add_u32 s55, s68, 266240
    buffer_load_dwordx4 v2, s[8:11], s55 offen offset:0  lds
    buffer_load_dwordx4 v2, s[8:11], s55 offen offset:1024  lds
    buffer_load_dwordx4 v2, s[8:11], s55 offen offset:2048  lds
    buffer_load_dwordx4 v2, s[8:11], s55 offen offset:3072  lds
    s_add_u32 m0, s62, 16384
    s_mov_b32 s55, 512
    buffer_load_dwordx4 v8, s[16:19], s55 offen offset:0  lds
    buffer_load_dwordx4 v9, s[16:19], s55 offen offset:1024  lds
    buffer_load_dwordx4 v10, s[16:19], s55 offen offset:2048  lds
    buffer_load_dwordx4 v11, s[16:19], s55 offen offset:3072  lds
    s_waitcnt vmcnt(12)
    s_barrier
    s_mov_b32 s55, 16
    s_cmp_eq_u32 s63, 1
    s_cmov_b32 s55, 18
    s_add_u32 s55, s55, s64
    s_lshl_b64 s[78:79], 1, s55
    s_andn2_b64 s[80:81], s[78:79], s[76:77]
    s_cbranch_scc0 K1_ok_23
    s_swappc_b64 s[82:83], s[86:87]
K1_ok_23:
    s_add_u32 m0, s61, 65536
    s_add_u32 s55, s68, 294912
    buffer_load_dwordx4 v2, s[8:11], s55 offen offset:0  lds
    buffer_load_dwordx4 v2, s[8:11], s55 offen offset:1024  lds
    buffer_load_dwordx4 v2, s[8:11], s55 offen offset:2048  lds
    buffer_load_dwordx4 v2, s[8:11], s55 offen offset:3072  lds
    s_add_u32 m0, s61, 69632
    s_add_u32 s55, s68, 299008
    buffer_load_dwordx4 v2, s[8:11], s55 offen offset:0  lds
    buffer_load_dwordx4 v2, s[8:11], s55 offen offset:1024  lds
    buffer_load_dwordx4 v2, s[8:11], s55 offen offset:2048  lds
    buffer_load_dwordx4 v2, s[8:11], s55 offen offset:3072  lds
    s_add_u32 m0, s62, 32768
    s_mov_b32 s55, 512
    buffer_load_dwordx4 v8, s[20:23], s55 offen offset:0  lds
    buffer_load_dwordx4 v9, s[20:23], s55 offen offset:1024  lds
    buffer_load_dwordx4 v10, s[20:23], s55 offen offset:2048  lds
    buffer_load_dwordx4 v11, s[20:23], s55 offen offset:3072  lds
    s_waitcnt vmcnt(12)
    s_barrier
    s_mov_b32 s55, 20
    s_cmp_eq_u32 s63, 1
    s_cmov_b32 s55, 22
    s_add_u32 s55, s55, s64
    s_lshl_b64 s[78:79], 1, s55
    s_andn2_b64 s[80:81], s[78:79], s[76:77]
    s_cbranch_scc0 K1_ok_24
    s_swappc_b64 s[82:83], s[86:87]
K1_ok_24:
    s_add_u32 m0, s61, 0
    s_add_u32 s55, s68, 327680
    buffer_load_dwordx4 v2, s[8:11], s55 offen offset:0  lds
    buffer_load_dwordx4 v2, s[8:11], s55 offen offset:1024  lds
    buffer_load_dwordx4 v2, s[8:11], s55 offen offset:2048  lds
    buffer_load_dwordx4 v2, s[8:11], s55 offen offset:3072  lds
    s_add_u32 m0, s61, 4096
    s_add_u32 s55, s68, 331776
    buffer_load_dwordx4 v2, s[8:11], s55 offen offset:0  lds
    buffer_load_dwordx4 v2, s[8:11], s55 offen offset:1024  lds
    buffer_load_dwordx4 v2, s[8:11], s55 offen offset:2048  lds
    buffer_load_dwordx4 v2, s[8:11], s55 offen offset:3072  lds
    s_add_u32 m0, s62, 0
    s_mov_b32 s55, 640
    buffer_load_dwordx4 v8, s[16:19], s55 offen offset:0  lds
    buffer_load_dwordx4 v9, s[16:19], s55 offen offset:1024  lds
    buffer_load_dwordx4 v10, s[16:19], s55 offen offset:2048  lds
    buffer_load_dwordx4 v11, s[16:19], s55 offen offset:3072  lds
    s_waitcnt vmcnt(12)
    s_barrier
    s_mov_b32 s55, 20
    s_cmp_eq_u32 s63, 1
    s_cmov_b32 s55, 22
    s_add_u32 s55, s55, s64
    s_lshl_b64 s[78:79], 1, s55
    s_andn2_b64 s[80:81], s[78:79], s[76:77]
    s_cbranch_scc0 K1_ok_25
    s_swappc_b64 s[82:83], s[86:87]
K1_ok_25:
    s_add_u32 m0, s61, 32768
    s_add_u32 s55, s68, 360448
    buffer_load_dwordx4 v2, s[8:11], s55 offen offset:0  lds
    buffer_load_dwordx4 v2, s[8:11], s55 offen offset:1024  lds
    buffer_load_dwordx4 v2, s[8:11], s55 offen offset:2048  lds
    buffer_load_dwordx4 v2, s[8:11], s55 offen offset:3072  lds
    s_add_u32 m0, s61, 36864
    s_add_u32 s55, s68, 364544
    buffer_load_dwordx4 v2, s[8:11], s55 offen offset:0  lds
    buffer_load_dwordx4 v2, s[8:11], s55 offen offset:1024  lds
    buffer_load_dwordx4 v2, s[8:11], s55 offen offset:2048  lds
    buffer_load_dwordx4 v2, s[8:11], s55 offen offset:3072  lds
    s_add_u32 m0, s62, 16384
    s_mov_b32 s55, 640
    buffer_load_dwordx4 v8, s[20:23], s55 offen offset:0  lds
    buffer_load_dwordx4 v9, s[20:23], s55 offen offset:1024  lds
    buffer_load_dwordx4 v10, s[20:23], s55 offen offset:2048  lds
    buffer_load_dwordx4 v11, s[20:23], s55 offen offset:3072  lds
    s_waitcnt vmcnt(12)
    s_barrier
    s_mov_b32 s55, 24
    s_cmp_eq_u32 s63, 1
    s_cmov_b32 s55, 26
    s_add_u32 s55, s55, s64
    s_lshl_b64 s[78:79], 1, s55
    s_andn2_b64 s[80:81], s[78:79], s[76:77]
    s_cbranch_scc0 K1_ok_26
    s_swappc_b64 s[82:83], s[86:87]
K1_ok_26:
    s_add_u32 m0, s61, 65536
    s_add_u32 s55, s68, 393216
    buffer_load_dwordx4 v2, s[8:11], s55 offen offset:0  lds
    buffer_load_dwordx4 v2, s[8:11], s55 offen offset:1024  lds
    buffer_load_dwordx4 v2, s[8:11], s55 offen offset:2048  lds
    buffer_load_dwordx4 v2, s[8:11], s55 offen offset:3072  lds
    s_add_u32 m0, s61, 69632
    s_add_u32 s55, s68, 397312
    buffer_load_dwordx4 v2, s[8:11], s55 offen offset:0  lds
    buffer_load_dwordx4 v2, s[8:11], s55 offen offset:1024  lds
    buffer_load_dwordx4 v2, s[8:11], s55 offen offset:2048  lds
    buffer_load_dwordx4 v2, s[8:11], s55 offen offset:3072  lds
    s_add_u32 m0, s62, 32768
    s_mov_b32 s55, 768
    buffer_load_dwordx4 v8, s[16:19], s55 offen offset:0  lds
    buffer_load_dwordx4 v9, s[16:19], s55 offen offset:1024  lds
    buffer_load_dwordx4 v10, s[16:19], s55 offen offset:2048  lds
    buffer_load_dwordx4 v11, s[16:19], s55 offen offset:3072  lds
    s_waitcnt vmcnt(12)
    s_barrier
    s_mov_b32 s55, 24
    s_cmp_eq_u32 s63, 1
    s_cmov_b32 s55, 26
    s_add_u32 s55, s55, s64
    s_lshl_b64 s[78:79], 1, s55
    s_andn2_b64 s[80:81], s[78:79], s[76:77]
    s_cbranch_scc0 K1_ok_27
    s_swappc_b64 s[82:83], s[86:87]
K1_ok_27:
    s_add_u32 m0, s61, 0
    s_add_u32 s55, s68, 425984
    buffer_load_dwordx4 v2, s[8:11], s55 offen offset:0  lds
    buffer_load_dwordx4 v2, s[8:11], s55 offen offset:1024  lds
    buffer_load_dwordx4 v2, s[8:11], s55 offen offset:2048  lds
    buffer_load_dwordx4 v2, s[8:11], s55 offen offset:3072  lds
    s_add_u32 m0, s61, 4096
    s_add_u32 s55, s68, 430080
    buffer_load_dwordx4 v2, s[8:11], s55 offen offset:0  lds
    buffer_load_dwordx4 v2, s[8:11], s55 offen offset:1024  lds
    buffer_load_dwordx4 v2, s[8:11], s55 offen offset:2048  lds
    buffer_load_dwordx4 v2, s[8:11], s55 offen offset:3072  lds
    s_add_u32 m0, s62, 0
    s_mov_b32 s55, 768
    buffer_load_dwordx4 v8, s[20:23], s55 offen offset:0  lds
    buffer_load_dwordx4 v9, s[20:23], s55 offen offset:1024  lds
    buffer_load_dwordx4 v10, s[20:23], s55 offen offset:2048  lds
    buffer_load_dwordx4 v11, s[20:23], s55 offen offset:3072  lds
    s_waitcnt vmcnt(12)
    s_barrier
    s_mov_b32 s55, 28
    s_cmp_eq_u32 s63, 1
    s_cmov_b32 s55, 30
    s_add_u32 s55, s55, s64
    s_lshl_b64 s[78:79], 1, s55
    s_andn2_b64 s[80:81], s[78:79], s[76:77]
    s_cbranch_scc0 K1_ok_28
    s_swappc_b64 s[82:83], s[86:87]
K1_ok_28:
    s_add_u32 m0, s61, 32768
    s_add_u32 s55, s68, 458752
    buffer_load_dwordx4 v2, s[8:11], s55 offen offset:0  lds
    buffer_load_dwordx4 v2, s[8:11], s55 offen offset:1024  lds
    buffer_load_dwordx4 v2, s[8:11], s55 offen offset:2048  lds
    buffer_load_dwordx4 v2, s[8:11], s55 offen offset:3072  lds
    s_add_u32 m0, s61, 36864
    s_add_u32 s55, s68, 462848
    buffer_load_dwordx4 v2, s[8:11], s55 offen offset:0  lds
    buffer_load_dwordx4 v2, s[8:11], s55 offen offset:1024  lds
    buffer_load_dwordx4 v2, s[8:11], s55 offen offset:2048  lds
    buffer_load_dwordx4 v2, s[8:11], s55 offen offset:3072  lds
    s_add_u32 m0, s62, 16384
    s_mov_b32 s55, 896
    buffer_load_dwordx4 v8, s[16:19], s55 offen offset:0  lds
    buffer_load_dwordx4 v9, s[16:19], s55 offen offset:1024  lds
    buffer_load_dwordx4 v10, s[16:19], s55 offen offset:2048  lds
    buffer_load_dwordx4 v11, s[16:19], s55 offen offset:3072  lds
    s_waitcnt vmcnt(12)
    s_barrier
    s_mov_b32 s55, 28
    s_cmp_eq_u32 s63, 1
    s_cmov_b32 s55, 30
    s_add_u32 s55, s55, s64
    s_lshl_b64 s[78:79], 1, s55
    s_andn2_b64 s[80:81], s[78:79], s[76:77]
    s_cbranch_scc0 K1_ok_29
    s_swappc_b64 s[82:83], s[86:87]
K1_ok_29:
    s_add_u32 m0, s61, 65536
    s_add_u32 s55, s68, 491520
    buffer_load_dwordx4 v2, s[8:11], s55 offen offset:0  lds
    buffer_load_dwordx4 v2, s[8:11], s55 offen offset:1024  lds
    buffer_load_dwordx4 v2, s[8:11], s55 offen offset:2048  lds
    buffer_load_dwordx4 v2, s[8:11], s55 offen offset:3072  lds
    s_add_u32 m0, s61, 69632
    s_add_u32 s55, s68, 495616
    buffer_load_dwordx4 v2, s[8:11], s55 offen offset:0  lds
    buffer_load_dwordx4 v2, s[8:11], s55 offen offset:1024  lds
    buffer_load_dwordx4 v2, s[8:11], s55 offen offset:2048  lds
    buffer_load_dwordx4 v2, s[8:11], s55 offen offset:3072  lds
    s_add_u32 m0, s62, 32768
    s_mov_b32 s55, 896
    buffer_load_dwordx4 v8, s[20:23], s55 offen offset:0  lds
    buffer_load_dwordx4 v9, s[20:23], s55 offen offset:1024  lds
    buffer_load_dwordx4 v10, s[20:23], s55 offen offset:2048  lds
    buffer_load_dwordx4 v11, s[20:23], s55 offen offset:3072  lds
    s_waitcnt vmcnt(12)
    s_barrier
    s_waitcnt vmcnt(0)
    s_barrier
    s_barrier
    s_mov_b32 s59, 32768
    s_mov_b32 s70, 0
    s_branch K2_final
K2_l1:
    s_barrier
    s_lshl_b32 s69, s64, 15
    s_lshl_b32 s55, s35, 8
    s_add_u32 s69, s69, s55
    v_lshrrev_b32 v12, 4, v1
    v_bfe_u32 v14, v1, 1, 3
    v_xor_b32 v13, v12, v14
    v_lshlrev_b32 v13, 5, v13
    v_lshl_add_u32 v13, v12, 11, v13
    v_and_b32 v14, 1, v1
    v_lshl_add_u32 v13, v14, 4, v13
    v_add_u32 v4, s69, v13
    v_xor_b32 v13, 128, v4
    v_add_u32 v5, 7168, v13
    v_add_u32 v6, 14336, v4
    v_add_u32 v7, 14336, v5
    s_add_u32 m0, s62, 0
    s_mov_b32 s55, 0
    s_cmp_eq_u32 s63, 1
    s_cmov_b32 s55, 229376
    buffer_load_dwordx4 v4, s[12:15], s55 offen offset:0  lds
    buffer_load_dwordx4 v5, s[12:15], s55 offen offset:1024  lds
    buffer_load_dwordx4 v6, s[12:15], s55 offen offset:2048  lds
    buffer_load_dwordx4 v7, s[12:15], s55 offen offset:3072  lds
    s_add_u32 m0, s62, 16384
    s_mov_b32 s55, 458752
    s_cmp_eq_u32 s63, 1
    s_cmov_b32 s55, 688128
    buffer_load_dwordx4 v4, s[12:15], s55 offen offset:0  lds
    buffer_load_dwordx4 v5, s[12:15], s55 offen offset:1024  lds
    buffer_load_dwordx4 v6, s[12:15], s55 offen offset:2048  lds
    buffer_load_dwordx4 v7, s[12:15], s55 offen offset:3072  lds
    s_add_u32 m0, s62, 32768
    s_mov_b32 s55, 917504
    s_cmp_eq_u32 s63, 1
    s_cmov_b32 s55, 1146880
    buffer_load_dwordx4 v4, s[12:15], s55 offen offset:0  lds
    buffer_load_dwordx4 v5, s[12:15], s55 offen offset:1024  lds
    buffer_load_dwordx4 v6, s[12:15], s55 offen offset:2048  lds
    buffer_load_dwordx4 v7, s[12:15], s55 offen offset:3072  lds
    s_sleep 1
    s_mov_b32 s55, 0
    s_cmp_eq_u32 s63, 1
    s_cmov_b32 s55, 2
    s_add_u32 s55, s55, s64
    s_lshl_b64 s[78:79], 1, s55
    s_andn2_b64 s[80:81], s[78:79], s[88:89]
    s_cbranch_scc0 K1_ok_30
    s_swappc_b64 s[82:83], s[92:93]
K1_ok_30:
    s_add_u32 m0, s61, 0
    s_add_u32 s55, s66, 0
    buffer_load_dwordx4 v2, s[8:11], s55 offen offset:0  lds
    buffer_load_dwordx4 v2, s[8:11], s55 offen offset:1024  lds
    buffer_load_dwordx4 v2, s[8:11], s55 offen offset:2048  lds
    buffer_load_dwordx4 v2, s[8:11], s55 offen offset:3072  lds
    s_add_u32 m0, s61, 4096
    s_add_u32 s55, s66, 4096
    buffer_load_dwordx4 v2, s[8:11], s55 offen offset:0  lds
    buffer_load_dwordx4 v2, s[8:11], s55 offen offset:1024  lds
    buffer_load_dwordx4 v2, s[8:11], s55 offen offset:2048  lds
    buffer_load_dwordx4 v2, s[8:11], s55 offen offset:3072  lds
    s_mov_b32 s55, 4
    s_cmp_eq_u32 s63, 1
    s_cmov_b32 s55, 6
    s_add_u32 s55, s55, s64
    s_lshl_b64 s[78:79], 1, s55
    s_andn2_b64 s[80:81], s[78:79], s[88:89]
    s_cbranch_scc0 K1_ok_31
    s_swappc_b64 s[82:83], s[92:93]
K1_ok_31:
    s_add_u32 m0, s61, 32768
    s_add_u32 s55, s66, 32768
    buffer_load_dwordx4 v2, s[8:11], s55 offen offset:0  lds
    buffer_load_dwordx4 v2, s[8:11], s55 offen offset:1024  lds
    buffer_load_dwordx4 v2, s[8:11], s55 offen offset:2048  lds
    buffer_load_dwordx4 v2, s[8:11], s55 offen offset:3072  lds
    s_add_u32 m0, s61, 36864
    s_add_u32 s55, s66, 36864
    buffer_load_dwordx4 v2, s[8:11], s55 offen offset:0  lds
    buffer_load_dwordx4 v2, s[8:11], s55 offen offset:1024  lds
    buffer_load_dwordx4 v2, s[8:11], s55 offen offset:2048  lds
    buffer_load_dwordx4 v2, s[8:11], s55 offen offset:3072  lds
    s_waitcnt vmcnt(8)
    s_barrier
    s_mov_b32 s55, 8
    s_cmp_eq_u32 s63, 1
    s_cmov_b32 s55, 10
    s_add_u32 s55, s55, s64
    s_lshl_b64 s[78:79], 1, s55
    s_andn2_b64 s[80:81], s[78:79], s[88:89]
    s_cbranch_scc0 K1_ok_32
    s_swappc_b64 s[82:83], s[92:93]
K1_ok_32:
    s_add_u32 m0, s61, 65536
    s_add_u32 s55, s66, 65536
    buffer_load_dwordx4 v2, s[8:11], s55 offen offset:0  lds
    buffer_load_dwordx4 v2, s[8:11], s55 offen offset:1024  lds
    buffer_load_dwordx4 v2, s[8:11], s55 offen offset:2048  lds
    buffer_load_dwordx4 v2, s[8:11], s55 offen offset:3072  lds
    s_add_u32 m0, s61, 69632
    s_add_u32 s55, s66, 69632
    buffer_load_dwordx4 v2, s[8:11], s55 offen offset:0  lds
    buffer_load_dwordx4 v2, s[8:11], s55 offen offset:1024  lds
    buffer_load_dwordx4 v2, s[8:11], s55 offen offset:2048  lds
    buffer_load_dwordx4 v2, s[8:11], s55 offen offset:3072  lds
    s_waitcnt vmcnt(8)
    s_barrier
    s_mov_b32 s55, 12
    s_cmp_eq_u32 s63, 1
    s_cmov_b32 s55, 14
    s_add_u32 s55, s55, s64
    s_lshl_b64 s[78:79], 1, s55
    s_andn2_b64 s[80:81], s[78:79], s[88:89]
    s_cbranch_scc0 K1_ok_33
    s_swappc_b64 s[82:83], s[92:93]
K1_ok_33:
    s_add_u32 m0, s61, 0
    s_add_u32 s55, s66, 98304
    buffer_load_dwordx4 v2, s[8:11], s55 offen offset:0  lds
    buffer_load_dwordx4 v2, s[8:11], s55 offen offset:1024  lds
    buffer_load_dwordx4 v2, s[8:11], s55 offen offset:2048  lds
    buffer_load_dwordx4 v2, s[8:11], s55 offen offset:3072  lds
    s_add_u32 m0, s61, 4096
    s_add_u32 s55, s66, 102400
    buffer_load_dwordx4 v2, s[8:11], s55 offen offset:0  lds
    buffer_load_dwordx4 v2, s[8:11], s55 offen offset:1024  lds
    buffer_load_dwordx4 v2, s[8:11], s55 offen offset:2048  lds
    buffer_load_dwordx4 v2, s[8:11], s55 offen offset:3072  lds
    s_add_u32 m0, s62, 0
    s_mov_b32 s55, 1376256
    s_cmp_eq_u32 s63, 1
    s_cmov_b32 s55, 1605632
    buffer_load_dwordx4 v4, s[12:15], s55 offen offset:0  lds
    buffer_load_dwordx4 v5, s[12:15], s55 offen offset:1024  lds
    buffer_load_dwordx4 v6, s[12:15], s55 offen offset:2048  lds
    buffer_load_dwordx4 v7, s[12:15], s55 offen offset:3072  lds
    s_waitcnt vmcnt(12)
    s_barrier
    s_mov_b32 s55, 48
    s_cmp_eq_u32 s63, 1
    s_cmov_b32 s55, 50
    s_add_u32 s55, s55, s64
    s_lshl_b64 s[78:79], 1, s55
    s_andn2_b64 s[80:81], s[78:79], s[88:89]
    s_cbranch_scc0 K1_ok_34
    s_swappc_b64 s[82:83], s[92:93]
K1_ok_34:
    s_add_u32 m0, s61, 32768
    s_add_u32 s55, s66, 393216
    buffer_load_dwordx4 v2, s[8:11], s55 offen offset:0  lds
    buffer_load_dwordx4 v2, s[8:11], s55 offen offset:1024  lds
    buffer_load_dwordx4 v2, s[8:11], s55 offen offset:2048  lds
    buffer_load_dwordx4 v2, s[8:11], s55 offen offset:3072  lds
    s_add_u32 m0, s61, 36864
    s_add_u32 s55, s66, 397312
    buffer_load_dwordx4 v2, s[8:11], s55 offen offset:0  lds
    buffer_load_dwordx4 v2, s[8:11], s55 offen offset:1024  lds
    buffer_load_dwordx4 v2, s[8:11], s55 offen offset:2048  lds
    buffer_load_dwordx4 v2, s[8:11], s55 offen offset:3072  lds
    s_add_u32 m0, s62, 16384
    s_mov_b32 s55, 5505024
    s_cmp_eq_u32 s63, 1
    s_cmov_b32 s55, 5734400
    buffer_load_dwordx4 v4, s[12:15], s55 offen offset:0  lds
    buffer_load_dwordx4 v5, s[12:15], s55 offen offset:1024  lds
    buffer_load_dwordx4 v6, s[12:15], s55 offen offset:2048  lds
    buffer_load_dwordx4 v7, s[12:15], s55 offen offset:3072  lds
    s_waitcnt vmcnt(12)
    s_barrier
    s_mov_b32 s55, 52
    s_cmp_eq_u32 s63, 1
    s_cmov_b32 s55, 54
    s_add_u32 s55, s55, s64
    s_lshl_b64 s[78:79], 1, s55
    s_andn2_b64 s[80:81], s[78:79], s[88:89]
    s_cbranch_scc0 K1_ok_35
    s_swappc_b64 s[82:83], s[92:93]
K1_ok_35:
    s_add_u32 m0, s61, 65536
    s_add_u32 s55, s66, 425984
    buffer_load_dwordx4 v2, s[8:11], s55 offen offset:0  lds
    buffer_load_dwordx4 v2, s[8:11], s55 offen offset:1024  lds
    buffer_load_dwordx4 v2, s[8:11], s55 offen offset:2048  lds
    buffer_load_dwordx4 v2, s[8:11], s55 offen offset:3072  lds
    s_add_u32 m0, s61, 69632
    s_add_u32 s55, s66, 430080
    buffer_load_dwordx4 v2, s[8:11], s55 offen offset:0  lds
    buffer_load_dwordx4 v2, s[8:11], s55 offen offset:1024  lds
    buffer_load_dwordx4 v2, s[8:11], s55 offen offset:2048  lds
    buffer_load_dwordx4 v2, s[8:11], s55 offen offset:3072  lds
    s_add_u32 m0, s62, 32768
    s_mov_b32 s55, 5963776
    s_cmp_eq_u32 s63, 1
    s_cmov_b32 s55, 6193152
    buffer_load_dwordx4 v4, s[12:15], s55 offen offset:0  lds
    buffer_load_dwordx4 v5, s[12:15], s55 offen offset:1024  lds
    buffer_load_dwordx4 v6, s[12:15], s55 offen offset:2048  lds
    buffer_load_dwordx4 v7, s[12:15], s55 offen offset:3072  lds
    s_waitcnt vmcnt(12)
    s_barrier
    s_mov_b32 s55, 56
    s_cmp_eq_u32 s63, 1
    s_cmov_b32 s55, 58
    s_add_u32 s55, s55, s64
    s_lshl_b64 s[78:79], 1, s55
    s_andn2_b64 s[80:81], s[78:79], s[88:89]
    s_cbranch_scc0 K1_ok_36
    s_swappc_b64 s[82:83], s[92:93]
K1_ok_36:
    s_add_u32 m0, s61, 0
    s_add_u32 s55, s66, 458752
    buffer_load_dwordx4 v2, s[8:11], s55 offen offset:0  lds
    buffer_load_dwordx4 v2, s[8:11], s55 offen offset:1024  lds
    buffer_load_dwordx4 v2, s[8:11], s55 offen offset:2048  lds
    buffer_load_dwordx4 v2, s[8:11], s55 offen offset:3072  lds
    s_add_u32 m0, s61, 4096
    s_add_u32 s55, s66, 462848
    buffer_load_dwordx4 v2, s[8:11], s55 offen offset:0  lds
    buffer_load_dwordx4 v2, s[8:11], s55 offen offset:1024  lds
    buffer_load_dwordx4 v2, s[8:11], s55 offen offset:2048  lds
    buffer_load_dwordx4 v2, s[8:11], s55 offen offset:3072  lds
    s_add_u32 m0, s62, 0
    s_mov_b32 s55, 6422528
    s_cmp_eq_u32 s63, 1
    s_cmov_b32 s55, 6651904
    buffer_load_dwordx4 v4, s[12:15], s55 offen offset:0  lds
    buffer_load_dwordx4 v5, s[12:15], s55 offen offset:1024  lds
    buffer_load_dwordx4 v6, s[12:15], s55 offen offset:2048  lds
    buffer_load_dwordx4 v7, s[12:15], s55 offen offset:3072  lds
    s_waitcnt vmcnt(12)
    s_barrier
    s_mov_b32 s55, 60
    s_cmp_eq_u32 s63, 1
    s_cmov_b32 s55, 62
    s_add_u32 s55, s55, s64
    s_lshl_b64 s[78:79], 1, s55
    s_andn2_b64 s[80:81], s[78:79], s[88:89]
    s_cbranch_scc0 K1_ok_37
    s_swappc_b64 s[82:83], s[92:93]
K1_ok_37:
    s_add_u32 m0, s61, 32768
    s_add_u32 s55, s66, 491520
    buffer_load_dwordx4 v2, s[8:11], s55 offen offset:0  lds
    buffer_load_dwordx4 v2, s[8:11], s55 offen offset:1024  lds
    buffer_load_dwordx4 v2, s[8:11], s55 offen offset:2048  lds
    buffer_load_dwordx4 v2, s[8:11], s55 offen offset:3072  lds
    s_add_u32 m0, s61, 36864
    s_add_u32 s55, s66, 495616
    buffer_load_dwordx4 v2, s[8:11], s55 offen offset:0  lds
    buffer_load_dwordx4 v2, s[8:11], s55 offen offset:1024  lds
    buffer_load_dwordx4 v2, s[8:11], s55 offen offset:2048  lds
    buffer_load_dwordx4 v2, s[8:11], s55 offen offset:3072  lds
    s_add_u32 m0, s62, 16384
    s_mov_b32 s55, 6881280
    s_cmp_eq_u32 s63, 1
    s_cmov_b32 s55, 7110656
    buffer_load_dwordx4 v4, s[12:15], s55 offen offset:0  lds
    buffer_load_dwordx4 v5, s[12:15], s55 offen offset:1024  lds
    buffer_load_dwordx4 v6, s[12:15], s55 offen offset:2048  lds
    buffer_load_dwordx4 v7, s[12:15], s55 offen offset:3072  lds
    s_waitcnt vmcnt(12)
    s_barrier
    s_mov_b32 s55, 0
    s_cmp_eq_u32 s63, 1
    s_cmov_b32 s55, 2
    s_add_u32 s55, s55, s64
    s_lshl_b64 s[78:79], 1, s55
    s_andn2_b64 s[80:81], s[78:79], s[74:75]
    s_cbranch_scc0 K1_ok_38
    s_swappc_b64 s[82:83], s[84:85]
K1_ok_38:
    s_add_u32 m0, s61, 65536
    s_add_u32 s55, s66, 524288
    buffer_load_dwordx4 v2, s[8:11], s55 offen offset:0  lds
    buffer_load_dwordx4 v2, s[8:11], s55 offen offset:1024  lds
    buffer_load_dwordx4 v2, s[8:11], s55 offen offset:2048  lds
    buffer_load_dwordx4 v2, s[8:11], s55 offen offset:3072  lds
    s_add_u32 m0, s61, 69632
    s_add_u32 s55, s66, 528384
    buffer_load_dwordx4 v2, s[8:11], s55 offen offset:0  lds
    buffer_load_dwordx4 v2, s[8:11], s55 offen offset:1024  lds
    buffer_load_dwordx4 v2, s[8:11], s55 offen offset:2048  lds
    buffer_load_dwordx4 v2, s[8:11], s55 offen offset:3072  lds
    s_add_u32 m0, s62, 32768
    s_mov_b32 s55, 65536
    s_cmp_eq_u32 s63, 1
    s_cmov_b32 s55, 294912
    buffer_load_dwordx4 v4, s[12:15], s55 offen offset:0  lds
    buffer_load_dwordx4 v5, s[12:15], s55 offen offset:1024  lds
    buffer_load_dwordx4 v6, s[12:15], s55 offen offset:2048  lds
    buffer_load_dwordx4 v7, s[12:15], s55 offen offset:3072  lds
    s_waitcnt vmcnt(12)
    s_barrier
    s_mov_b32 s55, 4
    s_cmp_eq_u32 s63, 1
    s_cmov_b32 s55, 6
    s_add_u32 s55, s55, s64
    s_lshl_b64 s[78:79], 1, s55
    s_andn2_b64 s[80:81], s[78:79], s[74:75]
    s_cbranch_scc0 K1_ok_39
    s_swappc_b64 s[82:83], s[84:85]
K1_ok_39:
    s_add_u32 m0, s61, 0
    s_add_u32 s55, s66, 557056
    buffer_load_dwordx4 v2, s[8:11], s55 offen offset:0  lds
    buffer_load_dwordx4 v2, s[8:11], s55 offen offset:1024  lds
    buffer_load_dwordx4 v2, s[8:11], s55 offen offset:2048  lds
    buffer_load_dwordx4 v2, s[8:11], s55 offen offset:3072  lds
    s_add_u32 m0, s61, 4096
    s_add_u32 s55, s66, 561152
    buffer_load_dwordx4 v2, s[8:11], s55 offen offset:0  lds
    buffer_load_dwordx4 v2, s[8:11], s55 offen offset:1024  lds
    buffer_load_dwordx4 v2, s[8:11], s55 offen offset:2048  lds
    buffer_load_dwordx4 v2, s[8:11], s55 offen offset:3072  lds
    s_add_u32 m0, s62, 0
    s_mov_b32 s55, 524288
    s_cmp_eq_u32 s63, 1
    s_cmov_b32 s55, 753664
    buffer_load_dwordx4 v4, s[12:15], s55 offen offset:0  lds
    buffer_load_dwordx4 v5, s[12:15], s55 offen offset:1024  lds
    buffer_load_dwordx4 v6, s[12:15], s55 offen offset:2048  lds
    buffer_load_dwordx4 v7, s[12:15], s55 offen offset:3072  lds
    s_waitcnt vmcnt(12)
    s_barrier
    s_mov_b32 s55, 40
    s_cmp_eq_u32 s63, 1
    s_cmov_b32 s55, 42
    s_add_u32 s55, s55, s64
    s_lshl_b64 s[78:79], 1, s55
    s_andn2_b64 s[80:81], s[78:79], s[76:77]
    s_cbranch_scc0 K1_ok_40
    s_swappc_b64 s[82:83], s[86:87]
K1_ok_40:
    s_add_u32 m0, s61, 32768
    s_add_u32 s55, s68, 688128
    buffer_load_dwordx4 v2, s[8:11], s55 offen offset:0  lds
    buffer_load_dwordx4 v2, s[8:11], s55 offen offset:1024  lds
    buffer_load_dwordx4 v2, s[8:11], s55 offen offset:2048  lds
    buffer_load_dwordx4 v2, s[8:11], s55 offen offset:3072  lds
    s_add_u32 m0, s61, 36864
    s_add_u32 s55, s68, 692224
    buffer_load_dwordx4 v2, s[8:11], s55 offen offset:0  lds
    buffer_load_dwordx4 v2, s[8:11], s55 offen offset:1024  lds
    buffer_load_dwordx4 v2, s[8:11], s55 offen offset:2048  lds
    buffer_load_dwordx4 v2, s[8:11], s55 offen offset:3072  lds
    s_lshl_b32 s69, s35, 7
    s_lshl_b32 s55, s60, 5
    s_add_u32 s69, s69, s55
    v_lshrrev_b32 v12, 3, v1
    v_lshrrev_b32 v13, 1, v12
    v_and_b32 v14, 7, v1
    v_xor_b32 v13, v13, v14
    v_add_u32 v12, s69, v12
    v_lshlrev_b32 v12, 11, v12
    v_lshl_add_u32 v8, v13, 4, v12
    v_xor_b32 v13, 64, v8
    v_add_u32 v9, 15360, v13
    v_add_u32 v10, 30720, v8
    v_add_u32 v11, 30720, v9
    s_add_u32 m0, s62, 16384
    s_mov_b32 s55, 1280
    buffer_load_dwordx4 v8, s[20:23], s55 offen offset:0  lds
    buffer_load_dwordx4 v9, s[20:23], s55 offen offset:1024  lds
    buffer_load_dwordx4 v10, s[20:23], s55 offen offset:2048  lds
    buffer_load_dwordx4 v11, s[20:23], s55 offen offset:3072  lds
    s_waitcnt vmcnt(12)
    s_barrier
    s_mov_b32 s55, 44
    s_cmp_eq_u32 s63, 1
    s_cmov_b32 s55, 46
    s_add_u32 s55, s55, s64
    s_lshl_b64 s[78:79], 1, s55
    s_andn2_b64 s[80:81], s[78:79], s[76:77]
    s_cbranch_scc0 K1_ok_41
    s_swappc_b64 s[82:83], s[86:87]
K1_ok_41:
    s_add_u32 m0, s61, 65536
    s_add_u32 s55, s68, 720896
    buffer_load_dwordx4 v2, s[8:11], s55 offen offset:0  lds
    buffer_load_dwordx4 v2, s[8:11], s55 offen offset:1024  lds
    buffer_load_dwordx4 v2, s[8:11], s55 offen offset:2048  lds
    buffer_load_dwordx4 v2, s[8:11], s55 offen offset:3072  lds
    s_add_u32 m0, s61, 69632
    s_add_u32 s55, s68, 724992
    buffer_load_dwordx4 v2, s[8:11], s55 offen offset:0  lds
    buffer_load_dwordx4 v2, s[8:11], s55 offen offset:1024  lds
    buffer_load_dwordx4 v2, s[8:11], s55 offen offset:2048  lds
    buffer_load_dwordx4 v2, s[8:11], s55 offen offset:3072  lds
    s_add_u32 m0, s62, 32768
    s_mov_b32 s55, 1408
    buffer_load_dwordx4 v8, s[16:19], s55 offen offset:0  lds
    buffer_load_dwordx4 v9, s[16:19], s55 offen offset:1024  lds
    buffer_load_dwordx4 v10, s[16:19], s55 offen offset:2048  lds
    buffer_load_dwordx4 v11, s[16:19], s55 offen offset:3072  lds
    s_waitcnt vmcnt(12)
    s_barrier
    s_mov_b32 s55, 44
    s_cmp_eq_u32 s63, 1
    s_cmov_b32 s55, 46
    s_add_u32 s55, s55, s64
    s_lshl_b64 s[78:79], 1, s55
    s_andn2_b64 s[80:81], s[78:79], s[76:77]
    s_cbranch_scc0 K1_ok_42
    s_swappc_b64 s[82:83], s[86:87]
K1_ok_42:
    s_add_u32 m0, s61, 0
    s_add_u32 s55, s68, 753664
    buffer_load_dwordx4 v2, s[8:11], s55 offen offset:0  lds
    buffer_load_dwordx4 v2, s[8:11], s55 offen offset:1024  lds
    buffer_load_dwordx4 v2, s[8:11], s55 offen offset:2048  lds
    buffer_load_dwordx4 v2, s[8:11], s55 offen offset:3072  lds
    s_add_u32 m0, s61, 4096
    s_add_u32 s55, s68, 757760
    buffer_load_dwordx4 v2, s[8:11], s55 offen offset:0  lds
    buffer_load_dwordx4 v2, s[8:11], s55 offen offset:1024  lds
    buffer_load_dwordx4 v2, s[8:11], s55 offen offset:2048  lds
    buffer_load_dwordx4 v2, s[8:11], s55 offen offset:3072  lds
    s_add_u32 m0, s62, 0
    s_mov_b32 s55, 1408
    buffer_load_dwordx4 v8, s[20:23], s55 offen offset:0  lds
    buffer_load_dwordx4 v9, s[20:23], s55 offen offset:1024  lds
    buffer_load_dwordx4 v10, s[20:23], s55 offen offset:2048  lds
    buffer_load_dwordx4 v11, s[20:23], s55 offen offset:3072  lds
    s_waitcnt vmcnt(12)
    s_barrier
    s_mov_b32 s55, 48
    s_cmp_eq_u32 s63, 1
    s_cmov_b32 s55, 50
    s_add_u32 s55, s55, s64
    s_lshl_b64 s[78:79], 1, s55
    s_andn2_b64 s[80:81], s[78:79], s[76:77]
    s_cbranch_scc0 K1_ok_43
    s_swappc_b64 s[82:83], s[86:87]
K1_ok_43:
    s_add_u32 m0, s61, 32768
    s_add_u32 s55, s68, 786432
    buffer_load_dwordx4 v2, s[8:11], s55 offen offset:0  lds
    buffer_load_dwordx4 v2, s[8:11], s55 offen offset:1024  lds
    buffer_load_dwordx4 v2, s[8:11], s55 offen offset:2048  lds
    buffer_load_dwordx4 v2, s[8:11], s55 offen offset:3072  lds
    s_add_u32 m0, s61, 36864
    s_add_u32 s55, s68, 790528
    buffer_load_dwordx4 v2, s[8:11], s55 offen offset:0  lds
    buffer_load_dwordx4 v2, s[8:11], s55 offen offset:1024  lds
    buffer_load_dwordx4 v2, s[8:11], s55 offen offset:2048  lds
    buffer_load_dwordx4 v2, s[8:11], s55 offen offset:3072  lds
    s_add_u32 m0, s62, 16384
    s_mov_b32 s55, 1536
    buffer_load_dwordx4 v8, s[16:19], s55 offen offset:0  lds
    buffer_load_dwordx4 v9, s[16:19], s55 offen offset:1024  lds
    buffer_load_dwordx4 v10, s[16:19], s55 offen offset:2048  lds
    buffer_load_dwordx4 v11, s[16:19], s55 offen offset:3072  lds
    s_waitcnt vmcnt(12)
    s_barrier
    s_mov_b32 s55, 48
    s_cmp_eq_u32 s63, 1
    s_cmov_b32 s55, 50
    s_add_u32 s55, s55, s64
    s_lshl_b64 s[78:79], 1, s55
    s_andn2_b64 s[80:81], s[78:79], s[76:77]
    s_cbranch_scc0 K1_ok_44
    s_swappc_b64 s[82:83], s[86:87]
K1_ok_44:
    s_add_u32 m0, s61, 65536
    s_add_u32 s55, s68, 819200
    buffer_load_dwordx4 v2, s[8:11], s55 offen offset:0  lds
    buffer_load_dwordx4 v2, s[8:11], s55 offen offset:1024  lds
    buffer_load_dwordx4 v2, s[8:11], s55 offen offset:2048  lds
    buffer_load_dwordx4 v2, s[8:11], s55 offen offset:3072  lds
    s_add_u32 m0, s61, 69632
    s_add_u32 s55, s68, 823296
    buffer_load_dwordx4 v2, s[8:11], s55 offen offset:0  lds
    buffer_load_dwordx4 v2, s[8:11], s55 offen offset:1024  lds
    buffer_load_dwordx4 v2, s[8:11], s55 offen offset:2048  lds
    buffer_load_dwordx4 v2, s[8:11], s55 offen offset:3072  lds
    s_add_u32 m0, s62, 32768
    s_mov_b32 s55, 1536
    buffer_load_dwordx4 v8, s[20:23], s55 offen offset:0  lds
    buffer_load_dwordx4 v9, s[20:23], s55 offen offset:1024  lds
    buffer_load_dwordx4 v10, s[20:23], s55 offen offset:2048  lds
    buffer_load_dwordx4 v11, s[20:23], s55 offen offset:3072  lds
    s_waitcnt vmcnt(12)
    s_barrier
    s_mov_b32 s55, 52
    s_cmp_eq_u32 s63, 1
    s_cmov_b32 s55, 54
    s_add_u32 s55, s55, s64
    s_lshl_b64 s[78:79], 1, s55
    s_andn2_b64 s[80:81], s[78:79], s[76:77]
    s_cbranch_scc0 K1_ok_45
    s_swappc_b64 s[82:83], s[86:87]
K1_ok_45:
    s_add_u32 m0, s61, 0
    s_add_u32 s55, s68, 851968
    buffer_load_dwordx4 v2, s[8:11], s55 offen offset:0  lds
    buffer_load_dwordx4 v2, s[8:11], s55 offen offset:1024  lds
    buffer_load_dwordx4 v2, s[8:11], s55 offen offset:2048  lds
    buffer_load_dwordx4 v2, s[8:11], s55 offen offset:3072  lds
    s_add_u32 m0, s61, 4096
    s_add_u32 s55, s68, 856064
    buffer_load_dwordx4 v2, s[8:11], s55 offen offset:0  lds
    buffer_load_dwordx4 v2, s[8:11], s55 offen offset:1024  lds
    buffer_load_dwordx4 v2, s[8:11], s55 offen offset:2048  lds
    buffer_load_dwordx4 v2, s[8:11], s55 offen offset:3072  lds
    s_add_u32 m0, s62, 0
    s_mov_b32 s55, 1664
    buffer_load_dwordx4 v8, s[16:19], s55 offen offset:0  lds
    buffer_load_dwordx4 v9, s[16:19], s55 offen offset:1024  lds
    buffer_load_dwordx4 v10, s[16:19], s55 offen offset:2048  lds
    buffer_load_dwordx4 v11, s[16:19], s55 offen offset:3072  lds
    s_waitcnt vmcnt(12)
    s_barrier
    s_mov_b32 s55, 52
    s_cmp_eq_u32 s63, 1
    s_cmov_b32 s55, 54
    s_add_u32 s55, s55, s64
    s_lshl_b64 s[78:79], 1, s55
    s_andn2_b64 s[80:81], s[78:79], s[76:77]
    s_cbranch_scc0 K1_ok_46
    s_swappc_b64 s[82:83], s[86:87]
K1_ok_46:
    s_add_u32 m0, s61, 32768
    s_add_u32 s55, s68, 884736
    buffer_load_dwordx4 v2, s[8:11], s55 offen offset:0  lds
    buffer_load_dwordx4 v2, s[8:11], s55 offen offset:1024  lds
    buffer_load_dwordx4 v2, s[8:11], s55 offen offset:2048  lds
    buffer_load_dwordx4 v2, s[8:11], s55 offen offset:3072  lds
    s_add_u32 m0, s61, 36864
    s_add_u32 s55, s68, 888832
    buffer_load_dwordx4 v2, s[8:11], s55 offen offset:0  lds
    buffer_load_dwordx4 v2, s[8:11], s55 offen offset:1024  lds
    buffer_load_dwordx4 v2, s[8:11], s55 offen offset:2048  lds
    buffer_load_dwordx4 v2, s[8:11], s55 offen offset:3072  lds
    s_add_u32 m0, s62, 16384
    s_mov_b32 s55, 1664
    buffer_load_dwordx4 v8, s[20:23], s55 offen offset:0  lds
    buffer_load_dwordx4 v9, s[20:23], s55 offen offset:1024  lds
    buffer_load_dwordx4 v10, s[20:23], s55 offen offset:2048  lds
    buffer_load_dwordx4 v11, s[20:23], s55 offen offset:3072  lds
    s_waitcnt vmcnt(12)
    s_barrier
    s_mov_b32 s55, 56
    s_cmp_eq_u32 s63, 1
    s_cmov_b32 s55, 58
    s_add_u32 s55, s55, s64
    s_lshl_b64 s[78:79], 1, s55
    s_andn2_b64 s[80:81], s[78:79], s[76:77]
    s_cbranch_scc0 K1_ok_47
    s_swappc_b64 s[82:83], s[86:87]
K1_ok_47:
    s_add_u32 m0, s61, 65536
    s_add_u32 s55, s68, 917504
    buffer_load_dwordx4 v2, s[8:11], s55 offen offset:0  lds
    buffer_load_dwordx4 v2, s[8:11], s55 offen offset:1024  lds
    buffer_load_dwordx4 v2, s[8:11], s55 offen offset:2048  lds
    buffer_load_dwordx4 v2, s[8:11], s55 offen offset:3072  lds
    s_add_u32 m0, s61, 69632
    s_add_u32 s55, s68, 921600
    buffer_load_dwordx4 v2, s[8:11], s55 offen offset:0  lds
    buffer_load_dwordx4 v2, s[8:11], s55 offen offset:1024  lds
    buffer_load_dwordx4 v2, s[8:11], s55 offen offset:2048  lds
    buffer_load_dwordx4 v2, s[8:11], s55 offen offset:3072  lds
    s_add_u32 m0, s62, 32768
    s_mov_b32 s55, 1792
    buffer_load_dwordx4 v8, s[16:19], s55 offen offset:0  lds
    buffer_load_dwordx4 v9, s[16:19], s55 offen offset:1024  lds
    buffer_load_dwordx4 v10, s[16:19], s55 offen offset:2048  lds
    buffer_load_dwordx4 v11, s[16:19], s55 offen offset:3072  lds
    s_waitcnt vmcnt(12)
    s_barrier
    s_mov_b32 s55, 56
    s_cmp_eq_u32 s63, 1
    s_cmov_b32 s55, 58
    s_add_u32 s55, s55, s64
    s_lshl_b64 s[78:79], 1, s55
    s_andn2_b64 s[80:81], s[78:79], s[76:77]
    s_cbranch_scc0 K1_ok_48
    s_swappc_b64 s[82:83], s[86:87]
K1_ok_48:
    s_add_u32 m0, s61, 0
    s_add_u32 s55, s68, 950272
    buffer_load_dwordx4 v2, s[8:11], s55 offen offset:0  lds
    buffer_load_dwordx4 v2, s[8:11], s55 offen offset:1024  lds
    buffer_load_dwordx4 v2, s[8:11], s55 offen offset:2048  lds
    buffer_load_dwordx4 v2, s[8:11], s55 offen offset:3072  lds
    s_add_u32 m0, s61, 4096
    s_add_u32 s55, s68, 954368
    buffer_load_dwordx4 v2, s[8:11], s55 offen offset:0  lds
    buffer_load_dwordx4 v2, s[8:11], s55 offen offset:1024  lds
    buffer_load_dwordx4 v2, s[8:11], s55 offen offset:2048  lds
    buffer_load_dwordx4 v2, s[8:11], s55 offen offset:3072  lds
    s_add_u32 m0, s62, 0
    s_mov_b32 s55, 1792
    buffer_load_dwordx4 v8, s[20:23], s55 offen offset:0  lds
    buffer_load_dwordx4 v9, s[20:23], s55 offen offset:1024  lds
    buffer_load_dwordx4 v10, s[20:23], s55 offen offset:2048  lds
    buffer_load_dwordx4 v11, s[20:23], s55 offen offset:3072  lds
    s_waitcnt vmcnt(12)
    s_barrier
    s_mov_b32 s55, 60
    s_cmp_eq_u32 s63, 1
    s_cmov_b32 s55, 62
    s_add_u32 s55, s55, s64
    s_lshl_b64 s[78:79], 1, s55
    s_andn2_b64 s[80:81], s[78:79], s[76:77]
    s_cbranch_scc0 K1_ok_49
    s_swappc_b64 s[82:83], s[86:87]
K1_ok_49:
    s_add_u32 m0, s61, 32768
    s_add_u32 s55, s68, 983040
    buffer_load_dwordx4 v2, s[8:11], s55 offen offset:0  lds
    buffer_load_dwordx4 v2, s[8:11], s55 offen offset:1024  lds
    buffer_load_dwordx4 v2, s[8:11], s55 offen offset:2048  lds
    buffer_load_dwordx4 v2, s[8:11], s55 offen offset:3072  lds
    s_add_u32 m0, s61, 36864
    s_add_u32 s55, s68, 987136
    buffer_load_dwordx4 v2, s[8:11], s55 offen offset:0  lds
    buffer_load_dwordx4 v2, s[8:11], s55 offen offset:1024  lds
    buffer_load_dwordx4 v2, s[8:11], s55 offen offset:2048  lds
    buffer_load_dwordx4 v2, s[8:11], s55 offen offset:3072  lds
    s_add_u32 m0, s62, 16384
    s_mov_b32 s55, 1920
    buffer_load_dwordx4 v8, s[16:19], s55 offen offset:0  lds
    buffer_load_dwordx4 v9, s[16:19], s55 offen offset:1024  lds
    buffer_load_dwordx4 v10, s[16:19], s55 offen offset:2048  lds
    buffer_load_dwordx4 v11, s[16:19], s55 offen offset:3072  lds
    s_waitcnt vmcnt(12)
    s_barrier
    s_mov_b32 s55, 60
    s_cmp_eq_u32 s63, 1
    s_cmov_b32 s55, 62
    s_add_u32 s55, s55, s64
    s_lshl_b64 s[78:79], 1, s55
    s_andn2_b64 s[80:81], s[78:79], s[76:77]
    s_cbranch_scc0 K1_ok_50
    s_swappc_b64 s[82:83], s[86:87]
K1_ok_50:
    s_add_u32 m0, s61, 65536
    s_add_u32 s55, s68, 1015808
    buffer_load_dwordx4 v2, s[8:11], s55 offen offset:0  lds
    buffer_load_dwordx4 v2, s[8:11], s55 offen offset:1024  lds
    buffer_load_dwordx4 v2, s[8:11], s55 offen offset:2048  lds
    buffer_load_dwordx4 v2, s[8:11], s55 offen offset:3072  lds
    s_add_u32 m0, s61, 69632
    s_add_u32 s55, s68, 1019904
    buffer_load_dwordx4 v2, s[8:11], s55 offen offset:0  lds
    buffer_load_dwordx4 v2, s[8:11], s55 offen offset:1024  lds
    buffer_load_dwordx4 v2, s[8:11], s55 offen offset:2048  lds
    buffer_load_dwordx4 v2, s[8:11], s55 offen offset:3072  lds
    s_add_u32 m0, s62, 32768
    s_mov_b32 s55, 1920
    buffer_load_dwordx4 v8, s[20:23], s55 offen offset:0  lds
    buffer_load_dwordx4 v9, s[20:23], s55 offen offset:1024  lds
    buffer_load_dwordx4 v10, s[20:23], s55 offen offset:2048  lds
    buffer_load_dwordx4 v11, s[20:23], s55 offen offset:3072  lds
    s_waitcnt vmcnt(12)
    s_barrier
    s_waitcnt vmcnt(0)
    s_barrier
    s_barrier
    s_mov_b32 s59, 32768
    s_mov_b32 s70, 0
    s_branch K2_final
K2_l2:
    s_barrier
    s_lshl_b32 s69, s64, 15
    s_lshl_b32 s55, s35, 8
    s_add_u32 s69, s69, s55
    v_lshrrev_b32 v12, 4, v1
    v_bfe_u32 v14, v1, 1, 3
    v_xor_b32 v13, v12, v14
    v_lshlrev_b32 v13, 5, v13
    v_lshl_add_u32 v13, v12, 11, v13
    v_and_b32 v14, 1, v1
    v_lshl_add_u32 v13, v14, 4, v13
    v_add_u32 v4, s69, v13
    v_xor_b32 v13, 128, v4
    v_add_u32 v5, 7168, v13
    v_add_u32 v6, 14336, v4
    v_add_u32 v7, 14336, v5
    s_add_u32 m0, s62, 0
    s_mov_b32 s55, 1835008
    s_cmp_eq_u32 s63, 1
    s_cmov_b32 s55, 2064384
    buffer_load_dwordx4 v4, s[12:15], s55 offen offset:0  lds
    buffer_load_dwordx4 v5, s[12:15], s55 offen offset:1024  lds
    buffer_load_dwordx4 v6, s[12:15], s55 offen offset:2048  lds
    buffer_load_dwordx4 v7, s[12:15], s55 offen offset:3072  lds
    s_add_u32 m0, s62, 16384
    s_mov_b32 s55, 2293760
    s_cmp_eq_u32 s63, 1
    s_cmov_b32 s55, 2523136
    buffer_load_dwordx4 v4, s[12:15], s55 offen offset:0  lds
    buffer_load_dwordx4 v5, s[12:15], s55 offen offset:1024  lds
    buffer_load_dwordx4 v6, s[12:15], s55 offen offset:2048  lds
    buffer_load_dwordx4 v7, s[12:15], s55 offen offset:3072  lds
    s_add_u32 m0, s62, 32768
    s_mov_b32 s55, 2752512
    s_cmp_eq_u32 s63, 1
    s_cmov_b32 s55, 2981888
    buffer_load_dwordx4 v4, s[12:15], s55 offen offset:0  lds
    buffer_load_dwordx4 v5, s[12:15], s55 offen offset:1024  lds
    buffer_load_dwordx4 v6, s[12:15], s55 offen offset:2048  lds
    buffer_load_dwordx4 v7, s[12:15], s55 offen offset:3072  lds
    s_sleep 1
    s_mov_b32 s55, 16
    s_cmp_eq_u32 s63, 1
    s_cmov_b32 s55, 18
    s_add_u32 s55, s55, s64
    s_lshl_b64 s[78:79], 1, s55
    s_andn2_b64 s[80:81], s[78:79], s[88:89]
    s_cbranch_scc0 K1_ok_51
    s_swappc_b64 s[82:83], s[92:93]
K1_ok_51:
    s_add_u32 m0, s61, 0
    s_add_u32 s55, s66, 131072
    buffer_load_dwordx4 v2, s[8:11], s55 offen offset:0  lds
    buffer_load_dwordx4 v2, s[8:11], s55 offen offset:1024  lds
    buffer_load_dwordx4 v2, s[8:11], s55 offen offset:2048  lds
    buffer_load_dwordx4 v2, s[8:11], s55 offen offset:3072  lds
    s_add_u32 m0, s61, 4096
    s_add_u32 s55, s66, 135168
    buffer_load_dwordx4 v2, s[8:11], s55 offen offset:0  lds
    buffer_load_dwordx4 v2, s[8:11], s55 offen offset:1024  lds
    buffer_load_dwordx4 v2, s[8:11], s55 offen offset:2048  lds
    buffer_load_dwordx4 v2, s[8:11], s55 offen offset:3072  lds
    s_mov_b32 s55, 20
    s_cmp_eq_u32 s63, 1
    s_cmov_b32 s55, 22
    s_add_u32 s55, s55, s64
    s_lshl_b64 s[78:79], 1, s55
    s_andn2_b64 s[80:81], s[78:79], s[88:89]
    s_cbranch_scc0 K1_ok_52
    s_swappc_b64 s[82:83], s[92:93]
K1_ok_52:
    s_add_u32 m0, s61, 32768
    s_add_u32 s55, s66, 163840
    buffer_load_dwordx4 v2, s[8:11], s55 offen offset:0  lds
    buffer_load_dwordx4 v2, s[8:11], s55 offen offset:1024  lds
    buffer_load_dwordx4 v2, s[8:11], s55 offen offset:2048  lds
    buffer_load_dwordx4 v2, s[8:11], s55 offen offset:3072  lds
    s_add_u32 m0, s61, 36864
    s_add_u32 s55, s66, 167936
    buffer_load_dwordx4 v2, s[8:11], s55 offen offset:0  lds
    buffer_load_dwordx4 v2, s[8:11], s55 offen offset:1024  lds
    buffer_load_dwordx4 v2, s[8:11], s55 offen offset:2048  lds
    buffer_load_dwordx4 v2, s[8:11], s55 offen offset:3072  lds
    s_waitcnt vmcnt(8)
    s_barrier
    s_mov_b32 s55, 24
    s_cmp_eq_u32 s63, 1
    s_cmov_b32 s55, 26
    s_add_u32 s55, s55, s64
    s_lshl_b64 s[78:79], 1, s55
    s_andn2_b64 s[80:81], s[78:79], s[88:89]
    s_cbranch_scc0 K1_ok_53
    s_swappc_b64 s[82:83], s[92:93]
K1_ok_53:
    s_add_u32 m0, s61, 65536
    s_add_u32 s55, s66, 196608
    buffer_load_dwordx4 v2, s[8:11], s55 offen offset:0  lds
    buffer_load_dwordx4 v2, s[8:11], s55 offen offset:1024  lds
    buffer_load_dwordx4 v2, s[8:11], s55 offen offset:2048  lds
    buffer_load_dwordx4 v2, s[8:11], s55 offen offset:3072  lds
    s_add_u32 m0, s61, 69632
    s_add_u32 s55, s66, 200704
    buffer_load_dwordx4 v2, s[8:11], s55 offen offset:0  lds
    buffer_load_dwordx4 v2, s[8:11], s55 offen offset:1024  lds
    buffer_load_dwordx4 v2, s[8:11], s55 offen offset:2048  lds
    buffer_load_dwordx4 v2, s[8:11], s55 offen offset:3072  lds
    s_waitcnt vmcnt(8)
    s_barrier
    s_mov_b32 s55, 28
    s_cmp_eq_u32 s63, 1
    s_cmov_b32 s55, 30
    s_add_u32 s55, s55, s64
    s_lshl_b64 s[78:79], 1, s55
    s_andn2_b64 s[80:81], s[78:79], s[88:89]
    s_cbranch_scc0 K1_ok_54
    s_swappc_b64 s[82:83], s[92:93]
K1_ok_54:
    s_add_u32 m0, s61, 0
    s_add_u32 s55, s66, 229376
    buffer_load_dwordx4 v2, s[8:11], s55 offen offset:0  lds
    buffer_load_dwordx4 v2, s[8:11], s55 offen offset:1024  lds
    buffer_load_dwordx4 v2, s[8:11], s55 offen offset:2048  lds
    buffer_load_dwordx4 v2, s[8:11], s55 offen offset:3072  lds
    s_add_u32 m0, s61, 4096
    s_add_u32 s55, s66, 233472
    buffer_load_dwordx4 v2, s[8:11], s55 offen offset:0  lds
    buffer_load_dwordx4 v2, s[8:11], s55 offen offset:1024  lds
    buffer_load_dwordx4 v2, s[8:11], s55 offen offset:2048  lds
    buffer_load_dwordx4 v2, s[8:11], s55 offen offset:3072  lds
    s_add_u32 m0, s62, 0
    s_mov_b32 s55, 3211264
    s_cmp_eq_u32 s63, 1
    s_cmov_b32 s55, 3440640
    buffer_load_dwordx4 v4, s[12:15], s55 offen offset:0  lds
    buffer_load_dwordx4 v5, s[12:15], s55 offen offset:1024  lds
    buffer_load_dwordx4 v6, s[12:15], s55 offen offset:2048  lds
    buffer_load_dwordx4 v7, s[12:15], s55 offen offset:3072  lds
    s_waitcnt vmcnt(12)
    s_barrier
    s_mov_b32 s55, 8
    s_cmp_eq_u32 s63, 1
    s_cmov_b32 s55, 10
    s_add_u32 s55, s55, s64
    s_lshl_b64 s[78:79], 1, s55
    s_andn2_b64 s[80:81], s[78:79], s[74:75]
    s_cbranch_scc0 K1_ok_55
    s_swappc_b64 s[82:83], s[84:85]
K1_ok_55:
    s_add_u32 m0, s61, 32768
    s_add_u32 s55, s66, 589824
    buffer_load_dwordx4 v2, s[8:11], s55 offen offset:0  lds
    buffer_load_dwordx4 v2, s[8:11], s55 offen offset:1024  lds
    buffer_load_dwordx4 v2, s[8:11], s55 offen offset:2048  lds
    buffer_load_dwordx4 v2, s[8:11], s55 offen offset:3072  lds
    s_add_u32 m0, s61, 36864
    s_add_u32 s55, s66, 593920
    buffer_load_dwordx4 v2, s[8:11], s55 offen offset:0  lds
    buffer_load_dwordx4 v2, s[8:11], s55 offen offset:1024  lds
    buffer_load_dwordx4 v2, s[8:11], s55 offen offset:2048  lds
    buffer_load_dwordx4 v2, s[8:11], s55 offen offset:3072  lds
    s_add_u32 m0, s62, 16384
    s_mov_b32 s55, 983040
    s_cmp_eq_u32 s63, 1
    s_cmov_b32 s55, 1212416
    buffer_load_dwordx4 v4, s[12:15], s55 offen offset:0  lds
    buffer_load_dwordx4 v5, s[12:15], s55 offen offset:1024  lds
    buffer_load_dwordx4 v6, s[12:15], s55 offen offset:2048  lds
    buffer_load_dwordx4 v7, s[12:15], s55 offen offset:3072  lds
    s_waitcnt vmcnt(12)
    s_barrier
    s_mov_b32 s55, 12
    s_cmp_eq_u32 s63, 1
    s_cmov_b32 s55, 14
    s_add_u32 s55, s55, s64
    s_lshl_b64 s[78:79], 1, s55
    s_andn2_b64 s[80:81], s[78:79], s[74:75]
    s_cbranch_scc0 K1_ok_56
    s_swappc_b64 s[82:83], s[84:85]
K1_ok_56:
    s_add_u32 m0, s61, 65536
    s_add_u32 s55, s66, 622592
    buffer_load_dwordx4 v2, s[8:11], s55 offen offset:0  lds
    buffer_load_dwordx4 v2, s[8:11], s55 offen offset:1024  lds
    buffer_load_dwordx4 v2, s[8:11], s55 offen offset:2048  lds
    buffer_load_dwordx4 v2, s[8:11], s55 offen offset:3072  lds
    s_add_u32 m0, s61, 69632
    s_add_u32 s55, s66, 626688
    buffer_load_dwordx4 v2, s[8:11], s55 offen offset:0  lds
    buffer_load_dwordx4 v2, s[8:11], s55 offen offset:1024  lds
    buffer_load_dwordx4 v2, s[8:11], s55 offen offset:2048  lds
    buffer_load_dwordx4 v2, s[8:11], s55 offen offset:3072  lds
    s_add_u32 m0, s62, 32768
    s_mov_b32 s55, 1441792
    s_cmp_eq_u32 s63, 1
    s_cmov_b32 s55, 1671168
    buffer_load_dwordx4 v4, s[12:15], s55 offen offset:0  lds
    buffer_load_dwordx4 v5, s[12:15], s55 offen offset:1024  lds
    buffer_load_dwordx4 v6, s[12:15], s55 offen offset:2048  lds
    buffer_load_dwordx4 v7, s[12:15], s55 offen offset:3072  lds
    s_waitcnt vmcnt(12)
    s_barrier
    s_mov_b32 s55, 16
    s_cmp_eq_u32 s63, 1
    s_cmov_b32 s55, 18
    s_add_u32 s55, s55, s64
    s_lshl_b64 s[78:79], 1, s55
    s_andn2_b64 s[80:81], s[78:79], s[74:75]
    s_cbranch_scc0 K1_ok_57
    s_swappc_b64 s[82:83], s[84:85]
K1_ok_57:
    s_add_u32 m0, s61, 0
    s_add_u32 s55, s66, 655360
    buffer_load_dwordx4 v2, s[8:11], s55 offen offset:0  lds
    buffer_load_dwordx4 v2, s[8:11], s55 offen offset:1024  lds
    buffer_load_dwordx4 v2, s[8:11], s55 offen offset:2048  lds
    buffer_load_dwordx4 v2, s[8:11], s55 offen offset:3072  lds
    s_add_u32 m0, s61, 4096
    s_add_u32 s55, s66, 659456
    buffer_load_dwordx4 v2, s[8:11], s55 offen offset:0  lds
    buffer_load_dwordx4 v2, s[8:11], s55 offen offset:1024  lds
    buffer_load_dwordx4 v2, s[8:11], s55 offen offset:2048  lds
    buffer_load_dwordx4 v2, s[8:11], s55 offen offset:3072  lds
    s_add_u32 m0, s62, 0
    s_mov_b32 s55, 1900544
    s_cmp_eq_u32 s63, 1
    s_cmov_b32 s55, 2129920
    buffer_load_dwordx4 v4, s[12:15], s55 offen offset:0  lds
    buffer_load_dwordx4 v5, s[12:15], s55 offen offset:1024  lds
    buffer_load_dwordx4 v6, s[12:15], s55 offen offset:2048  lds
    buffer_load_dwordx4 v7, s[12:15], s55 offen offset:3072  lds
    s_waitcnt vmcnt(12)
    s_barrier
    s_mov_b32 s55, 20
    s_cmp_eq_u32 s63, 1
    s_cmov_b32 s55, 22
    s_add_u32 s55, s55, s64
    s_lshl_b64 s[78:79], 1, s55
    s_andn2_b64 s[80:81], s[78:79], s[74:75]
    s_cbranch_scc0 K1_ok_58
    s_swappc_b64 s[82:83], s[84:85]
K1_ok_58:
    s_add_u32 m0, s61, 32768
    s_add_u32 s55, s66, 688128
    buffer_load_dwordx4 v2, s[8:11], s55 offen offset:0  lds
    buffer_load_dwordx4 v2, s[8:11], s55 offen offset:1024  lds
    buffer_load_dwordx4 v2, s[8:11], s55 offen offset:2048  lds
    buffer_load_dwordx4 v2, s[8:11], s55 offen offset:3072  lds
    s_add_u32 m0, s61, 36864
    s_add_u32 s55, s66, 692224
    buffer_load_dwordx4 v2, s[8:11], s55 offen offset:0  lds
    buffer_load_dwordx4 v2, s[8:11], s55 offen offset:1024  lds
    buffer_load_dwordx4 v2, s[8:11], s55 offen offset:2048  lds
    buffer_load_dwordx4 v2, s[8:11], s55 offen offset:3072  lds
    s_add_u32 m0, s62, 16384
    s_mov_b32 s55, 2359296
    s_cmp_eq_u32 s63, 1
    s_cmov_b32 s55, 2588672
    buffer_load_dwordx4 v4, s[12:15], s55 offen offset:0  lds
    buffer_load_dwordx4 v5, s[12:15], s55 offen offset:1024  lds
    buffer_load_dwordx4 v6, s[12:15], s55 offen offset:2048  lds
    buffer_load_dwordx4 v7, s[12:15], s55 offen offset:3072  lds
    s_waitcnt vmcnt(12)
    s_barrier
    s_mov_b32 s55, 24
    s_cmp_eq_u32 s63, 1
    s_cmov_b32 s55, 26
    s_add_u32 s55, s55, s64
    s_lshl_b64 s[78:79], 1, s55
    s_andn2_b64 s[80:81], s[78:79], s[74:75]
    s_cbranch_scc0 K1_ok_59
    s_swappc_b64 s[82:83], s[84:85]
K1_ok_59:
    s_add_u32 m0, s61, 65536
    s_add_u32 s55, s66, 720896
    buffer_load_dwordx4 v2, s[8:11], s55 offen offset:0  lds
    buffer_load_dwordx4 v2, s[8:11], s55 offen offset:1024  lds
    buffer_load_dwordx4 v2, s[8:11], s55 offen offset:2048  lds
    buffer_load_dwordx4 v2, s[8:11], s55 offen offset:3072  lds
    s_add_u32 m0, s61, 69632
    s_add_u32 s55, s66, 724992
    buffer_load_dwordx4 v2, s[8:11], s55 offen offset:0  lds
    buffer_load_dwordx4 v2, s[8:11], s55 offen offset:1024  lds
    buffer_load_dwordx4 v2, s[8:11], s55 offen offset:2048  lds
    buffer_load_dwordx4 v2, s[8:11], s55 offen offset:3072  lds
    s_add_u32 m0, s62, 32768
    s_mov_b32 s55, 2818048
    s_cmp_eq_u32 s63, 1
    s_cmov_b32 s55, 3047424
    buffer_load_dwordx4 v4, s[12:15], s55 offen offset:0  lds
    buffer_load_dwordx4 v5, s[12:15], s55 offen offset:1024  lds
    buffer_load_dwordx4 v6, s[12:15], s55 offen offset:2048  lds
    buffer_load_dwordx4 v7, s[12:15], s55 offen offset:3072  lds
    s_waitcnt vmcnt(12)
    s_barrier
    s_mov_b32 s55, 28
    s_cmp_eq_u32 s63, 1
    s_cmov_b32 s55, 30
    s_add_u32 s55, s55, s64
    s_lshl_b64 s[78:79], 1, s55
    s_andn2_b64 s[80:81], s[78:79], s[74:75]
    s_cbranch_scc0 K1_ok_60
    s_swappc_b64 s[82:83], s[84:85]
K1_ok_60:
    s_add_u32 m0, s61, 0
    s_add_u32 s55, s66, 753664
    buffer_load_dwordx4 v2, s[8:11], s55 offen offset:0  lds
    buffer_load_dwordx4 v2, s[8:11], s55 offen offset:1024  lds
    buffer_load_dwordx4 v2, s[8:11], s55 offen offset:2048  lds
    buffer_load_dwordx4 v2, s[8:11], s55 offen offset:3072  lds
    s_add_u32 m0, s61, 4096
    s_add_u32 s55, s66, 757760
    buffer_load_dwordx4 v2, s[8:11], s55 offen offset:0  lds
    buffer_load_dwordx4 v2, s[8:11], s55 offen offset:1024  lds
    buffer_load_dwordx4 v2, s[8:11], s55 offen offset:2048  lds
    buffer_load_dwordx4 v2, s[8:11], s55 offen offset:3072  lds
    s_add_u32 m0, s62, 0
    s_mov_b32 s55, 3276800
    s_cmp_eq_u32 s63, 1
    s_cmov_b32 s55, 3506176
    buffer_load_dwordx4 v4, s[12:15], s55 offen offset:0  lds
    buffer_load_dwordx4 v5, s[12:15], s55 offen offset:1024  lds
    buffer_load_dwordx4 v6, s[12:15], s55 offen offset:2048  lds
    buffer_load_dwordx4 v7, s[12:15], s55 offen offset:3072  lds
    s_waitcnt vmcnt(12)
    s_barrier
    s_mov_b32 s55, 32
    s_cmp_eq_u32 s63, 1
    s_cmov_b32 s55, 34
    s_add_u32 s55, s55, s64
    s_lshl_b64 s[78:79], 1, s55
    s_andn2_b64 s[80:81], s[78:79], s[74:75]
    s_cbranch_scc0 K1_ok_61
    s_swappc_b64 s[82:83], s[84:85]
K1_ok_61:
    s_add_u32 m0, s61, 32768
    s_add_u32 s55, s66, 786432
    buffer_load_dwordx4 v2, s[8:11], s55 offen offset:0  lds
    buffer_load_dwordx4 v2, s[8:11], s55 offen offset:1024  lds
    buffer_load_dwordx4 v2, s[8:11], s55 offen offset:2048  lds
    buffer_load_dwordx4 v2, s[8:11], s55 offen offset:3072  lds
    s_add_u32 m0, s61, 36864
    s_add_u32 s55, s66, 790528
    buffer_load_dwordx4 v2, s[8:11], s55 offen offset:0  lds
    buffer_load_dwordx4 v2, s[8:11], s55 offen offset:1024  lds
    buffer_load_dwordx4 v2, s[8:11], s55 offen offset:2048  lds
    buffer_load_dwordx4 v2, s[8:11], s55 offen offset:3072  lds
    s_add_u32 m0, s62, 16384
    s_mov_b32 s55, 3735552
    s_cmp_eq_u32 s63, 1
    s_cmov_b32 s55, 3964928
    buffer_load_dwordx4 v4, s[12:15], s55 offen offset:0  lds
    buffer_load_dwordx4 v5, s[12:15], s55 offen offset:1024  lds
    buffer_load_dwordx4 v6, s[12:15], s55 offen offset:2048  lds
    buffer_load_dwordx4 v7, s[12:15], s55 offen offset:3072  lds
    s_waitcnt vmcnt(12)
    s_barrier
    s_mov_b32 s55, 36
    s_cmp_eq_u32 s63, 1
    s_cmov_b32 s55, 38
    s_add_u32 s55, s55, s64
    s_lshl_b64 s[78:79], 1, s55
    s_andn2_b64 s[80:81], s[78:79], s[74:75]
    s_cbranch_scc0 K1_ok_62
    s_swappc_b64 s[82:83], s[84:85]
K1_ok_62:
    s_add_u32 m0, s61, 65536
    s_add_u32 s55, s66, 819200
    buffer_load_dwordx4 v2, s[8:11], s55 offen offset:0  lds
    buffer_load_dwordx4 v2, s[8:11], s55 offen offset:1024  lds
    buffer_load_dwordx4 v2, s[8:11], s55 offen offset:2048  lds
    buffer_load_dwordx4 v2, s[8:11], s55 offen offset:3072  lds
    s_add_u32 m0, s61, 69632
    s_add_u32 s55, s66, 823296
    buffer_load_dwordx4 v2, s[8:11], s55 offen offset:0  lds
    buffer_load_dwordx4 v2, s[8:11], s55 offen offset:1024  lds
    buffer_load_dwordx4 v2, s[8:11], s55 offen offset:2048  lds
    buffer_load_dwordx4 v2, s[8:11], s55 offen offset:3072  lds
    s_add_u32 m0, s62, 32768
    s_mov_b32 s55, 4194304
    s_cmp_eq_u32 s63, 1
    s_cmov_b32 s55, 4423680
    buffer_load_dwordx4 v4, s[12:15], s55 offen offset:0  lds
    buffer_load_dwordx4 v5, s[12:15], s55 offen offset:1024  lds
    buffer_load_dwordx4 v6, s[12:15], s55 offen offset:2048  lds
    buffer_load_dwordx4 v7, s[12:15], s55 offen offset:3072  lds
    s_waitcnt vmcnt(12)
    s_barrier
    s_mov_b32 s55, 40
    s_cmp_eq_u32 s63, 1
    s_cmov_b32 s55, 42
    s_add_u32 s55, s55, s64
    s_lshl_b64 s[78:79], 1, s55
    s_andn2_b64 s[80:81], s[78:79], s[74:75]
    s_cbranch_scc0 K1_ok_63
    s_swappc_b64 s[82:83], s[84:85]
K1_ok_63:
    s_add_u32 m0, s61, 0
    s_add_u32 s55, s66, 851968
    buffer_load_dwordx4 v2, s[8:11], s55 offen offset:0  lds
    buffer_load_dwordx4 v2, s[8:11], s55 offen offset:1024  lds
    buffer_load_dwordx4 v2, s[8:11], s55 offen offset:2048  lds
    buffer_load_dwordx4 v2, s[8:11], s55 offen offset:3072  lds
    s_add_u32 m0, s61, 4096
    s_add_u32 s55, s66, 856064
    buffer_load_dwordx4 v2, s[8:11], s55 offen offset:0  lds
    buffer_load_dwordx4 v2, s[8:11], s55 offen offset:1024  lds
    buffer_load_dwordx4 v2, s[8:11], s55 offen offset:2048  lds
    buffer_load_dwordx4 v2, s[8:11], s55 offen offset:3072  lds
    s_add_u32 m0, s62, 0
    s_mov_b32 s55, 4653056
    s_cmp_eq_u32 s63, 1
    s_cmov_b32 s55, 4882432
    buffer_load_dwordx4 v4, s[12:15], s55 offen offset:0  lds
    buffer_load_dwordx4 v5, s[12:15], s55 offen offset:1024  lds
    buffer_load_dwordx4 v6, s[12:15], s55 offen offset:2048  lds
    buffer_load_dwordx4 v7, s[12:15], s55 offen offset:3072  lds
    s_waitcnt vmcnt(12)
    s_barrier
    s_mov_b32 s55, 44
    s_cmp_eq_u32 s63, 1
    s_cmov_b32 s55, 46
    s_add_u32 s55, s55, s64
    s_lshl_b64 s[78:79], 1, s55
    s_andn2_b64 s[80:81], s[78:79], s[74:75]
    s_cbranch_scc0 K1_ok_64
    s_swappc_b64 s[82:83], s[84:85]
K1_ok_64:
    s_add_u32 m0, s61, 32768
    s_add_u32 s55, s66, 884736
    buffer_load_dwordx4 v2, s[8:11], s55 offen offset:0  lds
    buffer_load_dwordx4 v2, s[8:11], s55 offen offset:1024  lds
    buffer_load_dwordx4 v2, s[8:11], s55 offen offset:2048  lds
    buffer_load_dwordx4 v2, s[8:11], s55 offen offset:3072  lds
    s_add_u32 m0, s61, 36864
    s_add_u32 s55, s66, 888832
    buffer_load_dwordx4 v2, s[8:11], s55 offen offset:0  lds
    buffer_load_dwordx4 v2, s[8:11], s55 offen offset:1024  lds
    buffer_load_dwordx4 v2, s[8:11], s55 offen offset:2048  lds
    buffer_load_dwordx4 v2, s[8:11], s55 offen offset:3072  lds
    s_add_u32 m0, s62, 16384
    s_mov_b32 s55, 5111808
    s_cmp_eq_u32 s63, 1
    s_cmov_b32 s55, 5341184
    buffer_load_dwordx4 v4, s[12:15], s55 offen offset:0  lds
    buffer_load_dwordx4 v5, s[12:15], s55 offen offset:1024  lds
    buffer_load_dwordx4 v6, s[12:15], s55 offen offset:2048  lds
    buffer_load_dwordx4 v7, s[12:15], s55 offen offset:3072  lds
    s_waitcnt vmcnt(12)
    s_barrier
    s_mov_b32 s55, 48
    s_cmp_eq_u32 s63, 1
    s_cmov_b32 s55, 50
    s_add_u32 s55, s55, s64
    s_lshl_b64 s[78:79], 1, s55
    s_andn2_b64 s[80:81], s[78:79], s[74:75]
    s_cbranch_scc0 K1_ok_65
    s_swappc_b64 s[82:83], s[84:85]
K1_ok_65:
    s_add_u32 m0, s61, 65536
    s_add_u32 s55, s66, 917504
    buffer_load_dwordx4 v2, s[8:11], s55 offen offset:0  lds
    buffer_load_dwordx4 v2, s[8:11], s55 offen offset:1024  lds
    buffer_load_dwordx4 v2, s[8:11], s55 offen offset:2048  lds
    buffer_load_dwordx4 v2, s[8:11], s55 offen offset:3072  lds
    s_add_u32 m0, s61, 69632
    s_add_u32 s55, s66, 921600
    buffer_load_dwordx4 v2, s[8:11], s55 offen offset:0  lds
    buffer_load_dwordx4 v2, s[8:11], s55 offen offset:1024  lds
    buffer_load_dwordx4 v2, s[8:11], s55 offen offset:2048  lds
    buffer_load_dwordx4 v2, s[8:11], s55 offen offset:3072  lds
    s_add_u32 m0, s62, 32768
    s_mov_b32 s55, 5570560
    s_cmp_eq_u32 s63, 1
    s_cmov_b32 s55, 5799936
    buffer_load_dwordx4 v4, s[12:15], s55 offen offset:0  lds
    buffer_load_dwordx4 v5, s[12:15], s55 offen offset:1024  lds
    buffer_load_dwordx4 v6, s[12:15], s55 offen offset:2048  lds
    buffer_load_dwordx4 v7, s[12:15], s55 offen offset:3072  lds
    s_waitcnt vmcnt(12)
    s_barrier
    s_mov_b32 s55, 52
    s_cmp_eq_u32 s63, 1
    s_cmov_b32 s55, 54
    s_add_u32 s55, s55, s64
    s_lshl_b64 s[78:79], 1, s55
    s_andn2_b64 s[80:81], s[78:79], s[74:75]
    s_cbranch_scc0 K1_ok_66
    s_swappc_b64 s[82:83], s[84:85]
K1_ok_66:
    s_add_u32 m0, s61, 0
    s_add_u32 s55, s66, 950272
    buffer_load_dwordx4 v2, s[8:11], s55 offen offset:0  lds
    buffer_load_dwordx4 v2, s[8:11], s55 offen offset:1024  lds
    buffer_load_dwordx4 v2, s[8:11], s55 offen offset:2048  lds
    buffer_load_dwordx4 v2, s[8:11], s55 offen offset:3072  lds
    s_add_u32 m0, s61, 4096
    s_add_u32 s55, s66, 954368
    buffer_load_dwordx4 v2, s[8:11], s55 offen offset:0  lds
    buffer_load_dwordx4 v2, s[8:11], s55 offen offset:1024  lds
    buffer_load_dwordx4 v2, s[8:11], s55 offen offset:2048  lds
    buffer_load_dwordx4 v2, s[8:11], s55 offen offset:3072  lds
    s_add_u32 m0, s62, 0
    s_mov_b32 s55, 6029312
    s_cmp_eq_u32 s63, 1
    s_cmov_b32 s55, 6258688
    buffer_load_dwordx4 v4, s[12:15], s55 offen offset:0  lds
    buffer_load_dwordx4 v5, s[12:15], s55 offen offset:1024  lds
    buffer_load_dwordx4 v6, s[12:15], s55 offen offset:2048  lds
    buffer_load_dwordx4 v7, s[12:15], s55 offen offset:3072  lds
    s_waitcnt vmcnt(12)
    s_barrier
    s_mov_b32 s55, 56
    s_cmp_eq_u32 s63, 1
    s_cmov_b32 s55, 58
    s_add_u32 s55, s55, s64
    s_lshl_b64 s[78:79], 1, s55
    s_andn2_b64 s[80:81], s[78:79], s[74:75]
    s_cbranch_scc0 K1_ok_67
    s_swappc_b64 s[82:83], s[84:85]
K1_ok_67:
    s_add_u32 m0, s61, 32768
    s_add_u32 s55, s66, 983040
    buffer_load_dwordx4 v2, s[8:11], s55 offen offset:0  lds
    buffer_load_dwordx4 v2, s[8:11], s55 offen offset:1024  lds
    buffer_load_dwordx4 v2, s[8:11], s55 offen offset:2048  lds
    buffer_load_dwordx4 v2, s[8:11], s55 offen offset:3072  lds
    s_add_u32 m0, s61, 36864
    s_add_u32 s55, s66, 987136
    buffer_load_dwordx4 v2, s[8:11], s55 offen offset:0  lds
    buffer_load_dwordx4 v2, s[8:11], s55 offen offset:1024  lds
    buffer_load_dwordx4 v2, s[8:11], s55 offen offset:2048  lds
    buffer_load_dwordx4 v2, s[8:11], s55 offen offset:3072  lds
    s_add_u32 m0, s62, 16384
    s_mov_b32 s55, 6488064
    s_cmp_eq_u32 s63, 1
    s_cmov_b32 s55, 6717440
    buffer_load_dwordx4 v4, s[12:15], s55 offen offset:0  lds
    buffer_load_dwordx4 v5, s[12:15], s55 offen offset:1024  lds
    buffer_load_dwordx4 v6, s[12:15], s55 offen offset:2048  lds
    buffer_load_dwordx4 v7, s[12:15], s55 offen offset:3072  lds
    s_waitcnt vmcnt(12)
    s_barrier
    s_mov_b32 s55, 60
    s_cmp_eq_u32 s63, 1
    s_cmov_b32 s55, 62
    s_add_u32 s55, s55, s64
    s_lshl_b64 s[78:79], 1, s55
    s_andn2_b64 s[80:81], s[78:79], s[74:75]
    s_cbranch_scc0 K1_ok_68
    s_swappc_b64 s[82:83], s[84:85]
K1_ok_68:
    s_add_u32 m0, s61, 65536
    s_add_u32 s55, s66, 1015808
    buffer_load_dwordx4 v2, s[8:11], s55 offen offset:0  lds
    buffer_load_dwordx4 v2, s[8:11], s55 offen offset:1024  lds
    buffer_load_dwordx4 v2, s[8:11], s55 offen offset:2048  lds
    buffer_load_dwordx4 v2, s[8:11], s55 offen offset:3072  lds
    s_add_u32 m0, s61, 69632
    s_add_u32 s55, s66, 1019904
    buffer_load_dwordx4 v2, s[8:11], s55 offen offset:0  lds
    buffer_load_dwordx4 v2, s[8:11], s55 offen offset:1024  lds
    buffer_load_dwordx4 v2, s[8:11], s55 offen offset:2048  lds
    buffer_load_dwordx4 v2, s[8:11], s55 offen offset:3072  lds
    s_add_u32 m0, s62, 32768
    s_mov_b32 s55, 6946816
    s_cmp_eq_u32 s63, 1
    s_cmov_b32 s55, 7176192
    buffer_load_dwordx4 v4, s[12:15], s55 offen offset:0  lds
    buffer_load_dwordx4 v5, s[12:15], s55 offen offset:1024  lds
    buffer_load_dwordx4 v6, s[12:15], s55 offen offset:2048  lds
    buffer_load_dwordx4 v7, s[12:15], s55 offen offset:3072  lds
    s_waitcnt vmcnt(12)
    s_barrier
    s_mov_b32 s55, 0
    s_cmp_eq_u32 s63, 1
    s_cmov_b32 s55, 2
    s_add_u32 s55, s55, s64
    s_lshl_b64 s[78:79], 1, s55
    s_andn2_b64 s[80:81], s[78:79], s[74:75]
    s_cbranch_scc0 K1_ok_69
    s_swappc_b64 s[82:83], s[84:85]
K1_ok_69:
    s_add_u32 m0, s61, 0
    s_add_u32 s55, s66, 1048576
    buffer_load_dwordx4 v2, s[8:11], s55 offen offset:0  lds
    buffer_load_dwordx4 v2, s[8:11], s55 offen offset:1024  lds
    buffer_load_dwordx4 v2, s[8:11], s55 offen offset:2048  lds
    buffer_load_dwordx4 v2, s[8:11], s55 offen offset:3072  lds
    s_add_u32 m0, s61, 4096
    s_add_u32 s55, s66, 1052672
    buffer_load_dwordx4 v2, s[8:11], s55 offen offset:0  lds
    buffer_load_dwordx4 v2, s[8:11], s55 offen offset:1024  lds
    buffer_load_dwordx4 v2, s[8:11], s55 offen offset:2048  lds
    buffer_load_dwordx4 v2, s[8:11], s55 offen offset:3072  lds
    s_add_u32 m0, s62, 0
    s_mov_b32 s55, 131072
    s_cmp_eq_u32 s63, 1
    s_cmov_b32 s55, 360448
    buffer_load_dwordx4 v4, s[12:15], s55 offen offset:0  lds
    buffer_load_dwordx4 v5, s[12:15], s55 offen offset:1024  lds
    buffer_load_dwordx4 v6, s[12:15], s55 offen offset:2048  lds
    buffer_load_dwordx4 v7, s[12:15], s55 offen offset:3072  lds
    s_waitcnt vmcnt(12)
    s_barrier
    s_mov_b32 s55, 4
    s_cmp_eq_u32 s63, 1
    s_cmov_b32 s55, 6
    s_add_u32 s55, s55, s64
    s_lshl_b64 s[78:79], 1, s55
    s_andn2_b64 s[80:81], s[78:79], s[74:75]
    s_cbranch_scc0 K1_ok_70
    s_swappc_b64 s[82:83], s[84:85]
K1_ok_70:
    s_add_u32 m0, s61, 32768
    s_add_u32 s55, s66, 1081344
    buffer_load_dwordx4 v2, s[8:11], s55 offen offset:0  lds
    buffer_load_dwordx4 v2, s[8:11], s55 offen offset:1024  lds
    buffer_load_dwordx4 v2, s[8:11], s55 offen offset:2048  lds
    buffer_load_dwordx4 v2, s[8:11], s55 offen offset:3072  lds
    s_add_u32 m0, s61, 36864
    s_add_u32 s55, s66, 1085440
    buffer_load_dwordx4 v2, s[8:11], s55 offen offset:0  lds
    buffer_load_dwordx4 v2, s[8:11], s55 offen offset:1024  lds
    buffer_load_dwordx4 v2, s[8:11], s55 offen offset:2048  lds
    buffer_load_dwordx4 v2, s[8:11], s55 offen offset:3072  lds
    s_add_u32 m0, s62, 16384
    s_mov_b32 s55, 589824
    s_cmp_eq_u32 s63, 1
    s_cmov_b32 s55, 819200
    buffer_load_dwordx4 v4, s[12:15], s55 offen offset:0  lds
    buffer_load_dwordx4 v5, s[12:15], s55 offen offset:1024  lds
    buffer_load_dwordx4 v6, s[12:15], s55 offen offset:2048  lds
    buffer_load_dwordx4 v7, s[12:15], s55 offen offset:3072  lds
    s_waitcnt vmcnt(12)
    s_barrier
    s_mov_b32 s55, 8
    s_cmp_eq_u32 s63, 1
    s_cmov_b32 s55, 10
    s_add_u32 s55, s55, s64
    s_lshl_b64 s[78:79], 1, s55
    s_andn2_b64 s[80:81], s[78:79], s[74:75]
    s_cbranch_scc0 K1_ok_71
    s_swappc_b64 s[82:83], s[84:85]
K1_ok_71:
    s_add_u32 m0, s61, 65536
    s_add_u32 s55, s66, 1114112
    buffer_load_dwordx4 v2, s[8:11], s55 offen offset:0  lds
    buffer_load_dwordx4 v2, s[8:11], s55 offen offset:1024  lds
    buffer_load_dwordx4 v2, s[8:11], s55 offen offset:2048  lds
    buffer_load_dwordx4 v2, s[8:11], s55 offen offset:3072  lds
    s_add_u32 m0, s61, 69632
    s_add_u32 s55, s66, 1118208
    buffer_load_dwordx4 v2, s[8:11], s55 offen offset:0  lds
    buffer_load_dwordx4 v2, s[8:11], s55 offen offset:1024  lds
    buffer_load_dwordx4 v2, s[8:11], s55 offen offset:2048  lds
    buffer_load_dwordx4 v2, s[8:11], s55 offen offset:3072  lds
    s_add_u32 m0, s62, 32768
    s_mov_b32 s55, 1048576
    s_cmp_eq_u32 s63, 1
    s_cmov_b32 s55, 1277952
    buffer_load_dwordx4 v4, s[12:15], s55 offen offset:0  lds
    buffer_load_dwordx4 v5, s[12:15], s55 offen offset:1024  lds
    buffer_load_dwordx4 v6, s[12:15], s55 offen offset:2048  lds
    buffer_load_dwordx4 v7, s[12:15], s55 offen offset:3072  lds
    s_waitcnt vmcnt(12)
    s_barrier
    s_mov_b32 s55, 12
    s_cmp_eq_u32 s63, 1
    s_cmov_b32 s55, 14
    s_add_u32 s55, s55, s64
    s_lshl_b64 s[78:79], 1, s55
    s_andn2_b64 s[80:81], s[78:79], s[74:75]
    s_cbranch_scc0 K1_ok_72
    s_swappc_b64 s[82:83], s[84:85]
K1_ok_72:
    s_add_u32 m0, s61, 0
    s_add_u32 s55, s66, 1146880
    buffer_load_dwordx4 v2, s[8:11], s55 offen offset:0  lds
    buffer_load_dwordx4 v2, s[8:11], s55 offen offset:1024  lds
    buffer_load_dwordx4 v2, s[8:11], s55 offen offset:2048  lds
    buffer_load_dwordx4 v2, s[8:11], s55 offen offset:3072  lds
    s_add_u32 m0, s61, 4096
    s_add_u32 s55, s66, 1150976
    buffer_load_dwordx4 v2, s[8:11], s55 offen offset:0  lds
    buffer_load_dwordx4 v2, s[8:11], s55 offen offset:1024  lds
    buffer_load_dwordx4 v2, s[8:11], s55 offen offset:2048  lds
    buffer_load_dwordx4 v2, s[8:11], s55 offen offset:3072  lds
    s_add_u32 m0, s62, 0
    s_mov_b32 s55, 1507328
    s_cmp_eq_u32 s63, 1
    s_cmov_b32 s55, 1736704
    buffer_load_dwordx4 v4, s[12:15], s55 offen offset:0  lds
    buffer_load_dwordx4 v5, s[12:15], s55 offen offset:1024  lds
    buffer_load_dwordx4 v6, s[12:15], s55 offen offset:2048  lds
    buffer_load_dwordx4 v7, s[12:15], s55 offen offset:3072  lds
    s_waitcnt vmcnt(12)
    s_barrier
    s_mov_b32 s55, 16
    s_cmp_eq_u32 s63, 1
    s_cmov_b32 s55, 18
    s_add_u32 s55, s55, s64
    s_lshl_b64 s[78:79], 1, s55
    s_andn2_b64 s[80:81], s[78:79], s[74:75]
    s_cbranch_scc0 K1_ok_73
    s_swappc_b64 s[82:83], s[84:85]
K1_ok_73:
    s_add_u32 m0, s61, 32768
    s_add_u32 s55, s66, 1179648
    buffer_load_dwordx4 v2, s[8:11], s55 offen offset:0  lds
    buffer_load_dwordx4 v2, s[8:11], s55 offen offset:1024  lds
    buffer_load_dwordx4 v2, s[8:11], s55 offen offset:2048  lds
    buffer_load_dwordx4 v2, s[8:11], s55 offen offset:3072  lds
    s_add_u32 m0, s61, 36864
    s_add_u32 s55, s66, 1183744
    buffer_load_dwordx4 v2, s[8:11], s55 offen offset:0  lds
    buffer_load_dwordx4 v2, s[8:11], s55 offen offset:1024  lds
    buffer_load_dwordx4 v2, s[8:11], s55 offen offset:2048  lds
    buffer_load_dwordx4 v2, s[8:11], s55 offen offset:3072  lds
    s_add_u32 m0, s62, 16384
    s_mov_b32 s55, 1966080
    s_cmp_eq_u32 s63, 1
    s_cmov_b32 s55, 2195456
    buffer_load_dwordx4 v4, s[12:15], s55 offen offset:0  lds
    buffer_load_dwordx4 v5, s[12:15], s55 offen offset:1024  lds
    buffer_load_dwordx4 v6, s[12:15], s55 offen offset:2048  lds
    buffer_load_dwordx4 v7, s[12:15], s55 offen offset:3072  lds
    s_waitcnt vmcnt(12)
    s_barrier
    s_waitcnt vmcnt(0)
    s_barrier
    s_barrier
    s_mov_b32 s59, 0
    s_mov_b32 s70, 0
    s_branch K2_final
K2_l3:
    s_barrier
    s_lshl_b32 s69, s64, 15
    s_lshl_b32 s55, s35, 8
    s_add_u32 s69, s69, s55
    v_lshrrev_b32 v12, 4, v1
    v_bfe_u32 v14, v1, 1, 3
    v_xor_b32 v13, v12, v14
    v_lshlrev_b32 v13, 5, v13
    v_lshl_add_u32 v13, v12, 11, v13
    v_and_b32 v14, 1, v1
    v_lshl_add_u32 v13, v14, 4, v13
    v_add_u32 v4, s69, v13
    v_xor_b32 v13, 128, v4
    v_add_u32 v5, 7168, v13
    v_add_u32 v6, 14336, v4
    v_add_u32 v7, 14336, v5
    s_add_u32 m0, s62, 0
    s_mov_b32 s55, 3670016
    s_cmp_eq_u32 s63, 1
    s_cmov_b32 s55, 3899392
    buffer_load_dwordx4 v4, s[12:15], s55 offen offset:0  lds
    buffer_load_dwordx4 v5, s[12:15], s55 offen offset:1024  lds
    buffer_load_dwordx4 v6, s[12:15], s55 offen offset:2048  lds
    buffer_load_dwordx4 v7, s[12:15], s55 offen offset:3072  lds
    s_add_u32 m0, s62, 16384
    s_mov_b32 s55, 4128768
    s_cmp_eq_u32 s63, 1
    s_cmov_b32 s55, 4358144
    buffer_load_dwordx4 v4, s[12:15], s55 offen offset:0  lds
    buffer_load_dwordx4 v5, s[12:15], s55 offen offset:1024  lds
    buffer_load_dwordx4 v6, s[12:15], s55 offen offset:2048  lds
    buffer_load_dwordx4 v7, s[12:15], s55 offen offset:3072  lds
    s_add_u32 m0, s62, 32768
    s_mov_b32 s55, 4587520
    s_cmp_eq_u32 s63, 1
    s_cmov_b32 s55, 4816896
    buffer_load_dwordx4 v4, s[12:15], s55 offen offset:0  lds
    buffer_load_dwordx4 v5, s[12:15], s55 offen offset:1024  lds
    buffer_load_dwordx4 v6, s[12:15], s55 offen offset:2048  lds
    buffer_load_dwordx4 v7, s[12:15], s55 offen offset:3072  lds
    s_sleep 1
    s_mov_b32 s55, 32
    s_cmp_eq_u32 s63, 1
    s_cmov_b32 s55, 34
    s_add_u32 s55, s55, s64
    s_lshl_b64 s[78:79], 1, s55
    s_andn2_b64 s[80:81], s[78:79], s[88:89]
    s_cbranch_scc0 K1_ok_74
    s_swappc_b64 s[82:83], s[92:93]
K1_ok_74:
    s_add_u32 m0, s61, 0
    s_add_u32 s55, s66, 262144
    buffer_load_dwordx4 v2, s[8:11], s55 offen offset:0  lds
    buffer_load_dwordx4 v2, s[8:11], s55 offen offset:1024  lds
    buffer_load_dwordx4 v2, s[8:11], s55 offen offset:2048  lds
    buffer_load_dwordx4 v2, s[8:11], s55 offen offset:3072  lds
    s_add_u32 m0, s61, 4096
    s_add_u32 s55, s66, 266240
    buffer_load_dwordx4 v2, s[8:11], s55 offen offset:0  lds
    buffer_load_dwordx4 v2, s[8:11], s55 offen offset:1024  lds
    buffer_load_dwordx4 v2, s[8:11], s55 offen offset:2048  lds
    buffer_load_dwordx4 v2, s[8:11], s55 offen offset:3072  lds
    s_mov_b32 s55, 36
    s_cmp_eq_u32 s63, 1
    s_cmov_b32 s55, 38
    s_add_u32 s55, s55, s64
    s_lshl_b64 s[78:79], 1, s55
    s_andn2_b64 s[80:81], s[78:79], s[88:89]
    s_cbranch_scc0 K1_ok_75
    s_swappc_b64 s[82:83], s[92:93]
K1_ok_75:
    s_add_u32 m0, s61, 32768
    s_add_u32 s55, s66, 294912
    buffer_load_dwordx4 v2, s[8:11], s55 offen offset:0  lds
    buffer_load_dwordx4 v2, s[8:11], s55 offen offset:1024  lds
    buffer_load_dwordx4 v2, s[8:11], s55 offen offset:2048  lds
    buffer_load_dwordx4 v2, s[8:11], s55 offen offset:3072  lds
    s_add_u32 m0, s61, 36864
    s_add_u32 s55, s66, 299008
    buffer_load_dwordx4 v2, s[8:11], s55 offen offset:0  lds
    buffer_load_dwordx4 v2, s[8:11], s55 offen offset:1024  lds
    buffer_load_dwordx4 v2, s[8:11], s55 offen offset:2048  lds
    buffer_load_dwordx4 v2, s[8:11], s55 offen offset:3072  lds
    s_waitcnt vmcnt(8)
    s_barrier
    s_mov_b32 s55, 40
    s_cmp_eq_u32 s63, 1
    s_cmov_b32 s55, 42
    s_add_u32 s55, s55, s64
    s_lshl_b64 s[78:79], 1, s55
    s_andn2_b64 s[80:81], s[78:79], s[88:89]
    s_cbranch_scc0 K1_ok_76
    s_swappc_b64 s[82:83], s[92:93]
K1_ok_76:
    s_add_u32 m0, s61, 65536
    s_add_u32 s55, s66, 327680
    buffer_load_dwordx4 v2, s[8:11], s55 offen offset:0  lds
    buffer_load_dwordx4 v2, s[8:11], s55 offen offset:1024  lds
    buffer_load_dwordx4 v2, s[8:11], s55 offen offset:2048  lds
    buffer_load_dwordx4 v2, s[8:11], s55 offen offset:3072  lds
    s_add_u32 m0, s61, 69632
    s_add_u32 s55, s66, 331776
    buffer_load_dwordx4 v2, s[8:11], s55 offen offset:0  lds
    buffer_load_dwordx4 v2, s[8:11], s55 offen offset:1024  lds
    buffer_load_dwordx4 v2, s[8:11], s55 offen offset:2048  lds
    buffer_load_dwordx4 v2, s[8:11], s55 offen offset:3072  lds
    s_waitcnt vmcnt(8)
    s_barrier
    s_mov_b32 s55, 44
    s_cmp_eq_u32 s63, 1
    s_cmov_b32 s55, 46
    s_add_u32 s55, s55, s64
    s_lshl_b64 s[78:79], 1, s55
    s_andn2_b64 s[80:81], s[78:79], s[88:89]
    s_cbranch_scc0 K1_ok_77
    s_swappc_b64 s[82:83], s[92:93]
K1_ok_77:
    s_add_u32 m0, s61, 0
    s_add_u32 s55, s66, 360448
    buffer_load_dwordx4 v2, s[8:11], s55 offen offset:0  lds
    buffer_load_dwordx4 v2, s[8:11], s55 offen offset:1024  lds
    buffer_load_dwordx4 v2, s[8:11], s55 offen offset:2048  lds
    buffer_load_dwordx4 v2, s[8:11], s55 offen offset:3072  lds
    s_add_u32 m0, s61, 4096
    s_add_u32 s55, s66, 364544
    buffer_load_dwordx4 v2, s[8:11], s55 offen offset:0  lds
    buffer_load_dwordx4 v2, s[8:11], s55 offen offset:1024  lds
    buffer_load_dwordx4 v2, s[8:11], s55 offen offset:2048  lds
    buffer_load_dwordx4 v2, s[8:11], s55 offen offset:3072  lds
    s_add_u32 m0, s62, 0
    s_mov_b32 s55, 5046272
    s_cmp_eq_u32 s63, 1
    s_cmov_b32 s55, 5275648
    buffer_load_dwordx4 v4, s[12:15], s55 offen offset:0  lds
    buffer_load_dwordx4 v5, s[12:15], s55 offen offset:1024  lds
    buffer_load_dwordx4 v6, s[12:15], s55 offen offset:2048  lds
    buffer_load_dwordx4 v7, s[12:15], s55 offen offset:3072  lds
    s_waitcnt vmcnt(12)
    s_barrier
    s_mov_b32 s55, 20
    s_cmp_eq_u32 s63, 1
    s_cmov_b32 s55, 22
    s_add_u32 s55, s55, s64
    s_lshl_b64 s[78:79], 1, s55
    s_andn2_b64 s[80:81], s[78:79], s[74:75]
    s_cbranch_scc0 K1_ok_78
    s_swappc_b64 s[82:83], s[84:85]
K1_ok_78:
    s_add_u32 m0, s61, 32768
    s_add_u32 s55, s66, 1212416
    buffer_load_dwordx4 v2, s[8:11], s55 offen offset:0  lds
    buffer_load_dwordx4 v2, s[8:11], s55 offen offset:1024  lds
    buffer_load_dwordx4 v2, s[8:11], s55 offen offset:2048  lds
    buffer_load_dwordx4 v2, s[8:11], s55 offen offset:3072  lds
    s_add_u32 m0, s61, 36864
    s_add_u32 s55, s66, 1216512
    buffer_load_dwordx4 v2, s[8:11], s55 offen offset:0  lds
    buffer_load_dwordx4 v2, s[8:11], s55 offen offset:1024  lds
    buffer_load_dwordx4 v2, s[8:11], s55 offen offset:2048  lds
    buffer_load_dwordx4 v2, s[8:11], s55 offen offset:3072  lds
    s_add_u32 m0, s62, 16384
    s_mov_b32 s55, 2424832
    s_cmp_eq_u32 s63, 1
    s_cmov_b32 s55, 2654208
    buffer_load_dwordx4 v4, s[12:15], s55 offen offset:0  lds
    buffer_load_dwordx4 v5, s[12:15], s55 offen offset:1024  lds
    buffer_load_dwordx4 v6, s[12:15], s55 offen offset:2048  lds
    buffer_load_dwordx4 v7, s[12:15], s55 offen offset:3072  lds
    s_waitcnt vmcnt(12)
    s_barrier
    s_mov_b32 s55, 24
    s_cmp_eq_u32 s63, 1
    s_cmov_b32 s55, 26
    s_add_u32 s55, s55, s64
    s_lshl_b64 s[78:79], 1, s55
    s_andn2_b64 s[80:81], s[78:79], s[74:75]
    s_cbranch_scc0 K1_ok_79
    s_swappc_b64 s[82:83], s[84:85]
K1_ok_79:
    s_add_u32 m0, s61, 65536
    s_add_u32 s55, s66, 1245184
    buffer_load_dwordx4 v2, s[8:11], s55 offen offset:0  lds
    buffer_load_dwordx4 v2, s[8:11], s55 offen offset:1024  lds
    buffer_load_dwordx4 v2, s[8:11], s55 offen offset:2048  lds
    buffer_load_dwordx4 v2, s[8:11], s55 offen offset:3072  lds
    s_add_u32 m0, s61, 69632
    s_add_u32 s55, s66, 1249280
    buffer_load_dwordx4 v2, s[8:11], s55 offen offset:0  lds
    buffer_load_dwordx4 v2, s[8:11], s55 offen offset:1024  lds
    buffer_load_dwordx4 v2, s[8:11], s55 offen offset:2048  lds
    buffer_load_dwordx4 v2, s[8:11], s55 offen offset:3072  lds
    s_add_u32 m0, s62, 32768
    s_mov_b32 s55, 2883584
    s_cmp_eq_u32 s63, 1
    s_cmov_b32 s55, 3112960
    buffer_load_dwordx4 v4, s[12:15], s55 offen offset:0  lds
    buffer_load_dwordx4 v5, s[12:15], s55 offen offset:1024  lds
    buffer_load_dwordx4 v6, s[12:15], s55 offen offset:2048  lds
    buffer_load_dwordx4 v7, s[12:15], s55 offen offset:3072  lds
    s_waitcnt vmcnt(12)
    s_barrier
    s_mov_b32 s55, 28
    s_cmp_eq_u32 s63, 1
    s_cmov_b32 s55, 30
    s_add_u32 s55, s55, s64
    s_lshl_b64 s[78:79], 1, s55
    s_andn2_b64 s[80:81], s[78:79], s[74:75]
    s_cbranch_scc0 K1_ok_80
    s_swappc_b64 s[82:83], s[84:85]
K1_ok_80:
    s_add_u32 m0, s61, 0
    s_add_u32 s55, s66, 1277952
    buffer_load_dwordx4 v2, s[8:11], s55 offen offset:0  lds
    buffer_load_dwordx4 v2, s[8:11], s55 offen offset:1024  lds
    buffer_load_dwordx4 v2, s[8:11], s55 offen offset:2048  lds
    buffer_load_dwordx4 v2, s[8:11], s55 offen offset:3072  lds
    s_add_u32 m0, s61, 4096
    s_add_u32 s55, s66, 1282048
    buffer_load_dwordx4 v2, s[8:11], s55 offen offset:0  lds
    buffer_load_dwordx4 v2, s[8:11], s55 offen offset:1024  lds
    buffer_load_dwordx4 v2, s[8:11], s55 offen offset:2048  lds
    buffer_load_dwordx4 v2, s[8:11], s55 offen offset:3072  lds
    s_add_u32 m0, s62, 0
    s_mov_b32 s55, 3342336
    s_cmp_eq_u32 s63, 1
    s_cmov_b32 s55, 3571712
    buffer_load_dwordx4 v4, s[12:15], s55 offen offset:0  lds
    buffer_load_dwordx4 v5, s[12:15], s55 offen offset:1024  lds
    buffer_load_dwordx4 v6, s[12:15], s55 offen offset:2048  lds
    buffer_load_dwordx4 v7, s[12:15], s55 offen offset:3072  lds
    s_waitcnt vmcnt(12)
    s_barrier
    s_mov_b32 s55, 32
    s_cmp_eq_u32 s63, 1
    s_cmov_b32 s55, 34
    s_add_u32 s55, s55, s64
    s_lshl_b64 s[78:79], 1, s55
    s_andn2_b64 s[80:81], s[78:79], s[74:75]
    s_cbranch_scc0 K1_ok_81
    s_swappc_b64 s[82:83], s[84:85]
K1_ok_81:
    s_add_u32 m0, s61, 32768
    s_add_u32 s55, s66, 1310720
    buffer_load_dwordx4 v2, s[8:11], s55 offen offset:0  lds
    buffer_load_dwordx4 v2, s[8:11], s55 offen offset:1024  lds
    buffer_load_dwordx4 v2, s[8:11], s55 offen offset:2048  lds
    buffer_load_dwordx4 v2, s[8:11], s55 offen offset:3072  lds
    s_add_u32 m0, s61, 36864
    s_add_u32 s55, s66, 1314816
    buffer_load_dwordx4 v2, s[8:11], s55 offen offset:0  lds
    buffer_load_dwordx4 v2, s[8:11], s55 offen offset:1024  lds
    buffer_load_dwordx4 v2, s[8:11], s55 offen offset:2048  lds
    buffer_load_dwordx4 v2, s[8:11], s55 offen offset:3072  lds
    s_add_u32 m0, s62, 16384
    s_mov_b32 s55, 3801088
    s_cmp_eq_u32 s63, 1
    s_cmov_b32 s55, 4030464
    buffer_load_dwordx4 v4, s[12:15], s55 offen offset:0  lds
    buffer_load_dwordx4 v5, s[12:15], s55 offen offset:1024  lds
    buffer_load_dwordx4 v6, s[12:15], s55 offen offset:2048  lds
    buffer_load_dwordx4 v7, s[12:15], s55 offen offset:3072  lds
    s_waitcnt vmcnt(12)
    s_barrier
    s_mov_b32 s55, 36
    s_cmp_eq_u32 s63, 1
    s_cmov_b32 s55, 38
    s_add_u32 s55, s55, s64
    s_lshl_b64 s[78:79], 1, s55
    s_andn2_b64 s[80:81], s[78:79], s[74:75]
    s_cbranch_scc0 K1_ok_82
    s_swappc_b64 s[82:83], s[84:85]
K1_ok_82:
    s_add_u32 m0, s61, 65536
    s_add_u32 s55, s66, 1343488
    buffer_load_dwordx4 v2, s[8:11], s55 offen offset:0  lds
    buffer_load_dwordx4 v2, s[8:11], s55 offen offset:1024  lds
    buffer_load_dwordx4 v2, s[8:11], s55 offen offset:2048  lds
    buffer_load_dwordx4 v2, s[8:11], s55 offen offset:3072  lds
    s_add_u32 m0, s61, 69632
    s_add_u32 s55, s66, 1347584
    buffer_load_dwordx4 v2, s[8:11], s55 offen offset:0  lds
    buffer_load_dwordx4 v2, s[8:11], s55 offen offset:1024  lds
    buffer_load_dwordx4 v2, s[8:11], s55 offen offset:2048  lds
    buffer_load_dwordx4 v2, s[8:11], s55 offen offset:3072  lds
    s_add_u32 m0, s62, 32768
    s_mov_b32 s55, 4259840
    s_cmp_eq_u32 s63, 1
    s_cmov_b32 s55, 4489216
    buffer_load_dwordx4 v4, s[12:15], s55 offen offset:0  lds
    buffer_load_dwordx4 v5, s[12:15], s55 offen offset:1024  lds
    buffer_load_dwordx4 v6, s[12:15], s55 offen offset:2048  lds
    buffer_load_dwordx4 v7, s[12:15], s55 offen offset:3072  lds
    s_waitcnt vmcnt(12)
    s_barrier
    s_mov_b32 s55, 40
    s_cmp_eq_u32 s63, 1
    s_cmov_b32 s55, 42
    s_add_u32 s55, s55, s64
    s_lshl_b64 s[78:79], 1, s55
    s_andn2_b64 s[80:81], s[78:79], s[74:75]
    s_cbranch_scc0 K1_ok_83
    s_swappc_b64 s[82:83], s[84:85]
K1_ok_83:
    s_add_u32 m0, s61, 0
    s_add_u32 s55, s66, 1376256
    buffer_load_dwordx4 v2, s[8:11], s55 offen offset:0  lds
    buffer_load_dwordx4 v2, s[8:11], s55 offen offset:1024  lds
    buffer_load_dwordx4 v2, s[8:11], s55 offen offset:2048  lds
    buffer_load_dwordx4 v2, s[8:11], s55 offen offset:3072  lds
    s_add_u32 m0, s61, 4096
    s_add_u32 s55, s66, 1380352
    buffer_load_dwordx4 v2, s[8:11], s55 offen offset:0  lds
    buffer_load_dwordx4 v2, s[8:11], s55 offen offset:1024  lds
    buffer_load_dwordx4 v2, s[8:11], s55 offen offset:2048  lds
    buffer_load_dwordx4 v2, s[8:11], s55 offen offset:3072  lds
    s_add_u32 m0, s62, 0
    s_mov_b32 s55, 4718592
    s_cmp_eq_u32 s63, 1
    s_cmov_b32 s55, 4947968
    buffer_load_dwordx4 v4, s[12:15], s55 offen offset:0  lds
    buffer_load_dwordx4 v5, s[12:15], s55 offen offset:1024  lds
    buffer_load_dwordx4 v6, s[12:15], s55 offen offset:2048  lds
    buffer_load_dwordx4 v7, s[12:15], s55 offen offset:3072  lds
    s_waitcnt vmcnt(12)
    s_barrier
    s_mov_b32 s55, 44
    s_cmp_eq_u32 s63, 1
    s_cmov_b32 s55, 46
    s_add_u32 s55, s55, s64
    s_lshl_b64 s[78:79], 1, s55
    s_andn2_b64 s[80:81], s[78:79], s[74:75]
    s_cbranch_scc0 K1_ok_84
    s_swappc_b64 s[82:83], s[84:85]
K1_ok_84:
    s_add_u32 m0, s61, 32768
    s_add_u32 s55, s66, 1409024
    buffer_load_dwordx4 v2, s[8:11], s55 offen offset:0  lds
    buffer_load_dwordx4 v2, s[8:11], s55 offen offset:1024  lds
    buffer_load_dwordx4 v2, s[8:11], s55 offen offset:2048  lds
    buffer_load_dwordx4 v2, s[8:11], s55 offen offset:3072  lds
    s_add_u32 m0, s61, 36864
    s_add_u32 s55, s66, 1413120
    buffer_load_dwordx4 v2, s[8:11], s55 offen offset:0  lds
    buffer_load_dwordx4 v2, s[8:11], s55 offen offset:1024  lds
    buffer_load_dwordx4 v2, s[8:11], s55 offen offset:2048  lds
    buffer_load_dwordx4 v2, s[8:11], s55 offen offset:3072  lds
    s_add_u32 m0, s62, 16384
    s_mov_b32 s55, 5177344
    s_cmp_eq_u32 s63, 1
    s_cmov_b32 s55, 5406720
    buffer_load_dwordx4 v4, s[12:15], s55 offen offset:0  lds
    buffer_load_dwordx4 v5, s[12:15], s55 offen offset:1024  lds
    buffer_load_dwordx4 v6, s[12:15], s55 offen offset:2048  lds
    buffer_load_dwordx4 v7, s[12:15], s55 offen offset:3072  lds
    s_waitcnt vmcnt(12)
    s_barrier
    s_mov_b32 s55, 48
    s_cmp_eq_u32 s63, 1
    s_cmov_b32 s55, 50
    s_add_u32 s55, s55, s64
    s_lshl_b64 s[78:79], 1, s55
    s_andn2_b64 s[80:81], s[78:79], s[74:75]
    s_cbranch_scc0 K1_ok_85
    s_swappc_b64 s[82:83], s[84:85]
K1_ok_85:
    s_add_u32 m0, s61, 65536
    s_add_u32 s55, s66, 1441792
    buffer_load_dwordx4 v2, s[8:11], s55 offen offset:0  lds
    buffer_load_dwordx4 v2, s[8:11], s55 offen offset:1024  lds
    buffer_load_dwordx4 v2, s[8:11], s55 offen offset:2048  lds
    buffer_load_dwordx4 v2, s[8:11], s55 offen offset:3072  lds
    s_add_u32 m0, s61, 69632
    s_add_u32 s55, s66, 1445888
    buffer_load_dwordx4 v2, s[8:11], s55 offen offset:0  lds
    buffer_load_dwordx4 v2, s[8:11], s55 offen offset:1024  lds
    buffer_load_dwordx4 v2, s[8:11], s55 offen offset:2048  lds
    buffer_load_dwordx4 v2, s[8:11], s55 offen offset:3072  lds
    s_add_u32 m0, s62, 32768
    s_mov_b32 s55, 5636096
    s_cmp_eq_u32 s63, 1
    s_cmov_b32 s55, 5865472
    buffer_load_dwordx4 v4, s[12:15], s55 offen offset:0  lds
    buffer_load_dwordx4 v5, s[12:15], s55 offen offset:1024  lds
    buffer_load_dwordx4 v6, s[12:15], s55 offen offset:2048  lds
    buffer_load_dwordx4 v7, s[12:15], s55 offen offset:3072  lds
    s_waitcnt vmcnt(12)
    s_barrier
    s_mov_b32 s55, 52
    s_cmp_eq_u32 s63, 1
    s_cmov_b32 s55, 54
    s_add_u32 s55, s55, s64
    s_lshl_b64 s[78:79], 1, s55
    s_andn2_b64 s[80:81], s[78:79], s[74:75]
    s_cbranch_scc0 K1_ok_86
    s_swappc_b64 s[82:83], s[84:85]
K1_ok_86:
    s_add_u32 m0, s61, 0
    s_add_u32 s55, s66, 1474560
    buffer_load_dwordx4 v2, s[8:11], s55 offen offset:0  lds
    buffer_load_dwordx4 v2, s[8:11], s55 offen offset:1024  lds
    buffer_load_dwordx4 v2, s[8:11], s55 offen offset:2048  lds
    buffer_load_dwordx4 v2, s[8:11], s55 offen offset:3072  lds
    s_add_u32 m0, s61, 4096
    s_add_u32 s55, s66, 1478656
    buffer_load_dwordx4 v2, s[8:11], s55 offen offset:0  lds
    buffer_load_dwordx4 v2, s[8:11], s55 offen offset:1024  lds
    buffer_load_dwordx4 v2, s[8:11], s55 offen offset:2048  lds
    buffer_load_dwordx4 v2, s[8:11], s55 offen offset:3072  lds
    s_add_u32 m0, s62, 0
    s_mov_b32 s55, 6094848
    s_cmp_eq_u32 s63, 1
    s_cmov_b32 s55, 6324224
    buffer_load_dwordx4 v4, s[12:15], s55 offen offset:0  lds
    buffer_load_dwordx4 v5, s[12:15], s55 offen offset:1024  lds
    buffer_load_dwordx4 v6, s[12:15], s55 offen offset:2048  lds
    buffer_load_dwordx4 v7, s[12:15], s55 offen offset:3072  lds
    s_waitcnt vmcnt(12)
    s_barrier
    s_mov_b32 s55, 56
    s_cmp_eq_u32 s63, 1
    s_cmov_b32 s55, 58
    s_add_u32 s55, s55, s64
    s_lshl_b64 s[78:79], 1, s55
    s_andn2_b64 s[80:81], s[78:79], s[74:75]
    s_cbranch_scc0 K1_ok_87
    s_swappc_b64 s[82:83], s[84:85]
K1_ok_87:
    s_add_u32 m0, s61, 32768
    s_add_u32 s55, s66, 1507328
    buffer_load_dwordx4 v2, s[8:11], s55 offen offset:0  lds
    buffer_load_dwordx4 v2, s[8:11], s55 offen offset:1024  lds
    buffer_load_dwordx4 v2, s[8:11], s55 offen offset:2048  lds
    buffer_load_dwordx4 v2, s[8:11], s55 offen offset:3072  lds
    s_add_u32 m0, s61, 36864
    s_add_u32 s55, s66, 1511424
    buffer_load_dwordx4 v2, s[8:11], s55 offen offset:0  lds
    buffer_load_dwordx4 v2, s[8:11], s55 offen offset:1024  lds
    buffer_load_dwordx4 v2, s[8:11], s55 offen offset:2048  lds
    buffer_load_dwordx4 v2, s[8:11], s55 offen offset:3072  lds
    s_add_u32 m0, s62, 16384
    s_mov_b32 s55, 6553600
    s_cmp_eq_u32 s63, 1
    s_cmov_b32 s55, 6782976
    buffer_load_dwordx4 v4, s[12:15], s55 offen offset:0  lds
    buffer_load_dwordx4 v5, s[12:15], s55 offen offset:1024  lds
    buffer_load_dwordx4 v6, s[12:15], s55 offen offset:2048  lds
    buffer_load_dwordx4 v7, s[12:15], s55 offen offset:3072  lds
    s_waitcnt vmcnt(12)
    s_barrier
    s_mov_b32 s55, 60
    s_cmp_eq_u32 s63, 1
    s_cmov_b32 s55, 62
    s_add_u32 s55, s55, s64
    s_lshl_b64 s[78:79], 1, s55
    s_andn2_b64 s[80:81], s[78:79], s[74:75]
    s_cbranch_scc0 K1_ok_88
    s_swappc_b64 s[82:83], s[84:85]
K1_ok_88:
    s_add_u32 m0, s61, 65536
    s_add_u32 s55, s66, 1540096
    buffer_load_dwordx4 v2, s[8:11], s55 offen offset:0  lds
    buffer_load_dwordx4 v2, s[8:11], s55 offen offset:1024  lds
    buffer_load_dwordx4 v2, s[8:11], s55 offen offset:2048  lds
    buffer_load_dwordx4 v2, s[8:11], s55 offen offset:3072  lds
    s_add_u32 m0, s61, 69632
    s_add_u32 s55, s66, 1544192
    buffer_load_dwordx4 v2, s[8:11], s55 offen offset:0  lds
    buffer_load_dwordx4 v2, s[8:11], s55 offen offset:1024  lds
    buffer_load_dwordx4 v2, s[8:11], s55 offen offset:2048  lds
    buffer_load_dwordx4 v2, s[8:11], s55 offen offset:3072  lds
    s_add_u32 m0, s62, 32768
    s_mov_b32 s55, 7012352
    s_cmp_eq_u32 s63, 1
    s_cmov_b32 s55, 7241728
    buffer_load_dwordx4 v4, s[12:15], s55 offen offset:0  lds
    buffer_load_dwordx4 v5, s[12:15], s55 offen offset:1024  lds
    buffer_load_dwordx4 v6, s[12:15], s55 offen offset:2048  lds
    buffer_load_dwordx4 v7, s[12:15], s55 offen offset:3072  lds
    s_waitcnt vmcnt(12)
    s_barrier
    s_mov_b32 s55, 0
    s_cmp_eq_u32 s63, 1
    s_cmov_b32 s55, 4
    s_add_u32 s55, s55, s64
    s_lshl_b64 s[78:79], 5, s55
    s_andn2_b64 s[80:81], s[78:79], s[74:75]
    s_cbranch_scc0 K1_ok_89
    s_swappc_b64 s[82:83], s[84:85]
K1_ok_89:
    s_add_u32 m0, s61, 0
    s_add_u32 s55, s67, 0
    buffer_load_dwordx4 v2, s[8:11], s55 offen offset:0  lds
    buffer_load_dwordx4 v2, s[8:11], s55 offen offset:1024  lds
    buffer_load_dwordx4 v2, s[8:11], s55 offen offset:2048  lds
    buffer_load_dwordx4 v2, s[8:11], s55 offen offset:3072  lds
    s_add_u32 m0, s61, 4096
    s_add_u32 s55, s67, 4096
    buffer_load_dwordx4 v2, s[8:11], s55 offen offset:0  lds
    buffer_load_dwordx4 v2, s[8:11], s55 offen offset:1024  lds
    buffer_load_dwordx4 v2, s[8:11], s55 offen offset:2048  lds
    buffer_load_dwordx4 v2, s[8:11], s55 offen offset:3072  lds
    s_add_u32 m0, s62, 0
    s_mov_b32 s55, 196608
    s_cmp_eq_u32 s63, 1
    s_cmov_b32 s55, 655360
    s_add_u32 s55, s55, s65
    buffer_load_dwordx4 v4, s[12:15], s55 offen offset:0  lds
    buffer_load_dwordx4 v5, s[12:15], s55 offen offset:1024  lds
    buffer_load_dwordx4 v6, s[12:15], s55 offen offset:2048  lds
    buffer_load_dwordx4 v7, s[12:15], s55 offen offset:3072  lds
    s_waitcnt vmcnt(12)
    s_barrier
    s_mov_b32 s55, 8
    s_cmp_eq_u32 s63, 1
    s_cmov_b32 s55, 12
    s_add_u32 s55, s55, s64
    s_lshl_b64 s[78:79], 5, s55
    s_andn2_b64 s[80:81], s[78:79], s[74:75]
    s_cbranch_scc0 K1_ok_90
    s_swappc_b64 s[82:83], s[84:85]
K1_ok_90:
    s_add_u32 m0, s61, 32768
    s_add_u32 s55, s67, 32768
    buffer_load_dwordx4 v2, s[8:11], s55 offen offset:0  lds
    buffer_load_dwordx4 v2, s[8:11], s55 offen offset:1024  lds
    buffer_load_dwordx4 v2, s[8:11], s55 offen offset:2048  lds
    buffer_load_dwordx4 v2, s[8:11], s55 offen offset:3072  lds
    s_add_u32 m0, s61, 36864
    s_add_u32 s55, s67, 36864
    buffer_load_dwordx4 v2, s[8:11], s55 offen offset:0  lds
    buffer_load_dwordx4 v2, s[8:11], s55 offen offset:1024  lds
    buffer_load_dwordx4 v2, s[8:11], s55 offen offset:2048  lds
    buffer_load_dwordx4 v2, s[8:11], s55 offen offset:3072  lds
    s_add_u32 m0, s62, 16384
    s_mov_b32 s55, 1114112
    s_cmp_eq_u32 s63, 1
    s_cmov_b32 s55, 1572864
    s_add_u32 s55, s55, s65
    buffer_load_dwordx4 v4, s[12:15], s55 offen offset:0  lds
    buffer_load_dwordx4 v5, s[12:15], s55 offen offset:1024  lds
    buffer_load_dwordx4 v6, s[12:15], s55 offen offset:2048  lds
    buffer_load_dwordx4 v7, s[12:15], s55 offen offset:3072  lds
    s_waitcnt vmcnt(12)
    s_barrier
    s_mov_b32 s55, 16
    s_cmp_eq_u32 s63, 1
    s_cmov_b32 s55, 20
    s_add_u32 s55, s55, s64
    s_lshl_b64 s[78:79], 5, s55
    s_andn2_b64 s[80:81], s[78:79], s[74:75]
    s_cbranch_scc0 K1_ok_91
    s_swappc_b64 s[82:83], s[84:85]
K1_ok_91:
    s_add_u32 m0, s61, 65536
    s_add_u32 s55, s67, 65536
    buffer_load_dwordx4 v2, s[8:11], s55 offen offset:0  lds
    buffer_load_dwordx4 v2, s[8:11], s55 offen offset:1024  lds
    buffer_load_dwordx4 v2, s[8:11], s55 offen offset:2048  lds
    buffer_load_dwordx4 v2, s[8:11], s55 offen offset:3072  lds
    s_add_u32 m0, s61, 69632
    s_add_u32 s55, s67, 69632
    buffer_load_dwordx4 v2, s[8:11], s55 offen offset:0  lds
    buffer_load_dwordx4 v2, s[8:11], s55 offen offset:1024  lds
    buffer_load_dwordx4 v2, s[8:11], s55 offen offset:2048  lds
    buffer_load_dwordx4 v2, s[8:11], s55 offen offset:3072  lds
    s_add_u32 m0, s62, 32768
    s_mov_b32 s55, 2031616
    s_cmp_eq_u32 s63, 1
    s_cmov_b32 s55, 2490368
    s_add_u32 s55, s55, s65
    buffer_load_dwordx4 v4, s[12:15], s55 offen offset:0  lds
    buffer_load_dwordx4 v5, s[12:15], s55 offen offset:1024  lds
    buffer_load_dwordx4 v6, s[12:15], s55 offen offset:2048  lds
    buffer_load_dwordx4 v7, s[12:15], s55 offen offset:3072  lds
    s_waitcnt vmcnt(12)
    s_barrier
    s_mov_b32 s55, 24
    s_cmp_eq_u32 s63, 1
    s_cmov_b32 s55, 28
    s_add_u32 s55, s55, s64
    s_lshl_b64 s[78:79], 5, s55
    s_andn2_b64 s[80:81], s[78:79], s[74:75]
    s_cbranch_scc0 K1_ok_92
    s_swappc_b64 s[82:83], s[84:85]
K1_ok_92:
    s_add_u32 m0, s61, 0
    s_add_u32 s55, s67, 98304
    buffer_load_dwordx4 v2, s[8:11], s55 offen offset:0  lds
    buffer_load_dwordx4 v2, s[8:11], s55 offen offset:1024  lds
    buffer_load_dwordx4 v2, s[8:11], s55 offen offset:2048  lds
    buffer_load_dwordx4 v2, s[8:11], s55 offen offset:3072  lds
    s_add_u32 m0, s61, 4096
    s_add_u32 s55, s67, 102400
    buffer_load_dwordx4 v2, s[8:11], s55 offen offset:0  lds
    buffer_load_dwordx4 v2, s[8:11], s55 offen offset:1024  lds
    buffer_load_dwordx4 v2, s[8:11], s55 offen offset:2048  lds
    buffer_load_dwordx4 v2, s[8:11], s55 offen offset:3072  lds
    s_add_u32 m0, s62, 0
    s_mov_b32 s55, 2949120
    s_cmp_eq_u32 s63, 1
    s_cmov_b32 s55, 3407872
    s_add_u32 s55, s55, s65
    buffer_load_dwordx4 v4, s[12:15], s55 offen offset:0  lds
    buffer_load_dwordx4 v5, s[12:15], s55 offen offset:1024  lds
    buffer_load_dwordx4 v6, s[12:15], s55 offen offset:2048  lds
    buffer_load_dwordx4 v7, s[12:15], s55 offen offset:3072  lds
    s_waitcnt vmcnt(12)
    s_barrier
    s_mov_b32 s55, 32
    s_cmp_eq_u32 s63, 1
    s_cmov_b32 s55, 36
    s_add_u32 s55, s55, s64
    s_lshl_b64 s[78:79], 5, s55
    s_andn2_b64 s[80:81], s[78:79], s[74:75]
    s_cbranch_scc0 K1_ok_93
    s_swappc_b64 s[82:83], s[84:85]
K1_ok_93:
    s_add_u32 m0, s61, 32768
    s_add_u32 s55, s67, 131072
    buffer_load_dwordx4 v2, s[8:11], s55 offen offset:0  lds
    buffer_load_dwordx4 v2, s[8:11], s55 offen offset:1024  lds
    buffer_load_dwordx4 v2, s[8:11], s55 offen offset:2048  lds
    buffer_load_dwordx4 v2, s[8:11], s55 offen offset:3072  lds
    s_add_u32 m0, s61, 36864
    s_add_u32 s55, s67, 135168
    buffer_load_dwordx4 v2, s[8:11], s55 offen offset:0  lds
    buffer_load_dwordx4 v2, s[8:11], s55 offen offset:1024  lds
    buffer_load_dwordx4 v2, s[8:11], s55 offen offset:2048  lds
    buffer_load_dwordx4 v2, s[8:11], s55 offen offset:3072  lds
    s_add_u32 m0, s62, 16384
    s_mov_b32 s55, 3866624
    s_cmp_eq_u32 s63, 1
    s_cmov_b32 s55, 4325376
    s_add_u32 s55, s55, s65
    buffer_load_dwordx4 v4, s[12:15], s55 offen offset:0  lds
    buffer_load_dwordx4 v5, s[12:15], s55 offen offset:1024  lds
    buffer_load_dwordx4 v6, s[12:15], s55 offen offset:2048  lds
    buffer_load_dwordx4 v7, s[12:15], s55 offen offset:3072  lds
    s_waitcnt vmcnt(12)
    s_barrier
    s_mov_b32 s55, 40
    s_cmp_eq_u32 s63, 1
    s_cmov_b32 s55, 44
    s_add_u32 s55, s55, s64
    s_lshl_b64 s[78:79], 5, s55
    s_andn2_b64 s[80:81], s[78:79], s[74:75]
    s_cbranch_scc0 K1_ok_94
    s_swappc_b64 s[82:83], s[84:85]
K1_ok_94:
    s_add_u32 m0, s61, 65536
    s_add_u32 s55, s67, 163840
    buffer_load_dwordx4 v2, s[8:11], s55 offen offset:0  lds
    buffer_load_dwordx4 v2, s[8:11], s55 offen offset:1024  lds
    buffer_load_dwordx4 v2, s[8:11], s55 offen offset:2048  lds
    buffer_load_dwordx4 v2, s[8:11], s55 offen offset:3072  lds
    s_add_u32 m0, s61, 69632
    s_add_u32 s55, s67, 167936
    buffer_load_dwordx4 v2, s[8:11], s55 offen offset:0  lds
    buffer_load_dwordx4 v2, s[8:11], s55 offen offset:1024  lds
    buffer_load_dwordx4 v2, s[8:11], s55 offen offset:2048  lds
    buffer_load_dwordx4 v2, s[8:11], s55 offen offset:3072  lds
    s_add_u32 m0, s62, 32768
    s_mov_b32 s55, 4784128
    s_cmp_eq_u32 s63, 1
    s_cmov_b32 s55, 5242880
    s_add_u32 s55, s55, s65
    buffer_load_dwordx4 v4, s[12:15], s55 offen offset:0  lds
    buffer_load_dwordx4 v5, s[12:15], s55 offen offset:1024  lds
    buffer_load_dwordx4 v6, s[12:15], s55 offen offset:2048  lds
    buffer_load_dwordx4 v7, s[12:15], s55 offen offset:3072  lds
    s_waitcnt vmcnt(12)
    s_barrier
    s_mov_b32 s55, 48
    s_cmp_eq_u32 s63, 1
    s_cmov_b32 s55, 52
    s_add_u32 s55, s55, s64
    s_lshl_b64 s[78:79], 5, s55
    s_andn2_b64 s[80:81], s[78:79], s[74:75]
    s_cbranch_scc0 K1_ok_95
    s_swappc_b64 s[82:83], s[84:85]
K1_ok_95:
    s_add_u32 m0, s61, 0
    s_add_u32 s55, s67, 196608
    buffer_load_dwordx4 v2, s[8:11], s55 offen offset:0  lds
    buffer_load_dwordx4 v2, s[8:11], s55 offen offset:1024  lds
    buffer_load_dwordx4 v2, s[8:11], s55 offen offset:2048  lds
    buffer_load_dwordx4 v2, s[8:11], s55 offen offset:3072  lds
    s_add_u32 m0, s61, 4096
    s_add_u32 s55, s67, 200704
    buffer_load_dwordx4 v2, s[8:11], s55 offen offset:0  lds
    buffer_load_dwordx4 v2, s[8:11], s55 offen offset:1024  lds
    buffer_load_dwordx4 v2, s[8:11], s55 offen offset:2048  lds
    buffer_load_dwordx4 v2, s[8:11], s55 offen offset:3072  lds
    s_add_u32 m0, s62, 0
    s_mov_b32 s55, 5701632
    s_cmp_eq_u32 s63, 1
    s_cmov_b32 s55, 6160384
    s_add_u32 s55, s55, s65
    buffer_load_dwordx4 v4, s[12:15], s55 offen offset:0  lds
    buffer_load_dwordx4 v5, s[12:15], s55 offen offset:1024  lds
    buffer_load_dwordx4 v6, s[12:15], s55 offen offset:2048  lds
    buffer_load_dwordx4 v7, s[12:15], s55 offen offset:3072  lds
    s_waitcnt vmcnt(12)
    s_barrier
    s_mov_b32 s55, 56
    s_cmp_eq_u32 s63, 1
    s_cmov_b32 s55, 60
    s_add_u32 s55, s55, s64
    s_lshl_b64 s[78:79], 5, s55
    s_andn2_b64 s[80:81], s[78:79], s[74:75]
    s_cbranch_scc0 K1_ok_96
    s_swappc_b64 s[82:83], s[84:85]
K1_ok_96:
    s_add_u32 m0, s61, 32768
    s_add_u32 s55, s67, 229376
    buffer_load_dwordx4 v2, s[8:11], s55 offen offset:0  lds
    buffer_load_dwordx4 v2, s[8:11], s55 offen offset:1024  lds
    buffer_load_dwordx4 v2, s[8:11], s55 offen offset:2048  lds
    buffer_load_dwordx4 v2, s[8:11], s55 offen offset:3072  lds
    s_add_u32 m0, s61, 36864
    s_add_u32 s55, s67, 233472
    buffer_load_dwordx4 v2, s[8:11], s55 offen offset:0  lds
    buffer_load_dwordx4 v2, s[8:11], s55 offen offset:1024  lds
    buffer_load_dwordx4 v2, s[8:11], s55 offen offset:2048  lds
    buffer_load_dwordx4 v2, s[8:11], s55 offen offset:3072  lds
    s_add_u32 m0, s62, 16384
    s_mov_b32 s55, 6619136
    s_cmp_eq_u32 s63, 1
    s_cmov_b32 s55, 7077888
    s_add_u32 s55, s55, s65
    buffer_load_dwordx4 v4, s[12:15], s55 offen offset:0  lds
    buffer_load_dwordx4 v5, s[12:15], s55 offen offset:1024  lds
    buffer_load_dwordx4 v6, s[12:15], s55 offen offset:2048  lds
    buffer_load_dwordx4 v7, s[12:15], s55 offen offset:3072  lds
    s_waitcnt vmcnt(12)
    s_barrier
    s_waitcnt vmcnt(0)
    s_barrier
    s_barrier
    s_mov_b32 s59, 0
    s_mov_b32 s70, 0
    s_branch K2_final
K2_final:
    v_lshlrev_b32 v241, 4, v1
    s_xor_b32 s71, s32, 4
    s_lshr_b32 s71, s71, 1
    s_and_b32 s72, s32, 1
    s_lshl_b32 s68, s34, 8
    s_lshl_b32 s69, s33, 6
    s_add_u32 s68, s68, s69
    s_lshl_b32 s69, s72, 2
    s_add_u32 s68, s68, s69
    v_and_b32 v252, 15, v1
    v_lshrrev_b32 v248, 2, v252
    v_lshlrev_b32 v248, 4, v248
    v_and_b32 v253, 1, v252
    v_lshl_add_u32 v248, v253, 3, v248
    v_bfe_u32 v253, v252, 1, 1
    v_add_u32 v248, v248, v253
    v_add_u32 v248, s68, v248
    s_lshl_b32 s68, s35, 7
    s_lshl_b32 s69, s71, 5
    s_add_u32 s68, s68, s69
    v_lshrrev_b32 v252, 4, v1
    v_lshl_add_u32 v252, v252, 2, s68
    v_lshlrev_b32 v253, 4, v248
    v_lshlrev_b32 v249, 12, v248
    v_lshl_add_u32 v249, v252, 2, v249
    v_lshrrev_b32 v248, 1, v249
    v_lshlrev_b32 v252, 1, v252
    s_mov_b32 s60, 0
    s_mov_b32 s61, 4096
    s_mov_b32 s62, 8192
    s_mov_b32 s63, 0
    s_mov_b32 s68, 48234496
    buffer_load_dwordx2 v[148:149], v253, s[8:11], s68 offen
    buffer_load_dwordx2 v[150:151], v253, s[8:11], s68 offen offset:32
    buffer_load_dwordx2 v[132:133], v248, s[24:27], s60 offen offset:0
    buffer_load_dwordx2 v[134:135], v248, s[24:27], s61 offen offset:0
    buffer_load_dwordx2 v[136:137], v248, s[24:27], s60 offen offset:32
    buffer_load_dwordx2 v[138:139], v248, s[24:27], s61 offen offset:32
    global_load_dwordx2 v[140:141], v252, s[42:43] offset:0
    global_load_dwordx2 v[144:145], v252, s[40:41] offset:0
    global_load_dwordx2 v[142:143], v252, s[42:43] offset:32
    global_load_dwordx2 v[146:147], v252, s[40:41] offset:32
    s_lshl_b32 s68, s71, 2
    s_add_u32 s68, s68, s72
    s_lshl_b32 s69, s36, 2
    s_add_u32 s69, s69, s33
    s_lshl_b32 s69, s69, 6
    s_add_u32 s69, s69, s68
    s_lshl_b32 s69, s69, 10
    s_add_u32 s64, s69, 27262976
    s_add_u32 s65, s64, 16384
    s_add_u32 s66, s64, 32768
    s_add_u32 s67, s64, 49152
    s_lshl_b32 s68, s68, 10
    s_add_u32 s68, s68, s59
    v_add_u32 v250, s68, v241
    s_mov_b32 s57, 0xffff0000
    s_waitcnt vmcnt(0)
    v_lshlrev_b32 v152, 16, v140
    v_and_b32 v153, s57, v140
    v_lshlrev_b32 v154, 16, v141
    v_and_b32 v155, s57, v141
    v_lshlrev_b32 v180, 16, v132
    v_and_b32 v181, s57, v132
    v_pk_add_f32 v[156:157], v[180:181], v[148:149] op_sel_hi:[1,0] neg_lo:[0,1] neg_hi:[0,1]
    v_pk_mul_f32 v[156:157], v[148:149], v[156:157] op_sel:[1,0] op_sel_hi:[1,1]
    v_cvt_pk_bf16_f32 v156, v156, v157
    v_and_b32 v157, s57, v156
    v_lshlrev_b32 v156, 16, v156
    v_pk_mul_f32 v[156:157], v[156:157], v[152:153]
    v_cvt_pk_bf16_f32 v156, v156, v157
    v_lshlrev_b32 v196, 16, v156
    v_and_b32 v197, s57, v156
    v_lshlrev_b32 v212, 16, v144
    v_and_b32 v213, s57, v144
    v_lshlrev_b32 v182, 16, v133
    v_and_b32 v183, s57, v133
    v_pk_add_f32 v[156:157], v[182:183], v[148:149] op_sel_hi:[1,0] neg_lo:[0,1] neg_hi:[0,1]
    v_pk_mul_f32 v[156:157], v[148:149], v[156:157] op_sel:[1,0] op_sel_hi:[1,1]
    v_cvt_pk_bf16_f32 v156, v156, v157
    v_and_b32 v157, s57, v156
    v_lshlrev_b32 v156, 16, v156
    v_pk_mul_f32 v[156:157], v[156:157], v[154:155]
    v_cvt_pk_bf16_f32 v156, v156, v157
    v_lshlrev_b32 v198, 16, v156
    v_and_b32 v199, s57, v156
    v_lshlrev_b32 v214, 16, v145
    v_and_b32 v215, s57, v145
    v_lshlrev_b32 v184, 16, v134
    v_and_b32 v185, s57, v134
    v_pk_add_f32 v[156:157], v[184:185], v[150:151] op_sel_hi:[1,0] neg_lo:[0,1] neg_hi:[0,1]
    v_pk_mul_f32 v[156:157], v[150:151], v[156:157] op_sel:[1,0] op_sel_hi:[1,1]
    v_cvt_pk_bf16_f32 v156, v156, v157
    v_and_b32 v157, s57, v156
    v_lshlrev_b32 v156, 16, v156
    v_pk_mul_f32 v[156:157], v[156:157], v[152:153]
    v_cvt_pk_bf16_f32 v156, v156, v157
    v_lshlrev_b32 v200, 16, v156
    v_and_b32 v201, s57, v156
    v_lshlrev_b32 v216, 16, v144
    v_and_b32 v217, s57, v144
    v_lshlrev_b32 v186, 16, v135
    v_and_b32 v187, s57, v135
    v_pk_add_f32 v[156:157], v[186:187], v[150:151] op_sel_hi:[1,0] neg_lo:[0,1] neg_hi:[0,1]
    v_pk_mul_f32 v[156:157], v[150:151], v[156:157] op_sel:[1,0] op_sel_hi:[1,1]
    v_cvt_pk_bf16_f32 v156, v156, v157
    v_and_b32 v157, s57, v156
    v_lshlrev_b32 v156, 16, v156
    v_pk_mul_f32 v[156:157], v[156:157], v[154:155]
    v_cvt_pk_bf16_f32 v156, v156, v157
    v_lshlrev_b32 v202, 16, v156
    v_and_b32 v203, s57, v156
    v_lshlrev_b32 v218, 16, v145
    v_and_b32 v219, s57, v145
    v_lshlrev_b32 v152, 16, v142
    v_and_b32 v153, s57, v142
    v_lshlrev_b32 v154, 16, v143
    v_and_b32 v155, s57, v143
    v_lshlrev_b32 v188, 16, v136
    v_and_b32 v189, s57, v136
    v_pk_add_f32 v[156:157], v[188:189], v[148:149] op_sel_hi:[1,0] neg_lo:[0,1] neg_hi:[0,1]
    v_pk_mul_f32 v[156:157], v[148:149], v[156:157] op_sel:[1,0] op_sel_hi:[1,1]
    v_cvt_pk_bf16_f32 v156, v156, v157
    v_and_b32 v157, s57, v156
    v_lshlrev_b32 v156, 16, v156
    v_pk_mul_f32 v[156:157], v[156:157], v[152:153]
    v_cvt_pk_bf16_f32 v156, v156, v157
    v_lshlrev_b32 v204, 16, v156
    v_and_b32 v205, s57, v156
    v_lshlrev_b32 v220, 16, v146
    v_and_b32 v221, s57, v146
    v_lshlrev_b32 v190, 16, v137
    v_and_b32 v191, s57, v137
    v_pk_add_f32 v[156:157], v[190:191], v[148:149] op_sel_hi:[1,0] neg_lo:[0,1] neg_hi:[0,1]
    v_pk_mul_f32 v[156:157], v[148:149], v[156:157] op_sel:[1,0] op_sel_hi:[1,1]
    v_cvt_pk_bf16_f32 v156, v156, v157
    v_and_b32 v157, s57, v156
    v_lshlrev_b32 v156, 16, v156
    v_pk_mul_f32 v[156:157], v[156:157], v[154:155]
    v_cvt_pk_bf16_f32 v156, v156, v157
    v_lshlrev_b32 v206, 16, v156
    v_and_b32 v207, s57, v156
    v_lshlrev_b32 v222, 16, v147
    v_and_b32 v223, s57, v147
    v_lshlrev_b32 v192, 16, v138
    v_and_b32 v193, s57, v138
    v_pk_add_f32 v[156:157], v[192:193], v[150:151] op_sel_hi:[1,0] neg_lo:[0,1] neg_hi:[0,1]
    v_pk_mul_f32 v[156:157], v[150:151], v[156:157] op_sel:[1,0] op_sel_hi:[1,1]
    v_cvt_pk_bf16_f32 v156, v156, v157
    v_and_b32 v157, s57, v156
    v_lshlrev_b32 v156, 16, v156
    v_pk_mul_f32 v[156:157], v[156:157], v[152:153]
    v_cvt_pk_bf16_f32 v156, v156, v157
    v_lshlrev_b32 v208, 16, v156
    v_and_b32 v209, s57, v156
    v_lshlrev_b32 v224, 16, v146
    v_and_b32 v225, s57, v146
    v_lshlrev_b32 v194, 16, v139
    v_and_b32 v195, s57, v139
    v_pk_add_f32 v[156:157], v[194:195], v[150:151] op_sel_hi:[1,0] neg_lo:[0,1] neg_hi:[0,1]
    v_pk_mul_f32 v[156:157], v[150:151], v[156:157] op_sel:[1,0] op_sel_hi:[1,1]
    v_cvt_pk_bf16_f32 v156, v156, v157
    v_and_b32 v157, s57, v156
    v_lshlrev_b32 v156, 16, v156
    v_pk_mul_f32 v[156:157], v[156:157], v[154:155]
    v_cvt_pk_bf16_f32 v156, v156, v157
    v_lshlrev_b32 v210, 16, v156
    v_and_b32 v211, s57, v156
    v_lshlrev_b32 v226, 16, v147
    v_and_b32 v227, s57, v147
    s_barrier
K2_own:
    ds_read_b128 v[36:39], v250 offset:0
    ds_read_b128 v[40:43], v250 offset:2048
K2_first:
    v_lshlrev_b32 v253, 2, v1
    s_mov_b32 s68, 0
    s_lshl_b32 s58, s36, 2
    s_add_u32 s58, s58, s33
    s_lshl_b32 s58, s58, 2
    s_add_u32 s58, s58, s71
    s_lshl_b32 s58, s58, 7
    s_add_u32 s58, s58, 49283072
    s_cmp_lt_u32 s32, 4
    s_cbranch_scc1 K2_probe
    s_sleep 8
K2_probe:
    s_mov_b64 exec, 15
    buffer_load_dword v252, v253, s[8:11], s58 offen sc1
    s_waitcnt vmcnt(0)
    v_cmp_eq_u32 vcc, 1, v252
    s_mov_b64 exec, -1
    s_add_u32 s63, s63, 1
    s_cmp_gt_u32 s63, 0x40000
    s_nop 1
    s_cselect_b32 s69, 15, vcc_lo
    s_andn2_b32 s69, s69, s68
    s_or_b32 s68, s68, s69
    s_bitcmp1_b32 s69, 3
    s_cbranch_scc0 K2_skip3
    buffer_load_dwordx4 v[28:31], v241, s[8:11], s67 offen offset:0 sc1
    buffer_load_dwordx4 v[32:35], v241, s[8:11], s67 offen offset:2048 sc1
K2_skip3:
    s_bitcmp1_b32 s69, 0
    s_cbranch_scc0 K2_skip0
    buffer_load_dwordx4 v[4:7], v241, s[8:11], s64 offen offset:0 sc1
    buffer_load_dwordx4 v[8:11], v241, s[8:11], s64 offen offset:2048 sc1
K2_skip0:
    s_bitcmp1_b32 s69, 1
    s_cbranch_scc0 K2_skip1
    buffer_load_dwordx4 v[12:15], v241, s[8:11], s65 offen offset:0 sc1
    buffer_load_dwordx4 v[16:19], v241, s[8:11], s65 offen offset:2048 sc1
K2_skip1:
    s_bitcmp1_b32 s69, 2
    s_cbranch_scc0 K2_skip2
    buffer_load_dwordx4 v[20:23], v241, s[8:11], s66 offen offset:0 sc1
    buffer_load_dwordx4 v[24:27], v241, s[8:11], s66 offen offset:2048 sc1
K2_skip2:
    s_cmp_eq_u32 s68, 15
    s_cbranch_scc1 K2_all
    s_sleep 4
    s_branch K2_probe
K2_all:
    s_waitcnt vmcnt(0)
K2_ready:
    v_lshlrev_b32 v156, 16, v4
    v_and_b32 v157, s57, v4
    v_pk_add_f32 v[196:197], v[196:197], v[156:157]
    v_lshlrev_b32 v158, 16, v5
    v_and_b32 v159, s57, v5
    v_pk_add_f32 v[198:199], v[198:199], v[158:159]
    v_lshlrev_b32 v156, 16, v6
    v_and_b32 v157, s57, v6
    v_pk_add_f32 v[200:201], v[200:201], v[156:157]
    v_lshlrev_b32 v158, 16, v7
    v_and_b32 v159, s57, v7
    v_pk_add_f32 v[202:203], v[202:203], v[158:159]
    v_lshlrev_b32 v156, 16, v8
    v_and_b32 v157, s57, v8
    v_pk_add_f32 v[204:205], v[204:205], v[156:157]
    v_lshlrev_b32 v158, 16, v9
    v_and_b32 v159, s57, v9
    v_pk_add_f32 v[206:207], v[206:207], v[158:159]
    v_lshlrev_b32 v156, 16, v10
    v_and_b32 v157, s57, v10
    v_pk_add_f32 v[208:209], v[208:209], v[156:157]
    v_lshlrev_b32 v158, 16, v11
    v_and_b32 v159, s57, v11
    v_pk_add_f32 v[210:211], v[210:211], v[158:159]
    v_lshlrev_b32 v156, 16, v20
    v_and_b32 v157, s57, v20
    v_pk_add_f32 v[212:213], v[212:213], v[156:157]
    v_lshlrev_b32 v158, 16, v21
    v_and_b32 v159, s57, v21
    v_pk_add_f32 v[214:215], v[214:215], v[158:159]
    v_lshlrev_b32 v156, 16, v22
    v_and_b32 v157, s57, v22
    v_pk_add_f32 v[216:217], v[216:217], v[156:157]
    v_lshlrev_b32 v158, 16, v23
    v_and_b32 v159, s57, v23
    v_pk_add_f32 v[218:219], v[218:219], v[158:159]
    v_lshlrev_b32 v156, 16, v24
    v_and_b32 v157, s57, v24
    v_pk_add_f32 v[220:221], v[220:221], v[156:157]
    v_lshlrev_b32 v158, 16, v25
    v_and_b32 v159, s57, v25
    v_pk_add_f32 v[222:223], v[222:223], v[158:159]
    v_lshlrev_b32 v156, 16, v26
    v_and_b32 v157, s57, v26
    v_pk_add_f32 v[224:225], v[224:225], v[156:157]
    v_lshlrev_b32 v158, 16, v27
    v_and_b32 v159, s57, v27
    v_pk_add_f32 v[226:227], v[226:227], v[158:159]
    v_lshlrev_b32 v156, 16, v28
    v_and_b32 v157, s57, v28
    v_pk_add_f32 v[212:213], v[212:213], v[156:157]
    v_lshlrev_b32 v158, 16, v29
    v_and_b32 v159, s57, v29
    v_pk_add_f32 v[214:215], v[214:215], v[158:159]
    v_lshlrev_b32 v156, 16, v30
    v_and_b32 v157, s57, v30
    v_pk_add_f32 v[216:217], v[216:217], v[156:157]
    v_lshlrev_b32 v158, 16, v31
    v_and_b32 v159, s57, v31
    v_pk_add_f32 v[218:219], v[218:219], v[158:159]
    v_lshlrev_b32 v156, 16, v32
    v_and_b32 v157, s57, v32
    v_pk_add_f32 v[220:221], v[220:221], v[156:157]
    v_lshlrev_b32 v158, 16, v33
    v_and_b32 v159, s57, v33
    v_pk_add_f32 v[222:223], v[222:223], v[158:159]
    v_lshlrev_b32 v156, 16, v34
    v_and_b32 v157, s57, v34
    v_pk_add_f32 v[224:225], v[224:225], v[156:157]
    v_lshlrev_b32 v158, 16, v35
    v_and_b32 v159, s57, v35
    v_pk_add_f32 v[226:227], v[226:227], v[158:159]
    s_waitcnt lgkmcnt(0)
    s_cmp_ge_u32 s33, 2
    s_cbranch_scc1 K2_s1S
    v_lshlrev_b32 v156, 16, v12
    v_and_b32 v157, s57, v12
    v_pk_add_f32 v[212:213], v[212:213], v[156:157]
    v_lshlrev_b32 v158, 16, v13
    v_and_b32 v159, s57, v13
    v_pk_add_f32 v[214:215], v[214:215], v[158:159]
    v_lshlrev_b32 v156, 16, v14
    v_and_b32 v157, s57, v14
    v_pk_add_f32 v[216:217], v[216:217], v[156:157]
    v_lshlrev_b32 v158, 16, v15
    v_and_b32 v159, s57, v15
    v_pk_add_f32 v[218:219], v[218:219], v[158:159]
    v_lshlrev_b32 v156, 16, v16
    v_and_b32 v157, s57, v16
    v_pk_add_f32 v[220:221], v[220:221], v[156:157]
    v_lshlrev_b32 v158, 16, v17
    v_and_b32 v159, s57, v17
    v_pk_add_f32 v[222:223], v[222:223], v[158:159]
    v_lshlrev_b32 v156, 16, v18
    v_and_b32 v157, s57, v18
    v_pk_add_f32 v[224:225], v[224:225], v[156:157]
    v_lshlrev_b32 v158, 16, v19
    v_and_b32 v159, s57, v19
    v_pk_add_f32 v[226:227], v[226:227], v[158:159]
    v_lshlrev_b32 v156, 16, v36
    v_and_b32 v157, s57, v36
    v_pk_add_f32 v[196:197], v[196:197], v[156:157]
    v_lshlrev_b32 v158, 16, v37
    v_and_b32 v159, s57, v37
    v_pk_add_f32 v[198:199], v[198:199], v[158:159]
    v_lshlrev_b32 v156, 16, v38
    v_and_b32 v157, s57, v38
    v_pk_add_f32 v[200:201], v[200:201], v[156:157]
    v_lshlrev_b32 v158, 16, v39
    v_and_b32 v159, s57, v39
    v_pk_add_f32 v[202:203], v[202:203], v[158:159]
    v_lshlrev_b32 v156, 16, v40
    v_and_b32 v157, s57, v40
    v_pk_add_f32 v[204:205], v[204:205], v[156:157]
    v_lshlrev_b32 v158, 16, v41
    v_and_b32 v159, s57, v41
    v_pk_add_f32 v[206:207], v[206:207], v[158:159]
    v_lshlrev_b32 v156, 16, v42
    v_and_b32 v157, s57, v42
    v_pk_add_f32 v[208:209], v[208:209], v[156:157]
    v_lshlrev_b32 v158, 16, v43
    v_and_b32 v159, s57, v43
    v_pk_add_f32 v[210:211], v[210:211], v[158:159]
    s_branch K2_sum
K2_s1S:
    v_lshlrev_b32 v156, 16, v12
    v_and_b32 v157, s57, v12
    v_pk_add_f32 v[196:197], v[196:197], v[156:157]
    v_lshlrev_b32 v158, 16, v13
    v_and_b32 v159, s57, v13
    v_pk_add_f32 v[198:199], v[198:199], v[158:159]
    v_lshlrev_b32 v156, 16, v14
    v_and_b32 v157, s57, v14
    v_pk_add_f32 v[200:201], v[200:201], v[156:157]
    v_lshlrev_b32 v158, 16, v15
    v_and_b32 v159, s57, v15
    v_pk_add_f32 v[202:203], v[202:203], v[158:159]
    v_lshlrev_b32 v156, 16, v16
    v_and_b32 v157, s57, v16
    v_pk_add_f32 v[204:205], v[204:205], v[156:157]
    v_lshlrev_b32 v158, 16, v17
    v_and_b32 v159, s57, v17
    v_pk_add_f32 v[206:207], v[206:207], v[158:159]
    v_lshlrev_b32 v156, 16, v18
    v_and_b32 v157, s57, v18
    v_pk_add_f32 v[208:209], v[208:209], v[156:157]
    v_lshlrev_b32 v158, 16, v19
    v_and_b32 v159, s57, v19
    v_pk_add_f32 v[210:211], v[210:211], v[158:159]
    v_lshlrev_b32 v156, 16, v36
    v_and_b32 v157, s57, v36
    v_pk_add_f32 v[212:213], v[212:213], v[156:157]
    v_lshlrev_b32 v158, 16, v37
    v_and_b32 v159, s57, v37
    v_pk_add_f32 v[214:215], v[214:215], v[158:159]
    v_lshlrev_b32 v156, 16, v38
    v_and_b32 v157, s57, v38
    v_pk_add_f32 v[216:217], v[216:217], v[156:157]
    v_lshlrev_b32 v158, 16, v39
    v_and_b32 v159, s57, v39
    v_pk_add_f32 v[218:219], v[218:219], v[158:159]
    v_lshlrev_b32 v156, 16, v40
    v_and_b32 v157, s57, v40
    v_pk_add_f32 v[220:221], v[220:221], v[156:157]
    v_lshlrev_b32 v158, 16, v41
    v_and_b32 v159, s57, v41
    v_pk_add_f32 v[222:223], v[222:223], v[158:159]
    v_lshlrev_b32 v156, 16, v42
    v_and_b32 v157, s57, v42
    v_pk_add_f32 v[224:225], v[224:225], v[156:157]
    v_lshlrev_b32 v158, 16, v43
    v_and_b32 v159, s57, v43
    v_pk_add_f32 v[226:227], v[226:227], v[158:159]
K2_sum:
    s_mov_b32 s56, 0xbfb8aa3b
    v_pk_mul_f32 v[156:157], v[212:213], s[56:57] op_sel_hi:[1,0]
    v_exp_f32 v156, v156
    v_exp_f32 v157, v157
    v_pk_mul_f32 v[158:159], v[214:215], s[56:57] op_sel_hi:[1,0]
    v_exp_f32 v158, v158
    v_exp_f32 v159, v159
    v_pk_add_f32 v[156:157], v[156:157], 1.0
    v_rcp_f32 v156, v156
    v_rcp_f32 v157, v157
    v_pk_add_f32 v[158:159], v[158:159], 1.0
    v_rcp_f32 v158, v158
    v_rcp_f32 v159, v159
    v_pk_mul_f32 v[212:213], v[212:213], v[156:157]
    v_pk_mul_f32 v[214:215], v[214:215], v[158:159]
    v_pk_fma_f32 v[212:213], v[212:213], v[196:197], v[180:181]
    v_pk_fma_f32 v[214:215], v[214:215], v[198:199], v[182:183]
    buffer_store_dwordx4 v[212:215], v249, s[28:31], s60 offen offset:0 sc1
    v_pk_mul_f32 v[156:157], v[216:217], s[56:57] op_sel_hi:[1,0]
    v_exp_f32 v156, v156
    v_exp_f32 v157, v157
    v_pk_mul_f32 v[158:159], v[218:219], s[56:57] op_sel_hi:[1,0]
    v_exp_f32 v158, v158
    v_exp_f32 v159, v159
    v_pk_add_f32 v[156:157], v[156:157], 1.0
    v_rcp_f32 v156, v156
    v_rcp_f32 v157, v157
    v_pk_add_f32 v[158:159], v[158:159], 1.0
    v_rcp_f32 v158, v158
    v_rcp_f32 v159, v159
    v_pk_mul_f32 v[216:217], v[216:217], v[156:157]
    v_pk_mul_f32 v[218:219], v[218:219], v[158:159]
    v_pk_fma_f32 v[216:217], v[216:217], v[200:201], v[184:185]
    v_pk_fma_f32 v[218:219], v[218:219], v[202:203], v[186:187]
    buffer_store_dwordx4 v[216:219], v249, s[28:31], s62 offen offset:0 sc1
    v_pk_mul_f32 v[156:157], v[220:221], s[56:57] op_sel_hi:[1,0]
    v_exp_f32 v156, v156
    v_exp_f32 v157, v157
    v_pk_mul_f32 v[158:159], v[222:223], s[56:57] op_sel_hi:[1,0]
    v_exp_f32 v158, v158
    v_exp_f32 v159, v159
    v_pk_add_f32 v[156:157], v[156:157], 1.0
    v_rcp_f32 v156, v156
    v_rcp_f32 v157, v157
    v_pk_add_f32 v[158:159], v[158:159], 1.0
    v_rcp_f32 v158, v158
    v_rcp_f32 v159, v159
    v_pk_mul_f32 v[220:221], v[220:221], v[156:157]
    v_pk_mul_f32 v[222:223], v[222:223], v[158:159]
    v_pk_fma_f32 v[220:221], v[220:221], v[204:205], v[188:189]
    v_pk_fma_f32 v[222:223], v[222:223], v[206:207], v[190:191]
    buffer_store_dwordx4 v[220:223], v249, s[28:31], s60 offen offset:64 sc1
    v_pk_mul_f32 v[156:157], v[224:225], s[56:57] op_sel_hi:[1,0]
    v_exp_f32 v156, v156
    v_exp_f32 v157, v157
    v_pk_mul_f32 v[158:159], v[226:227], s[56:57] op_sel_hi:[1,0]
    v_exp_f32 v158, v158
    v_exp_f32 v159, v159
    v_pk_add_f32 v[156:157], v[156:157], 1.0
    v_rcp_f32 v156, v156
    v_rcp_f32 v157, v157
    v_pk_add_f32 v[158:159], v[158:159], 1.0
    v_rcp_f32 v158, v158
    v_rcp_f32 v159, v159
    v_pk_mul_f32 v[224:225], v[224:225], v[156:157]
    v_pk_mul_f32 v[226:227], v[226:227], v[158:159]
    v_pk_fma_f32 v[224:225], v[224:225], v[208:209], v[192:193]
    v_pk_fma_f32 v[226:227], v[226:227], v[210:211], v[194:195]
    buffer_store_dwordx4 v[224:227], v249, s[28:31], s62 offen offset:64 sc1
K2_end:
    s_endpgm
K1_end:
    s_endpgm

.section .rodata,"a"
.p2align 6
.amdhsa_kernel recurrent_scan__ssm_conv_s5__mixer_channel_mlp__prompt_kernel
  .amdhsa_next_free_vgpr 256
  .amdhsa_next_free_sgpr 102
  .amdhsa_accum_offset 256
  .amdhsa_group_segment_fixed_size 0
  .amdhsa_kernarg_size 136
  .amdhsa_user_sgpr_count 2
  .amdhsa_user_sgpr_kernarg_segment_ptr 1
  .amdhsa_system_sgpr_workgroup_id_x 1
  .amdhsa_float_denorm_mode_32 3
  .amdhsa_ieee_mode 0
  .amdhsa_dx10_clamp 1
.end_amdhsa_kernel
```
